```python
import torch

def _softmax(x, axis=-1):
    return torch.softmax(x, dim=axis)

def _gelu(x):
    return torch.nn.functional.gelu(x, approximate='tanh')

def _silu(x):
    return torch.nn.functional.silu(x)

def _sigmoid(x):
    return torch.sigmoid(x)

def _layernorm(x, axis=-1, eps=1e-05):
    m = x.mean(dim=axis, keepdim=True)
    v = x.var(dim=axis, keepdim=True, unbiased=False)
    return (x - m) / torch.sqrt(v + eps)

def _scatter_add(tgt, idx, src, axis=0):
    return tgt.clone().index_add_(axis, idx, src)

def _segment_sum(src, seg, n):
    out = torch.zeros((n,) + src.shape[1:], dtype=src.dtype)
    return out.index_add_(0, seg, src)

def _pad(x, pw):
    flat = tuple((v for pair in reversed(pw) for v in pair))
    return torch.nn.functional.pad(x, flat)
kernel_name = 'adaLN_cond__ssm_conv_s4d__dense_activation_silu__prompt'

def setup_inputs():

    _w = lambda a: (lambda t: t.to(torch.bfloat16) if t.is_floating_point() else t)(torch.as_tensor(a))

    def _A_setup():
        Bsz, L, D, N = (1, 2048, 576, 128)
        return {'u': _w((lambda *s: torch.randn(*s, dtype=torch.bfloat16) * 0.05)(Bsz, L, D)), 'log_A_real': _w((lambda *s: torch.randn(*s, dtype=torch.bfloat16) * 3.2)(D, N) * 0.5), 'A_imag': _w((lambda *s: torch.randn(*s, dtype=torch.bfloat16) * 0.05)(D, N) * 3.14), 'C_real': _w((lambda *s: torch.randn(*s, dtype=torch.bfloat16) * 0.2)(D, N) / N ** 0.5), 'C_imag': _w((lambda *s: torch.randn(*s, dtype=torch.bfloat16) * 0.2)(D, N) / N ** 0.5), 'log_dt': _w((lambda *s: torch.randn(*s, dtype=torch.bfloat16) * 0.05)(D) * 0.5 - 4.0), 'D_skip': _w((lambda *s: torch.randn(*s, dtype=torch.bfloat16) * 0.1)(D))}
    _A_in = _A_setup()

    def _B_setup():
        B, S, D, F = (1, 2048, 576, 4608)
        return {'x': _w((lambda *s: torch.randn(*s, dtype=torch.bfloat16) * 0.05)(B, S, D)), 'w1': _w((lambda *s: torch.randn(*s, dtype=torch.bfloat16) * 3.2)(D, F) * D ** (-0.5)), 'w2': _w((lambda *s: torch.randn(*s, dtype=torch.bfloat16) * 0.4)(F, D) * F ** (-0.5))}
    _B_in = _B_setup()
    return {'A_u': _A_in['u'], 'A_log_A_real': _A_in['log_A_real'], 'A_A_imag': _A_in['A_imag'], 'A_C_real': _A_in['C_real'], 'A_C_imag': _A_in['C_imag'], 'A_log_dt': _A_in['log_dt'], 'A_D_skip': _A_in['D_skip'], 'B_x': _B_in['x'], 'B_w1': _B_in['w1'], 'B_w2': _B_in['w2'], 'c': _w((lambda *s: torch.randn(*s, dtype=torch.bfloat16) * 0.2)(1, 576) * 8.0), 'w_mod': _w((lambda *s: torch.randn(*s, dtype=torch.bfloat16) * 0.2)(576, 6 * 576) * 576 ** (-0.5) * 8.0)}

def reference(A_u, A_log_A_real, A_A_imag, A_C_real, A_C_imag, A_log_dt, A_D_skip, B_x, B_w1, B_w2, c, w_mod):

    def _A_ref(u, log_A_real, A_imag, C_real, C_imag, log_dt, D_skip):
        L = u.shape[1]
        dt = torch.exp(log_dt)
        A = -torch.exp(log_A_real) + 1j * A_imag
        C = (C_real + 1j * C_imag) * dt[:, None]
        pos = (lambda x, dt: x.to(dt))(torch.arange(L), log_dt.dtype)
        P = torch.exp((A * dt[:, None])[:, :, None] * pos[None, None, :])
        K = 2.0 * torch.einsum('dn,dnl->dl', C, P).real
        L2 = 2 * L
        u_t = (lambda x, *d: x.permute(*d))(u, 0, 2, 1)
        Kf = (lambda x, *a, **k: torch.fft.rfft(x.float(), *a, **k))(K, L2)
        Uf = (lambda x, *a, **k: torch.fft.rfft(x.float(), *a, **k))(u_t, L2)
        y = (lambda x, *a, **k: torch.fft.irfft(x, *a, **k).to(torch.bfloat16))(Uf * Kf[None, :, :], L2)[:, :, :L]
        y = (lambda x, *d: x.permute(*d))(y, 0, 2, 1)
        return y + u * D_skip[None, None, :]

    def _B_ref(x, w1, w2):
        h = torch.einsum('bsd,df->bsf', x, w1)
        h = _silu(h)
        out = torch.einsum('bsf,fd->bsd', h, w2)
        return out
    x = A_u
    mod = (_silu(c) @ w_mod).reshape(c.shape[0], 6, 1, -1)
    sa, ca, ga, sb, cb, gb = (mod[:, 0].clone(), mod[:, 1].clone(), mod[:, 2].clone(), mod[:, 3].clone(), mod[:, 4].clone(), mod[:, 5].clone())
    h = _layernorm(x, axis=-1) * (1 + ca) + sa
    x = x + ga * _A_ref(h, A_log_A_real, A_A_imag, A_C_real, A_C_imag, A_log_dt, A_D_skip)
    h = _layernorm(x, axis=-1) * (1 + cb) + sb
    x = x + gb * _B_ref(h, B_w1, B_w2)
    return x
```

```asm
; @launch kernel=f_kernel grid=(256,1,1) block=(512,1,1) lds=154176
; @launch kernel=m_kernel grid=(256,1,1) block=(512,1,1) lds=152576
.amdgcn_target "amdgcn-amd-amdhsa--gfx950"
.text
.globl f_kernel
.p2align 8
.type f_kernel,@function
f_kernel:
    s_cmp_ge_u32 s2, 256
    s_cbranch_scc1 f_end
    s_load_dwordx2 s[4:5], s[0:1], 112
    s_load_dwordx2 s[6:7], s[0:1], 104
    v_mov_b32 v63, v0
    v_lshrrev_b32 v1, 6, v0
    v_and_b32 v0, 63, v0
    v_readfirstlane_b32 s14, v1
    v_mov_b32 v59, 153920
    v_mov_b32 v58, 0
    s_mov_b64 exec, 1
    ds_write_b32 v59, v58
    ds_write_b32 v59, v58 offset:4
    ds_write_b32 v59, v58 offset:16
    s_mov_b64 exec, -1
    v_mov_b32 v58, 1
    s_waitcnt lgkmcnt(0)
    s_barrier
    s_mov_b32 s8, s4
    s_mov_b32 s9, s5
    s_mov_b32 s10, 79564800
    s_mov_b32 s11, 0x00020000
    s_mov_b32 s52, s6
    s_mov_b32 s53, s7
    s_mov_b32 s54, 256
    s_mov_b32 s55, 0x00020000
    s_cmp_lg_u32 s14, 6
    s_cbranch_scc1 f_noz
    s_lshl_b32 s16, s2, 7
    s_add_u32 s17, s16, 53379072
    s_add_u32 s16, s16, 53313536
    v_mov_b32 v244, 0
    v_mov_b32 v245, 0
    v_mov_b32 v246, 0
    v_mov_b32 v247, 0
    s_mov_b64 exec, 1
    buffer_store_dwordx4 v[244:247], v244, s[8:11], s16 offen
    buffer_store_dwordx4 v[244:247], v244, s[8:11], s17 offen
    buffer_store_dwordx4 v[244:247], v244, s[8:11], s17 offen offset:16
    s_mov_b64 exec, -1
f_noz:
    s_cmp_ge_u32 s2, 112
    s_cbranch_scc1 f_conv
    s_cmp_lt_u32 s14, 4
    s_cbranch_scc1 f_nocpf
    s_getpc_b64 s[44:45]
f_pc:
    s_sub_u32 s44, s44, f_pc-f_kernel
    s_subb_u32 s45, s45, 0
    s_mov_b32 s46, code_end-f_kernel
    s_mov_b32 s47, 0x00020000
    s_lshr_b32 s33, s2, 3
    s_lshl_b32 s33, s33, 2
    s_add_u32 s33, s33, s14
    s_sub_u32 s33, s33, 4
    s_lshl_b32 s33, s33, 10
    v_lshlrev_b32 v56, 4, v0
    buffer_load_dwordx4 v[248:251], v56, s[44:47], s33 offen
f_nocpf:
    s_lshl_b32 s38, s2, 1
    s_mov_b32 s39, 8
    s_cmp_ge_u32 s2, 64
    s_cbranch_scc1 f_mod
    s_cmp_ge_u32 s14, 4
    s_cbranch_scc1 f_pref
    s_load_dwordx2 s[16:17], s[0:1], 0
    s_lshl_b32 s15, s2, 5
    s_lshl_b32 s18, s14, 3
    s_add_u32 s15, s15, s18
    s_mul_i32 s18, s15, 1152
    v_lshrrev_b32 v1, 3, v0
    v_and_b32 v2, 7, v0
    v_mul_u32_u24 v3, 1152, v1
    v_lshl_add_u32 v3, v2, 4, v3
    s_add_u32 s19, s18, 9216
    s_waitcnt lgkmcnt(0)
    s_mov_b32 s20, s16
    s_mov_b32 s21, s17
    s_mov_b32 s22, 2359296
    s_mov_b32 s23, 0x00020000
    buffer_load_dwordx4 v[64:67], v3, s[20:23], s18 offen offset:0
    buffer_load_dwordx4 v[68:71], v3, s[20:23], s18 offen offset:128
    buffer_load_dwordx4 v[72:75], v3, s[20:23], s18 offen offset:256
    buffer_load_dwordx4 v[76:79], v3, s[20:23], s18 offen offset:384
    buffer_load_dwordx4 v[80:83], v3, s[20:23], s18 offen offset:512
    buffer_load_dwordx4 v[84:87], v3, s[20:23], s18 offen offset:640
    buffer_load_dwordx4 v[88:91], v3, s[20:23], s18 offen offset:768
    buffer_load_dwordx4 v[92:95], v3, s[20:23], s18 offen offset:896
    buffer_load_dwordx4 v[96:99], v3, s[20:23], s18 offen offset:1024
    s_mov_b32 s24, 0x3f803f80
    s_mov_b32 s25, 0x3ae38e39
    s_mov_b32 s26, 0x3727c5ac
    s_lshl_b32 s27, s15, 2
    s_add_u32 s27, s27, 2433024
    v_lshlrev_b32 v4, 2, v1
    v_lshlrev_b32 v5, 9, v2
    v_lshl_add_u32 v5, v1, 4, v5
    s_lshr_b32 s28, s15, 5
    s_mul_i32 s28, s28, 36864
    s_and_b32 s29, s15, 31
    s_lshl_b32 s29, s29, 4
    s_add_u32 s28, s28, s29
    s_add_u32 s28, s28, 73728
    s_waitcnt vmcnt(8)
    s_add_u32 s29, s28, 0
    buffer_store_dwordx4 v[64:67], v5, s[8:11], s29 offen sc1
    s_waitcnt vmcnt(8)
    s_add_u32 s29, s28, 4096
    buffer_store_dwordx4 v[68:71], v5, s[8:11], s29 offen sc1
    s_waitcnt vmcnt(8)
    s_add_u32 s29, s28, 8192
    buffer_store_dwordx4 v[72:75], v5, s[8:11], s29 offen sc1
    s_waitcnt vmcnt(8)
    s_add_u32 s29, s28, 12288
    buffer_store_dwordx4 v[76:79], v5, s[8:11], s29 offen sc1
    s_waitcnt vmcnt(8)
    s_add_u32 s29, s28, 16384
    buffer_store_dwordx4 v[80:83], v5, s[8:11], s29 offen sc1
    s_waitcnt vmcnt(8)
    s_add_u32 s29, s28, 20480
    buffer_store_dwordx4 v[84:87], v5, s[8:11], s29 offen sc1
    s_waitcnt vmcnt(8)
    s_add_u32 s29, s28, 24576
    buffer_store_dwordx4 v[88:91], v5, s[8:11], s29 offen sc1
    s_waitcnt vmcnt(8)
    s_add_u32 s29, s28, 28672
    buffer_store_dwordx4 v[92:95], v5, s[8:11], s29 offen sc1
    s_waitcnt vmcnt(8)
    s_add_u32 s29, s28, 32768
    buffer_store_dwordx4 v[96:99], v5, s[8:11], s29 offen sc1
    v_mov_b32 v6, 0
    v_mov_b32 v8, 0
    s_mov_b64 exec, 1
    ds_add_u32 v59, v58
    s_mov_b64 exec, -1
    v_dot2_f32_bf16 v6, v64, s24, v6
    v_dot2_f32_bf16 v8, v65, s24, v8
    v_dot2_f32_bf16 v6, v66, s24, v6
    v_dot2_f32_bf16 v8, v67, s24, v8
    v_dot2_f32_bf16 v6, v68, s24, v6
    v_dot2_f32_bf16 v8, v69, s24, v8
    v_dot2_f32_bf16 v6, v70, s24, v6
    v_dot2_f32_bf16 v8, v71, s24, v8
    v_dot2_f32_bf16 v6, v72, s24, v6
    v_dot2_f32_bf16 v8, v73, s24, v8
    v_dot2_f32_bf16 v6, v74, s24, v6
    v_dot2_f32_bf16 v8, v75, s24, v8
    v_dot2_f32_bf16 v6, v76, s24, v6
    v_dot2_f32_bf16 v8, v77, s24, v8
    v_dot2_f32_bf16 v6, v78, s24, v6
    v_dot2_f32_bf16 v8, v79, s24, v8
    v_dot2_f32_bf16 v6, v80, s24, v6
    v_dot2_f32_bf16 v8, v81, s24, v8
    v_dot2_f32_bf16 v6, v82, s24, v6
    v_dot2_f32_bf16 v8, v83, s24, v8
    v_dot2_f32_bf16 v6, v84, s24, v6
    v_dot2_f32_bf16 v8, v85, s24, v8
    v_dot2_f32_bf16 v6, v86, s24, v6
    v_dot2_f32_bf16 v8, v87, s24, v8
    v_dot2_f32_bf16 v6, v88, s24, v6
    v_dot2_f32_bf16 v8, v89, s24, v8
    v_dot2_f32_bf16 v6, v90, s24, v6
    v_dot2_f32_bf16 v8, v91, s24, v8
    v_dot2_f32_bf16 v6, v92, s24, v6
    v_dot2_f32_bf16 v8, v93, s24, v8
    v_dot2_f32_bf16 v6, v94, s24, v6
    v_dot2_f32_bf16 v8, v95, s24, v8
    v_dot2_f32_bf16 v6, v96, s24, v6
    v_dot2_f32_bf16 v8, v97, s24, v8
    v_dot2_f32_bf16 v6, v98, s24, v6
    v_dot2_f32_bf16 v8, v99, s24, v8
    s_nop 2
    v_add_f32 v6, v6, v8
    s_nop 1
    v_add_f32_dpp v6, v6, v6 quad_perm:[1,0,3,2] row_mask:0xf bank_mask:0xf
    s_nop 1
    v_add_f32_dpp v6, v6, v6 quad_perm:[2,3,0,1] row_mask:0xf bank_mask:0xf
    s_nop 1
    v_add_f32_dpp v6, v6, v6 row_half_mirror row_mask:0xf bank_mask:0xf
    v_mul_f32 v6, s25, v6
    v_mov_b32 v10, 0
    v_mov_b32 v11, 0
    v_mov_b32 v12, 0
    v_mov_b32 v13, 0
    v_lshlrev_b32 v14, 16, v64
    v_and_b32 v15, 0xffff0000, v64
    v_pk_add_f32 v[14:15], v[14:15], v[6:7] op_sel_hi:[1,0] neg_lo:[0,1] neg_hi:[0,1]
    v_pk_fma_f32 v[10:11], v[14:15], v[14:15], v[10:11]
    v_lshlrev_b32 v16, 16, v65
    v_and_b32 v17, 0xffff0000, v65
    v_pk_add_f32 v[16:17], v[16:17], v[6:7] op_sel_hi:[1,0] neg_lo:[0,1] neg_hi:[0,1]
    v_pk_fma_f32 v[12:13], v[16:17], v[16:17], v[12:13]
    v_lshlrev_b32 v14, 16, v66
    v_and_b32 v15, 0xffff0000, v66
    v_pk_add_f32 v[14:15], v[14:15], v[6:7] op_sel_hi:[1,0] neg_lo:[0,1] neg_hi:[0,1]
    v_pk_fma_f32 v[10:11], v[14:15], v[14:15], v[10:11]
    v_lshlrev_b32 v16, 16, v67
    v_and_b32 v17, 0xffff0000, v67
    v_pk_add_f32 v[16:17], v[16:17], v[6:7] op_sel_hi:[1,0] neg_lo:[0,1] neg_hi:[0,1]
    v_pk_fma_f32 v[12:13], v[16:17], v[16:17], v[12:13]
    v_lshlrev_b32 v14, 16, v68
    v_and_b32 v15, 0xffff0000, v68
    v_pk_add_f32 v[14:15], v[14:15], v[6:7] op_sel_hi:[1,0] neg_lo:[0,1] neg_hi:[0,1]
    v_pk_fma_f32 v[10:11], v[14:15], v[14:15], v[10:11]
    v_lshlrev_b32 v16, 16, v69
    v_and_b32 v17, 0xffff0000, v69
    v_pk_add_f32 v[16:17], v[16:17], v[6:7] op_sel_hi:[1,0] neg_lo:[0,1] neg_hi:[0,1]
    v_pk_fma_f32 v[12:13], v[16:17], v[16:17], v[12:13]
    v_lshlrev_b32 v14, 16, v70
    v_and_b32 v15, 0xffff0000, v70
    v_pk_add_f32 v[14:15], v[14:15], v[6:7] op_sel_hi:[1,0] neg_lo:[0,1] neg_hi:[0,1]
    v_pk_fma_f32 v[10:11], v[14:15], v[14:15], v[10:11]
    v_lshlrev_b32 v16, 16, v71
    v_and_b32 v17, 0xffff0000, v71
    v_pk_add_f32 v[16:17], v[16:17], v[6:7] op_sel_hi:[1,0] neg_lo:[0,1] neg_hi:[0,1]
    v_pk_fma_f32 v[12:13], v[16:17], v[16:17], v[12:13]
    v_lshlrev_b32 v14, 16, v72
    v_and_b32 v15, 0xffff0000, v72
    v_pk_add_f32 v[14:15], v[14:15], v[6:7] op_sel_hi:[1,0] neg_lo:[0,1] neg_hi:[0,1]
    v_pk_fma_f32 v[10:11], v[14:15], v[14:15], v[10:11]
    v_lshlrev_b32 v16, 16, v73
    v_and_b32 v17, 0xffff0000, v73
    v_pk_add_f32 v[16:17], v[16:17], v[6:7] op_sel_hi:[1,0] neg_lo:[0,1] neg_hi:[0,1]
    v_pk_fma_f32 v[12:13], v[16:17], v[16:17], v[12:13]
    v_lshlrev_b32 v14, 16, v74
    v_and_b32 v15, 0xffff0000, v74
    v_pk_add_f32 v[14:15], v[14:15], v[6:7] op_sel_hi:[1,0] neg_lo:[0,1] neg_hi:[0,1]
    v_pk_fma_f32 v[10:11], v[14:15], v[14:15], v[10:11]
    v_lshlrev_b32 v16, 16, v75
    v_and_b32 v17, 0xffff0000, v75
    v_pk_add_f32 v[16:17], v[16:17], v[6:7] op_sel_hi:[1,0] neg_lo:[0,1] neg_hi:[0,1]
    v_pk_fma_f32 v[12:13], v[16:17], v[16:17], v[12:13]
    v_lshlrev_b32 v14, 16, v76
    v_and_b32 v15, 0xffff0000, v76
    v_pk_add_f32 v[14:15], v[14:15], v[6:7] op_sel_hi:[1,0] neg_lo:[0,1] neg_hi:[0,1]
    v_pk_fma_f32 v[10:11], v[14:15], v[14:15], v[10:11]
    v_lshlrev_b32 v16, 16, v77
    v_and_b32 v17, 0xffff0000, v77
    v_pk_add_f32 v[16:17], v[16:17], v[6:7] op_sel_hi:[1,0] neg_lo:[0,1] neg_hi:[0,1]
    v_pk_fma_f32 v[12:13], v[16:17], v[16:17], v[12:13]
    v_lshlrev_b32 v14, 16, v78
    v_and_b32 v15, 0xffff0000, v78
    v_pk_add_f32 v[14:15], v[14:15], v[6:7] op_sel_hi:[1,0] neg_lo:[0,1] neg_hi:[0,1]
    v_pk_fma_f32 v[10:11], v[14:15], v[14:15], v[10:11]
    v_lshlrev_b32 v16, 16, v79
    v_and_b32 v17, 0xffff0000, v79
    v_pk_add_f32 v[16:17], v[16:17], v[6:7] op_sel_hi:[1,0] neg_lo:[0,1] neg_hi:[0,1]
    v_pk_fma_f32 v[12:13], v[16:17], v[16:17], v[12:13]
    v_lshlrev_b32 v14, 16, v80
    v_and_b32 v15, 0xffff0000, v80
    v_pk_add_f32 v[14:15], v[14:15], v[6:7] op_sel_hi:[1,0] neg_lo:[0,1] neg_hi:[0,1]
    v_pk_fma_f32 v[10:11], v[14:15], v[14:15], v[10:11]
    v_lshlrev_b32 v16, 16, v81
    v_and_b32 v17, 0xffff0000, v81
    v_pk_add_f32 v[16:17], v[16:17], v[6:7] op_sel_hi:[1,0] neg_lo:[0,1] neg_hi:[0,1]
    v_pk_fma_f32 v[12:13], v[16:17], v[16:17], v[12:13]
    v_lshlrev_b32 v14, 16, v82
    v_and_b32 v15, 0xffff0000, v82
    v_pk_add_f32 v[14:15], v[14:15], v[6:7] op_sel_hi:[1,0] neg_lo:[0,1] neg_hi:[0,1]
    v_pk_fma_f32 v[10:11], v[14:15], v[14:15], v[10:11]
    v_lshlrev_b32 v16, 16, v83
    v_and_b32 v17, 0xffff0000, v83
    v_pk_add_f32 v[16:17], v[16:17], v[6:7] op_sel_hi:[1,0] neg_lo:[0,1] neg_hi:[0,1]
    v_pk_fma_f32 v[12:13], v[16:17], v[16:17], v[12:13]
    v_lshlrev_b32 v14, 16, v84
    v_and_b32 v15, 0xffff0000, v84
    v_pk_add_f32 v[14:15], v[14:15], v[6:7] op_sel_hi:[1,0] neg_lo:[0,1] neg_hi:[0,1]
    v_pk_fma_f32 v[10:11], v[14:15], v[14:15], v[10:11]
    v_lshlrev_b32 v16, 16, v85
    v_and_b32 v17, 0xffff0000, v85
    v_pk_add_f32 v[16:17], v[16:17], v[6:7] op_sel_hi:[1,0] neg_lo:[0,1] neg_hi:[0,1]
    v_pk_fma_f32 v[12:13], v[16:17], v[16:17], v[12:13]
    v_lshlrev_b32 v14, 16, v86
    v_and_b32 v15, 0xffff0000, v86
    v_pk_add_f32 v[14:15], v[14:15], v[6:7] op_sel_hi:[1,0] neg_lo:[0,1] neg_hi:[0,1]
    v_pk_fma_f32 v[10:11], v[14:15], v[14:15], v[10:11]
    v_lshlrev_b32 v16, 16, v87
    v_and_b32 v17, 0xffff0000, v87
    v_pk_add_f32 v[16:17], v[16:17], v[6:7] op_sel_hi:[1,0] neg_lo:[0,1] neg_hi:[0,1]
    v_pk_fma_f32 v[12:13], v[16:17], v[16:17], v[12:13]
    v_lshlrev_b32 v14, 16, v88
    v_and_b32 v15, 0xffff0000, v88
    v_pk_add_f32 v[14:15], v[14:15], v[6:7] op_sel_hi:[1,0] neg_lo:[0,1] neg_hi:[0,1]
    v_pk_fma_f32 v[10:11], v[14:15], v[14:15], v[10:11]
    v_lshlrev_b32 v16, 16, v89
    v_and_b32 v17, 0xffff0000, v89
    v_pk_add_f32 v[16:17], v[16:17], v[6:7] op_sel_hi:[1,0] neg_lo:[0,1] neg_hi:[0,1]
    v_pk_fma_f32 v[12:13], v[16:17], v[16:17], v[12:13]
    v_lshlrev_b32 v14, 16, v90
    v_and_b32 v15, 0xffff0000, v90
    v_pk_add_f32 v[14:15], v[14:15], v[6:7] op_sel_hi:[1,0] neg_lo:[0,1] neg_hi:[0,1]
    v_pk_fma_f32 v[10:11], v[14:15], v[14:15], v[10:11]
    v_lshlrev_b32 v16, 16, v91
    v_and_b32 v17, 0xffff0000, v91
    v_pk_add_f32 v[16:17], v[16:17], v[6:7] op_sel_hi:[1,0] neg_lo:[0,1] neg_hi:[0,1]
    v_pk_fma_f32 v[12:13], v[16:17], v[16:17], v[12:13]
    v_lshlrev_b32 v14, 16, v92
    v_and_b32 v15, 0xffff0000, v92
    v_pk_add_f32 v[14:15], v[14:15], v[6:7] op_sel_hi:[1,0] neg_lo:[0,1] neg_hi:[0,1]
    v_pk_fma_f32 v[10:11], v[14:15], v[14:15], v[10:11]
    v_lshlrev_b32 v16, 16, v93
    v_and_b32 v17, 0xffff0000, v93
    v_pk_add_f32 v[16:17], v[16:17], v[6:7] op_sel_hi:[1,0] neg_lo:[0,1] neg_hi:[0,1]
    v_pk_fma_f32 v[12:13], v[16:17], v[16:17], v[12:13]
    v_lshlrev_b32 v14, 16, v94
    v_and_b32 v15, 0xffff0000, v94
    v_pk_add_f32 v[14:15], v[14:15], v[6:7] op_sel_hi:[1,0] neg_lo:[0,1] neg_hi:[0,1]
    v_pk_fma_f32 v[10:11], v[14:15], v[14:15], v[10:11]
    v_lshlrev_b32 v16, 16, v95
    v_and_b32 v17, 0xffff0000, v95
    v_pk_add_f32 v[16:17], v[16:17], v[6:7] op_sel_hi:[1,0] neg_lo:[0,1] neg_hi:[0,1]
    v_pk_fma_f32 v[12:13], v[16:17], v[16:17], v[12:13]
    v_lshlrev_b32 v14, 16, v96
    v_and_b32 v15, 0xffff0000, v96
    v_pk_add_f32 v[14:15], v[14:15], v[6:7] op_sel_hi:[1,0] neg_lo:[0,1] neg_hi:[0,1]
    v_pk_fma_f32 v[10:11], v[14:15], v[14:15], v[10:11]
    v_lshlrev_b32 v16, 16, v97
    v_and_b32 v17, 0xffff0000, v97
    v_pk_add_f32 v[16:17], v[16:17], v[6:7] op_sel_hi:[1,0] neg_lo:[0,1] neg_hi:[0,1]
    v_pk_fma_f32 v[12:13], v[16:17], v[16:17], v[12:13]
    v_lshlrev_b32 v14, 16, v98
    v_and_b32 v15, 0xffff0000, v98
    v_pk_add_f32 v[14:15], v[14:15], v[6:7] op_sel_hi:[1,0] neg_lo:[0,1] neg_hi:[0,1]
    v_pk_fma_f32 v[10:11], v[14:15], v[14:15], v[10:11]
    v_lshlrev_b32 v16, 16, v99
    v_and_b32 v17, 0xffff0000, v99
    v_pk_add_f32 v[16:17], v[16:17], v[6:7] op_sel_hi:[1,0] neg_lo:[0,1] neg_hi:[0,1]
    v_pk_fma_f32 v[12:13], v[16:17], v[16:17], v[12:13]
    v_pk_add_f32 v[10:11], v[10:11], v[12:13]
    v_add_f32 v10, v10, v11
    s_nop 1
    v_add_f32_dpp v10, v10, v10 quad_perm:[1,0,3,2] row_mask:0xf bank_mask:0xf
    s_nop 1
    v_add_f32_dpp v10, v10, v10 quad_perm:[2,3,0,1] row_mask:0xf bank_mask:0xf
    s_nop 1
    v_add_f32_dpp v10, v10, v10 row_half_mirror row_mask:0xf bank_mask:0xf
    v_mul_f32 v10, s25, v10
    v_cvt_pk_bf16_f32 v10, v10, v10
    v_lshlrev_b32 v10, 16, v10
    v_add_f32 v10, s26, v10
    v_cvt_pk_bf16_f32 v10, v10, v10
    v_lshlrev_b32 v10, 16, v10
    v_sqrt_f32 v10, v10
    s_nop 0
    v_cvt_pk_bf16_f32 v18, v6, v10
    buffer_store_dword v18, v4, s[8:11], s27 offen offset:0 sc1
    s_mov_b64 exec, 1
    ds_add_u32 v59, v58
    s_mov_b64 exec, -1
    s_branch f_publish
f_mod:
    s_load_dwordx2 s[16:17], s[0:1], 88
    s_load_dwordx2 s[18:19], s[0:1], 80
    s_waitcnt lgkmcnt(0)
    s_mov_b32 s20, s16
    s_mov_b32 s21, s17
    s_mov_b32 s22, 3981312
    s_mov_b32 s23, 0x00020000
    s_mov_b32 s24, s18
    s_mov_b32 s25, s19
    s_mov_b32 s26, 1152
    s_mov_b32 s27, 0x00020000
    s_sub_u32 s15, s2, 64
    s_lshr_b32 s28, s15, 2
    s_and_b32 s29, s15, 3
    s_mul_i32 s16, s28, 576
    s_mul_i32 s17, s29, 995328
    s_add_u32 s16, s16, s17
    v_min_u32 v1, 431, v63
    v_mul_u32_u24 v2, 1821, v1
    v_lshrrev_b32 v2, 16, v2
    v_mul_u32_u24 v3, 36, v2
    v_sub_u32 v3, v1, v3
    v_mul_u32_u24 v4, 6912, v2
    v_lshl_add_u32 v4, v3, 4, v4
    v_lshlrev_b32 v5, 1, v63
    s_mul_i32 s17, s29, 288
    buffer_load_ushort v8, v5, s[24:27], s17 offen
    buffer_load_dwordx4 v[64:67], v4, s[20:23], s16 offen
    s_add_u32 s16, s16, 82944
    buffer_load_dwordx4 v[68:71], v4, s[20:23], s16 offen
    s_add_u32 s16, s16, 82944
    buffer_load_dwordx4 v[72:75], v4, s[20:23], s16 offen
    s_add_u32 s16, s16, 82944
    buffer_load_dwordx4 v[76:79], v4, s[20:23], s16 offen
    s_add_u32 s16, s16, 82944
    buffer_load_dwordx4 v[80:83], v4, s[20:23], s16 offen
    s_add_u32 s16, s16, 82944
    buffer_load_dwordx4 v[84:87], v4, s[20:23], s16 offen
    s_add_u32 s16, s16, 82944
    buffer_load_dwordx4 v[88:91], v4, s[20:23], s16 offen
    s_add_u32 s16, s16, 82944
    buffer_load_dwordx4 v[92:95], v4, s[20:23], s16 offen
    s_add_u32 s16, s16, 82944
    buffer_load_dwordx4 v[96:99], v4, s[20:23], s16 offen
    s_add_u32 s16, s16, 82944
    buffer_load_dwordx4 v[100:103], v4, s[20:23], s16 offen
    s_add_u32 s16, s16, 82944
    buffer_load_dwordx4 v[104:107], v4, s[20:23], s16 offen
    s_add_u32 s16, s16, 82944
    buffer_load_dwordx4 v[108:111], v4, s[20:23], s16 offen
    s_add_u32 s16, s16, 82944
    s_waitcnt vmcnt(12)
    s_mov_b32 s16, 0xbfb8aa3b
    v_lshlrev_b32 v5, 2, v63
    v_add_u32 v5, 110592, v5
    v_lshlrev_b32 v8, 16, v8
    v_mul_f32 v11, s16, v8
    v_exp_f32 v11, v11
    s_nop 0
    v_add_f32 v11, 1.0, v11
    v_rcp_f32 v11, v11
    s_nop 0
    v_mul_f32 v8, v8, v11
    v_cvt_pk_bf16_f32 v8, v8, v8
    v_lshlrev_b32 v8, 16, v8
    ds_write_b32 v5, v8
    v_lshlrev_b32 v6, 2, v2
    v_add_u32 v6, 110592, v6
    s_waitcnt lgkmcnt(0)
    s_barrier
    ds_read_b32 v16, v6 offset:0
    ds_read_b32 v17, v6 offset:48
    ds_read_b32 v18, v6 offset:96
    ds_read_b32 v19, v6 offset:144
    ds_read_b32 v20, v6 offset:192
    ds_read_b32 v21, v6 offset:240
    ds_read_b32 v22, v6 offset:288
    ds_read_b32 v23, v6 offset:336
    ds_read_b32 v24, v6 offset:384
    ds_read_b32 v25, v6 offset:432
    ds_read_b32 v26, v6 offset:480
    ds_read_b32 v27, v6 offset:528
    v_mov_b32 v40, 0
    v_mov_b32 v41, 0
    v_mov_b32 v42, 0
    v_mov_b32 v43, 0
    v_mov_b32 v44, 0
    v_mov_b32 v45, 0
    v_mov_b32 v46, 0
    v_mov_b32 v47, 0
    s_waitcnt lgkmcnt(0)
    s_waitcnt vmcnt(11)
    v_lshlrev_b32 v12, 16, v64
    v_and_b32 v13, 0xffff0000, v64
    v_fmac_f32 v40, v16, v12
    v_fmac_f32 v41, v16, v13
    v_lshlrev_b32 v12, 16, v65
    v_and_b32 v13, 0xffff0000, v65
    v_fmac_f32 v42, v16, v12
    v_fmac_f32 v43, v16, v13
    v_lshlrev_b32 v12, 16, v66
    v_and_b32 v13, 0xffff0000, v66
    v_fmac_f32 v44, v16, v12
    v_fmac_f32 v45, v16, v13
    v_lshlrev_b32 v12, 16, v67
    v_and_b32 v13, 0xffff0000, v67
    v_fmac_f32 v46, v16, v12
    v_fmac_f32 v47, v16, v13
    s_waitcnt vmcnt(10)
    v_lshlrev_b32 v12, 16, v68
    v_and_b32 v13, 0xffff0000, v68
    v_fmac_f32 v40, v17, v12
    v_fmac_f32 v41, v17, v13
    v_lshlrev_b32 v12, 16, v69
    v_and_b32 v13, 0xffff0000, v69
    v_fmac_f32 v42, v17, v12
    v_fmac_f32 v43, v17, v13
    v_lshlrev_b32 v12, 16, v70
    v_and_b32 v13, 0xffff0000, v70
    v_fmac_f32 v44, v17, v12
    v_fmac_f32 v45, v17, v13
    v_lshlrev_b32 v12, 16, v71
    v_and_b32 v13, 0xffff0000, v71
    v_fmac_f32 v46, v17, v12
    v_fmac_f32 v47, v17, v13
    s_waitcnt vmcnt(9)
    v_lshlrev_b32 v12, 16, v72
    v_and_b32 v13, 0xffff0000, v72
    v_fmac_f32 v40, v18, v12
    v_fmac_f32 v41, v18, v13
    v_lshlrev_b32 v12, 16, v73
    v_and_b32 v13, 0xffff0000, v73
    v_fmac_f32 v42, v18, v12
    v_fmac_f32 v43, v18, v13
    v_lshlrev_b32 v12, 16, v74
    v_and_b32 v13, 0xffff0000, v74
    v_fmac_f32 v44, v18, v12
    v_fmac_f32 v45, v18, v13
    v_lshlrev_b32 v12, 16, v75
    v_and_b32 v13, 0xffff0000, v75
    v_fmac_f32 v46, v18, v12
    v_fmac_f32 v47, v18, v13
    s_waitcnt vmcnt(8)
    v_lshlrev_b32 v12, 16, v76
    v_and_b32 v13, 0xffff0000, v76
    v_fmac_f32 v40, v19, v12
    v_fmac_f32 v41, v19, v13
    v_lshlrev_b32 v12, 16, v77
    v_and_b32 v13, 0xffff0000, v77
    v_fmac_f32 v42, v19, v12
    v_fmac_f32 v43, v19, v13
    v_lshlrev_b32 v12, 16, v78
    v_and_b32 v13, 0xffff0000, v78
    v_fmac_f32 v44, v19, v12
    v_fmac_f32 v45, v19, v13
    v_lshlrev_b32 v12, 16, v79
    v_and_b32 v13, 0xffff0000, v79
    v_fmac_f32 v46, v19, v12
    v_fmac_f32 v47, v19, v13
    s_waitcnt vmcnt(7)
    v_lshlrev_b32 v12, 16, v80
    v_and_b32 v13, 0xffff0000, v80
    v_fmac_f32 v40, v20, v12
    v_fmac_f32 v41, v20, v13
    v_lshlrev_b32 v12, 16, v81
    v_and_b32 v13, 0xffff0000, v81
    v_fmac_f32 v42, v20, v12
    v_fmac_f32 v43, v20, v13
    v_lshlrev_b32 v12, 16, v82
    v_and_b32 v13, 0xffff0000, v82
    v_fmac_f32 v44, v20, v12
    v_fmac_f32 v45, v20, v13
    v_lshlrev_b32 v12, 16, v83
    v_and_b32 v13, 0xffff0000, v83
    v_fmac_f32 v46, v20, v12
    v_fmac_f32 v47, v20, v13
    s_waitcnt vmcnt(6)
    v_lshlrev_b32 v12, 16, v84
    v_and_b32 v13, 0xffff0000, v84
    v_fmac_f32 v40, v21, v12
    v_fmac_f32 v41, v21, v13
    v_lshlrev_b32 v12, 16, v85
    v_and_b32 v13, 0xffff0000, v85
    v_fmac_f32 v42, v21, v12
    v_fmac_f32 v43, v21, v13
    v_lshlrev_b32 v12, 16, v86
    v_and_b32 v13, 0xffff0000, v86
    v_fmac_f32 v44, v21, v12
    v_fmac_f32 v45, v21, v13
    v_lshlrev_b32 v12, 16, v87
    v_and_b32 v13, 0xffff0000, v87
    v_fmac_f32 v46, v21, v12
    v_fmac_f32 v47, v21, v13
    s_waitcnt vmcnt(5)
    v_lshlrev_b32 v12, 16, v88
    v_and_b32 v13, 0xffff0000, v88
    v_fmac_f32 v40, v22, v12
    v_fmac_f32 v41, v22, v13
    v_lshlrev_b32 v12, 16, v89
    v_and_b32 v13, 0xffff0000, v89
    v_fmac_f32 v42, v22, v12
    v_fmac_f32 v43, v22, v13
    v_lshlrev_b32 v12, 16, v90
    v_and_b32 v13, 0xffff0000, v90
    v_fmac_f32 v44, v22, v12
    v_fmac_f32 v45, v22, v13
    v_lshlrev_b32 v12, 16, v91
    v_and_b32 v13, 0xffff0000, v91
    v_fmac_f32 v46, v22, v12
    v_fmac_f32 v47, v22, v13
    s_waitcnt vmcnt(4)
    v_lshlrev_b32 v12, 16, v92
    v_and_b32 v13, 0xffff0000, v92
    v_fmac_f32 v40, v23, v12
    v_fmac_f32 v41, v23, v13
    v_lshlrev_b32 v12, 16, v93
    v_and_b32 v13, 0xffff0000, v93
    v_fmac_f32 v42, v23, v12
    v_fmac_f32 v43, v23, v13
    v_lshlrev_b32 v12, 16, v94
    v_and_b32 v13, 0xffff0000, v94
    v_fmac_f32 v44, v23, v12
    v_fmac_f32 v45, v23, v13
    v_lshlrev_b32 v12, 16, v95
    v_and_b32 v13, 0xffff0000, v95
    v_fmac_f32 v46, v23, v12
    v_fmac_f32 v47, v23, v13
    s_waitcnt vmcnt(3)
    v_lshlrev_b32 v12, 16, v96
    v_and_b32 v13, 0xffff0000, v96
    v_fmac_f32 v40, v24, v12
    v_fmac_f32 v41, v24, v13
    v_lshlrev_b32 v12, 16, v97
    v_and_b32 v13, 0xffff0000, v97
    v_fmac_f32 v42, v24, v12
    v_fmac_f32 v43, v24, v13
    v_lshlrev_b32 v12, 16, v98
    v_and_b32 v13, 0xffff0000, v98
    v_fmac_f32 v44, v24, v12
    v_fmac_f32 v45, v24, v13
    v_lshlrev_b32 v12, 16, v99
    v_and_b32 v13, 0xffff0000, v99
    v_fmac_f32 v46, v24, v12
    v_fmac_f32 v47, v24, v13
    s_waitcnt vmcnt(2)
    v_lshlrev_b32 v12, 16, v100
    v_and_b32 v13, 0xffff0000, v100
    v_fmac_f32 v40, v25, v12
    v_fmac_f32 v41, v25, v13
    v_lshlrev_b32 v12, 16, v101
    v_and_b32 v13, 0xffff0000, v101
    v_fmac_f32 v42, v25, v12
    v_fmac_f32 v43, v25, v13
    v_lshlrev_b32 v12, 16, v102
    v_and_b32 v13, 0xffff0000, v102
    v_fmac_f32 v44, v25, v12
    v_fmac_f32 v45, v25, v13
    v_lshlrev_b32 v12, 16, v103
    v_and_b32 v13, 0xffff0000, v103
    v_fmac_f32 v46, v25, v12
    v_fmac_f32 v47, v25, v13
    s_waitcnt vmcnt(1)
    v_lshlrev_b32 v12, 16, v104
    v_and_b32 v13, 0xffff0000, v104
    v_fmac_f32 v40, v26, v12
    v_fmac_f32 v41, v26, v13
    v_lshlrev_b32 v12, 16, v105
    v_and_b32 v13, 0xffff0000, v105
    v_fmac_f32 v42, v26, v12
    v_fmac_f32 v43, v26, v13
    v_lshlrev_b32 v12, 16, v106
    v_and_b32 v13, 0xffff0000, v106
    v_fmac_f32 v44, v26, v12
    v_fmac_f32 v45, v26, v13
    v_lshlrev_b32 v12, 16, v107
    v_and_b32 v13, 0xffff0000, v107
    v_fmac_f32 v46, v26, v12
    v_fmac_f32 v47, v26, v13
    s_waitcnt vmcnt(0)
    v_lshlrev_b32 v12, 16, v108
    v_and_b32 v13, 0xffff0000, v108
    v_fmac_f32 v40, v27, v12
    v_fmac_f32 v41, v27, v13
    v_lshlrev_b32 v12, 16, v109
    v_and_b32 v13, 0xffff0000, v109
    v_fmac_f32 v42, v27, v12
    v_fmac_f32 v43, v27, v13
    v_lshlrev_b32 v12, 16, v110
    v_and_b32 v13, 0xffff0000, v110
    v_fmac_f32 v44, v27, v12
    v_fmac_f32 v45, v27, v13
    v_lshlrev_b32 v12, 16, v111
    v_and_b32 v13, 0xffff0000, v111
    v_fmac_f32 v46, v27, v12
    v_fmac_f32 v47, v27, v13
    v_lshlrev_b32 v6, 5, v1
    v_add_u32 v6, 114688, v6
    v_cmp_gt_u32 vcc, 432, v63
    s_and_saveexec_b64 s[30:31], vcc
    s_cbranch_execz f_mod_nw
    ds_write_b128 v6, v[40:43]
    ds_write_b128 v6, v[44:47] offset:16
f_mod_nw:
    s_mov_b64 exec, -1
    v_min_u32 v7, 71, v63
    v_lshlrev_b32 v7, 4, v7
    v_add_u32 v6, 114688, v7
    s_waitcnt lgkmcnt(0)
    s_barrier
    s_cmp_gt_u32 s14, 1
    s_cbranch_scc1 f_mod_st
    ds_read_b128 v[64:67], v6 offset:0
    ds_read_b128 v[68:71], v6 offset:1152
    ds_read_b128 v[72:75], v6 offset:2304
    ds_read_b128 v[76:79], v6 offset:3456
    ds_read_b128 v[80:83], v6 offset:4608
    ds_read_b128 v[84:87], v6 offset:5760
    ds_read_b128 v[88:91], v6 offset:6912
    ds_read_b128 v[92:95], v6 offset:8064
    ds_read_b128 v[96:99], v6 offset:9216
    ds_read_b128 v[100:103], v6 offset:10368
    ds_read_b128 v[104:107], v6 offset:11520
    ds_read_b128 v[108:111], v6 offset:12672
    s_waitcnt lgkmcnt(0)
    v_pk_add_f32 v[64:65], v[64:65], v[72:73]
    v_pk_add_f32 v[66:67], v[66:67], v[74:75]
    v_pk_add_f32 v[68:69], v[68:69], v[76:77]
    v_pk_add_f32 v[70:71], v[70:71], v[78:79]
    v_pk_add_f32 v[64:65], v[64:65], v[80:81]
    v_pk_add_f32 v[66:67], v[66:67], v[82:83]
    v_pk_add_f32 v[68:69], v[68:69], v[84:85]
    v_pk_add_f32 v[70:71], v[70:71], v[86:87]
    v_pk_add_f32 v[64:65], v[64:65], v[88:89]
    v_pk_add_f32 v[66:67], v[66:67], v[90:91]
    v_pk_add_f32 v[68:69], v[68:69], v[92:93]
    v_pk_add_f32 v[70:71], v[70:71], v[94:95]
    v_pk_add_f32 v[64:65], v[64:65], v[96:97]
    v_pk_add_f32 v[66:67], v[66:67], v[98:99]
    v_pk_add_f32 v[68:69], v[68:69], v[100:101]
    v_pk_add_f32 v[70:71], v[70:71], v[102:103]
    v_pk_add_f32 v[64:65], v[64:65], v[104:105]
    v_pk_add_f32 v[66:67], v[66:67], v[106:107]
    v_pk_add_f32 v[68:69], v[68:69], v[108:109]
    v_pk_add_f32 v[70:71], v[70:71], v[110:111]
    v_pk_add_f32 v[64:65], v[64:65], v[68:69]
    v_pk_add_f32 v[66:67], v[66:67], v[70:71]
    s_mul_i32 s16, s29, 13824
    s_mul_i32 s17, s28, 1152
    s_add_u32 s16, s16, s17
    s_add_u32 s16, s16, 0
    buffer_store_dwordx4 v[64:67], v7, s[8:11], s16 offen sc1
    s_waitcnt vmcnt(0)
f_mod_st:
    s_barrier
    s_cmp_ge_u32 s14, 4
    s_cbranch_scc1 f_pref
    s_cmp_lg_u32 s14, 0
    s_cbranch_scc1 f_pub_done
    s_cmp_ge_u32 s28, 6
    s_cbranch_scc1 f_mod_b
    v_mov_b32 v60, 0
    v_mov_b32 v61, 1
    s_mov_b64 exec, 1
    buffer_atomic_add v61, v60, s[52:55], 0 offen offset:64 sc0 sc1
    s_waitcnt vmcnt(0)
    s_mov_b64 exec, -1
    v_readfirstlane_b32 s35, v61
    s_cmp_lg_u32 s35, 23
    s_cbranch_scc1 arr_pm0
    v_mov_b32 v61, 1
    s_mov_b32 s35, 53510144
    v_add_u32 v60, 0, v0
    v_lshlrev_b32 v60, 7, v60
    buffer_atomic_add v61, v60, s[8:11], s35 offen sc1
    v_add_u32 v60, 64, v0
    v_lshlrev_b32 v60, 7, v60
    buffer_atomic_add v61, v60, s[8:11], s35 offen sc1
    v_add_u32 v60, 128, v0
    v_lshlrev_b32 v60, 7, v60
    s_mov_b64 exec, 0xffff
    buffer_atomic_add v61, v60, s[8:11], s35 offen sc1
    s_mov_b64 exec, -1
arr_pm0:
    s_branch f_pub_done
f_mod_b:
    v_mov_b32 v60, 0
    v_mov_b32 v61, 1
    s_mov_b64 exec, 1
    buffer_atomic_add v61, v60, s[52:55], 0 offen offset:128 sc0 sc1
    s_waitcnt vmcnt(0)
    s_mov_b64 exec, -1
    v_readfirstlane_b32 s35, v61
    s_cmp_lg_u32 s35, 23
    s_cbranch_scc1 arr_pm1
    v_mov_b32 v61, 1
    s_mov_b32 s35, 53477376
    v_add_u32 v60, 0, v0
    v_lshlrev_b32 v60, 7, v60
    buffer_atomic_add v61, v60, s[8:11], s35 offen sc1
    v_add_u32 v60, 64, v0
    v_lshlrev_b32 v60, 7, v60
    s_mov_b32 exec_hi, 0xffff
    buffer_atomic_add v61, v60, s[8:11], s35 offen sc1
    s_mov_b64 exec, -1
arr_pm1:
    s_branch f_pub_done
f_publish:
    s_waitcnt vmcnt(0)
    s_waitcnt lgkmcnt(0)
    s_mov_b64 exec, 1
    ds_add_u32 v59, v58
    s_mov_b64 exec, -1
gb_1:
    ds_read_b32 v60, v59 offset:0
    s_waitcnt lgkmcnt(0)
    v_readfirstlane_b32 s35, v60
    s_cmp_lt_u32 s35, 12
    s_cbranch_scc1 gb_1
    s_cmp_lg_u32 s14, 0
    s_cbranch_scc1 f_pub_done
    v_mov_b32 v60, 0
    v_mov_b32 v61, 1
    s_mov_b64 exec, 1
    buffer_atomic_add v61, v60, s[52:55], 0 offen offset:0 sc0 sc1
    s_waitcnt vmcnt(0)
    s_mov_b64 exec, -1
    v_readfirstlane_b32 s35, v61
    s_cmp_lg_u32 s35, 63
    s_cbranch_scc1 arr_pa
    v_mov_b32 v61, 1
    s_mov_b32 s35, 53444608
    v_add_u32 v60, 0, v0
    v_lshlrev_b32 v60, 7, v60
    buffer_atomic_add v61, v60, s[8:11], s35 offen sc1
    v_add_u32 v60, 64, v0
    v_lshlrev_b32 v60, 7, v60
    buffer_atomic_add v61, v60, s[8:11], s35 offen sc1
    v_add_u32 v60, 128, v0
    v_lshlrev_b32 v60, 7, v60
    s_mov_b64 exec, 0xffff
    buffer_atomic_add v61, v60, s[8:11], s35 offen sc1
    s_mov_b64 exec, -1
arr_pa:
f_pub_done:
    s_branch f_phase2
f_pref:
    s_cmp_ge_u32 s2, 72
    s_cbranch_scc1 f_phase2
    s_load_dwordx2 s[4:5], s[0:1], 64
    s_load_dwordx2 s[6:7], s[0:1], 72
    s_cmp_lg_u32 s14, 4
    s_cbranch_scc1 f_pref_go
    s_lshl_b32 s34, s2, 7
    s_add_u32 s34, s34, 53477376
    v_mov_b32 v60, 0
    buffer_load_dword v61, v60, s[8:11], s34 offen sc1
    s_waitcnt vmcnt(0)
    v_readfirstlane_b32 s31, v61
    buffer_load_dword v61, v60, s[52:55], 0 offen offset:128 sc1
    s_waitcnt vmcnt(0)
    v_readfirstlane_b32 s32, v61
f_pref_go:
    s_cmp_ge_u32 s2, 64
    s_cbranch_scc1 f_pref_nd
gb_2:
    s_sleep 1
    ds_read_b32 v60, v59 offset:0
    s_waitcnt lgkmcnt(0)
    v_readfirstlane_b32 s35, v60
    s_cmp_lt_u32 s35, 12
    s_cbranch_scc1 gb_2
f_pref_nd:
    s_waitcnt lgkmcnt(0)
    s_mov_b32 s44, s4
    s_mov_b32 s45, s5
    s_mov_b32 s46, 5308416
    s_mov_b32 s47, 0x00020000
    v_lshrrev_b32 v57, 3, v0
    v_mul_u32_u24 v57, 9216, v57
    v_and_b32 v58, 7, v0
    v_lshl_add_u32 v57, v58, 4, v57
    s_sub_u32 s37, s14, 4
    s_mul_i32 s42, s37, 18432
    s_lshl_b32 s43, s2, 7
    s_mul_i32 s33, s37, 1327104
    s_add_u32 s43, s43, s33
    s_add_u32 m0, s42, 0
    s_add_u32 s33, s43, 0
    buffer_load_dwordx4 v57, s[44:47], s33 offen lds
    s_add_u32 m0, s42, 1024
    s_add_u32 s33, s43, 73728
    buffer_load_dwordx4 v57, s[44:47], s33 offen lds
    s_add_u32 m0, s42, 2048
    s_add_u32 s33, s43, 147456
    buffer_load_dwordx4 v57, s[44:47], s33 offen lds
    s_add_u32 m0, s42, 3072
    s_add_u32 s33, s43, 221184
    buffer_load_dwordx4 v57, s[44:47], s33 offen lds
    s_add_u32 m0, s42, 4096
    s_add_u32 s33, s43, 294912
    buffer_load_dwordx4 v57, s[44:47], s33 offen lds
    s_add_u32 m0, s42, 5120
    s_add_u32 s33, s43, 368640
    buffer_load_dwordx4 v57, s[44:47], s33 offen lds
    s_add_u32 m0, s42, 6144
    s_add_u32 s33, s43, 442368
    buffer_load_dwordx4 v57, s[44:47], s33 offen lds
    s_add_u32 m0, s42, 7168
    s_add_u32 s33, s43, 516096
    buffer_load_dwordx4 v57, s[44:47], s33 offen lds
    s_add_u32 m0, s42, 8192
    s_add_u32 s33, s43, 589824
    buffer_load_dwordx4 v57, s[44:47], s33 offen lds
    s_add_u32 m0, s42, 9216
    s_add_u32 s33, s43, 663552
    buffer_load_dwordx4 v57, s[44:47], s33 offen lds
    s_add_u32 m0, s42, 10240
    s_add_u32 s33, s43, 737280
    buffer_load_dwordx4 v57, s[44:47], s33 offen lds
    s_add_u32 m0, s42, 11264
    s_add_u32 s33, s43, 811008
    buffer_load_dwordx4 v57, s[44:47], s33 offen lds
    s_add_u32 m0, s42, 12288
    s_add_u32 s33, s43, 884736
    buffer_load_dwordx4 v57, s[44:47], s33 offen lds
    s_add_u32 m0, s42, 13312
    s_add_u32 s33, s43, 958464
    buffer_load_dwordx4 v57, s[44:47], s33 offen lds
    s_add_u32 m0, s42, 14336
    s_add_u32 s33, s43, 1032192
    buffer_load_dwordx4 v57, s[44:47], s33 offen lds
    s_add_u32 m0, s42, 15360
    s_add_u32 s33, s43, 1105920
    buffer_load_dwordx4 v57, s[44:47], s33 offen lds
    s_add_u32 m0, s42, 16384
    s_add_u32 s33, s43, 1179648
    buffer_load_dwordx4 v57, s[44:47], s33 offen lds
    s_add_u32 m0, s42, 17408
    s_add_u32 s33, s43, 1253376
    buffer_load_dwordx4 v57, s[44:47], s33 offen lds
    s_cmp_ge_u32 s2, 64
    s_cbranch_scc1 pf_nox
    s_mov_b32 s48, s6
    s_mov_b32 s49, s7
    s_mov_b32 s50, 5308416
    s_mov_b32 s51, 0x00020000
    v_lshlrev_b32 v56, 4, v0
    s_mul_i32 s42, s37, 9216
    s_add_u32 s43, s2, 80
    s_mul_i32 s43, s43, 36864
    s_add_u32 s43, s43, s42
    s_add_u32 s42, s42, 73728
    s_add_u32 m0, s42, 0
    s_add_u32 s33, s43, 0
    buffer_load_dwordx4 v56, s[48:51], s33 offen lds
    s_add_u32 m0, s42, 1024
    s_add_u32 s33, s43, 1024
    buffer_load_dwordx4 v56, s[48:51], s33 offen lds
    s_add_u32 m0, s42, 2048
    s_add_u32 s33, s43, 2048
    buffer_load_dwordx4 v56, s[48:51], s33 offen lds
    s_add_u32 m0, s42, 3072
    s_add_u32 s33, s43, 3072
    buffer_load_dwordx4 v56, s[48:51], s33 offen lds
    s_add_u32 m0, s42, 4096
    s_add_u32 s33, s43, 4096
    buffer_load_dwordx4 v56, s[48:51], s33 offen lds
    s_add_u32 m0, s42, 5120
    s_add_u32 s33, s43, 5120
    buffer_load_dwordx4 v56, s[48:51], s33 offen lds
    s_add_u32 m0, s42, 6144
    s_add_u32 s33, s43, 6144
    buffer_load_dwordx4 v56, s[48:51], s33 offen lds
    s_add_u32 m0, s42, 7168
    s_add_u32 s33, s43, 7168
    buffer_load_dwordx4 v56, s[48:51], s33 offen lds
    s_add_u32 m0, s42, 8192
    s_add_u32 s33, s43, 8192
    buffer_load_dwordx4 v56, s[48:51], s33 offen lds
pf_nox:
    s_waitcnt vmcnt(0)
    s_cmp_lg_u32 s14, 4
    s_cbranch_scc1 f_phase2
    v_mov_b32 v60, 0
    s_mov_b32 s36, 0
    s_cmp_ge_u32 s32, 24
    s_cbranch_scc1 polled_w1
poll_w1:
    buffer_load_dword v61, v60, s[8:11], s34 offen sc1
    s_waitcnt vmcnt(0)
    v_readfirstlane_b32 s35, v61
    s_cmp_lg_u32 s35, s31
    s_cbranch_scc1 polled_w1
    s_sleep 1
    s_add_u32 s36, s36, 1
    s_cmp_lt_u32 s36, 0x100000
    s_cbranch_scc1 poll_w1
polled_w1:
f_phase2:
    s_barrier
    s_mov_b32 s41, s14
    s_cmp_lt_u32 s2, 72
    s_cbranch_scc1 f_w1
    s_load_dwordx2 s[6:7], s[0:1], 72
    s_sub_u32 s38, s2, 72
    s_mul_i32 s43, s38, 73728
    s_lshl_b32 s38, s38, 1
    s_mul_i32 s42, s14, 9216
    s_add_u32 s43, s43, s42
    v_lshlrev_b32 v2, 4, v0
    s_mov_b32 s39, 8
    s_mov_b32 s40, 0
    s_waitcnt lgkmcnt(0)
    s_mov_b32 s48, s6
    s_mov_b32 s49, s7
    s_mov_b32 s50, 5308416
    s_mov_b32 s51, 0x00020000
    s_add_u32 m0, s42, 0
    s_add_u32 s33, s43, 0
    buffer_load_dwordx4 v2, s[48:51], s33 offen lds
    s_add_u32 m0, s42, 1024
    s_add_u32 s33, s43, 1024
    buffer_load_dwordx4 v2, s[48:51], s33 offen lds
    s_add_u32 m0, s42, 2048
    s_add_u32 s33, s43, 2048
    buffer_load_dwordx4 v2, s[48:51], s33 offen lds
    s_add_u32 m0, s42, 3072
    s_add_u32 s33, s43, 3072
    buffer_load_dwordx4 v2, s[48:51], s33 offen lds
    s_add_u32 m0, s42, 4096
    s_add_u32 s33, s43, 4096
    buffer_load_dwordx4 v2, s[48:51], s33 offen lds
    s_add_u32 m0, s42, 5120
    s_add_u32 s33, s43, 5120
    buffer_load_dwordx4 v2, s[48:51], s33 offen lds
    s_add_u32 m0, s42, 6144
    s_add_u32 s33, s43, 6144
    buffer_load_dwordx4 v2, s[48:51], s33 offen lds
    s_add_u32 m0, s42, 7168
    s_add_u32 s33, s43, 7168
    buffer_load_dwordx4 v2, s[48:51], s33 offen lds
    s_add_u32 m0, s42, 8192
    s_add_u32 s33, s43, 8192
    buffer_load_dwordx4 v2, s[48:51], s33 offen lds
    s_waitcnt vmcnt(0)
    s_barrier
f_w2_start:
    v_lshlrev_b32 v2, 4, v0
    v_lshrrev_b32 v1, 2, v0
    v_mul_u32_u24 v1, 1152, v1
    v_and_b32 v3, 3, v0
    v_lshl_add_u32 v1, v3, 3, v1
    v_add_u32 v1, s40, v1
f_w2_loop:
    s_lshr_b32 s42, s41, 2
    s_and_b32 s43, s41, 3
    s_mul_i32 s16, s43, 288
    s_mul_i32 s17, s42, 36864
    s_add_u32 s16, s16, s17
    v_add_u32 v3, s16, v1
    s_mul_i32 s16, s43, 144
    s_add_u32 s16, s16, s38
    s_add_u32 s16, s16, s42
    s_mul_i32 s16, s16, 9216
    s_add_u32 s16, s16, 29130752
    ds_read_b64_tr_b16 v[16:17], v3 offset:0
    ds_read_b64_tr_b16 v[18:19], v3 offset:18432
    ds_read_b64_tr_b16 v[20:21], v3 offset:32
    ds_read_b64_tr_b16 v[22:23], v3 offset:18464
    ds_read_b64_tr_b16 v[24:25], v3 offset:64
    ds_read_b64_tr_b16 v[26:27], v3 offset:18496
    ds_read_b64_tr_b16 v[28:29], v3 offset:96
    ds_read_b64_tr_b16 v[30:31], v3 offset:18528
    ds_read_b64_tr_b16 v[32:33], v3 offset:128
    ds_read_b64_tr_b16 v[34:35], v3 offset:18560
    ds_read_b64_tr_b16 v[36:37], v3 offset:160
    ds_read_b64_tr_b16 v[38:39], v3 offset:18592
    ds_read_b64_tr_b16 v[40:41], v3 offset:192
    ds_read_b64_tr_b16 v[42:43], v3 offset:18624
    ds_read_b64_tr_b16 v[44:45], v3 offset:224
    ds_read_b64_tr_b16 v[46:47], v3 offset:18656
    ds_read_b64_tr_b16 v[48:49], v3 offset:256
    ds_read_b64_tr_b16 v[50:51], v3 offset:18688
    s_waitcnt lgkmcnt(15)
    buffer_store_dwordx4 v[16:19], v2, s[8:11], s16 offen offset:0 sc1
    s_waitcnt lgkmcnt(14)
    buffer_store_dwordx4 v[20:23], v2, s[8:11], s16 offen offset:1024 sc1
    s_waitcnt lgkmcnt(12)
    buffer_store_dwordx4 v[24:27], v2, s[8:11], s16 offen offset:2048 sc1
    s_waitcnt lgkmcnt(10)
    buffer_store_dwordx4 v[28:31], v2, s[8:11], s16 offen offset:3072 sc1
    s_add_u32 s16, s16, 4096
    s_waitcnt lgkmcnt(8)
    buffer_store_dwordx4 v[32:35], v2, s[8:11], s16 offen offset:0 sc1
    s_waitcnt lgkmcnt(6)
    buffer_store_dwordx4 v[36:39], v2, s[8:11], s16 offen offset:1024 sc1
    s_waitcnt lgkmcnt(4)
    buffer_store_dwordx4 v[40:43], v2, s[8:11], s16 offen offset:2048 sc1
    s_waitcnt lgkmcnt(2)
    buffer_store_dwordx4 v[44:47], v2, s[8:11], s16 offen offset:3072 sc1
    s_add_u32 s16, s16, 4096
    s_waitcnt lgkmcnt(0)
    buffer_store_dwordx4 v[48:51], v2, s[8:11], s16 offen offset:0 sc1
    s_add_u32 s41, s41, 8
    s_cmp_lt_u32 s41, s39
    s_cbranch_scc1 f_w2_loop
    s_branch f_aux_end
f_w1:
    v_min_u32 v1, 431, v63
    v_lshlrev_b32 v1, 4, v1
    s_mov_b32 s16, 6912
    buffer_load_dwordx4 v[4:7], v1, s[8:11], s16 offen sc1
    s_add_u32 s16, s16, 13824
    buffer_load_dwordx4 v[8:11], v1, s[8:11], s16 offen sc1
    s_add_u32 s16, s16, 13824
    buffer_load_dwordx4 v[12:15], v1, s[8:11], s16 offen sc1
    s_add_u32 s16, s16, 13824
    buffer_load_dwordx4 v[16:19], v1, s[8:11], s16 offen sc1
    s_add_u32 s16, s16, 13824
    v_cmp_le_u32 vcc, 144, v63
    s_mov_b32 s16, 64256
    s_waitcnt vmcnt(0)
    v_pk_add_f32 v[4:5], v[4:5], v[8:9]
    v_pk_add_f32 v[12:13], v[12:13], v[16:17]
    v_pk_add_f32 v[4:5], v[4:5], v[12:13]
    v_pk_add_f32 v[6:7], v[6:7], v[10:11]
    v_pk_add_f32 v[14:15], v[14:15], v[18:19]
    v_pk_add_f32 v[6:7], v[6:7], v[14:15]
    v_cvt_pk_bf16_f32 v4, v4, v4
    v_lshlrev_b32 v4, 16, v4
    v_cvt_pk_bf16_f32 v5, v5, v5
    v_lshlrev_b32 v5, 16, v5
    v_cvt_pk_bf16_f32 v6, v6, v6
    v_lshlrev_b32 v6, 16, v6
    v_cvt_pk_bf16_f32 v7, v7, v7
    v_lshlrev_b32 v7, 16, v7
    s_cmp_lg_u32 s2, 0
    s_cbranch_scc1 f_w1_nomod
    buffer_store_dwordx4 v[4:7], v1, s[8:11], s16 offen
    s_nop 1
f_w1_nomod:
    v_add_f32 v12, 1.0, v4
    v_cvt_pk_bf16_f32 v12, v12, v12
    v_lshlrev_b32 v12, 16, v12
    v_cndmask_b32 v4, v4, v12, vcc
    v_add_f32 v12, 1.0, v5
    v_cvt_pk_bf16_f32 v12, v12, v12
    v_lshlrev_b32 v12, 16, v12
    v_cndmask_b32 v5, v5, v12, vcc
    v_add_f32 v12, 1.0, v6
    v_cvt_pk_bf16_f32 v12, v12, v12
    v_lshlrev_b32 v12, 16, v12
    v_cndmask_b32 v6, v6, v12, vcc
    v_add_f32 v12, 1.0, v7
    v_cvt_pk_bf16_f32 v12, v12, v12
    v_lshlrev_b32 v12, 16, v12
    v_cndmask_b32 v7, v7, v12, vcc
    v_add_u32 v1, 110592, v1
    ds_write_b128 v1, v[4:7]
    v_lshrrev_b32 v1, 4, v0
    v_bfe_u32 v2, v0, 2, 2
    v_lshl_add_u32 v2, v1, 3, v2
    v_lshlrev_b32 v2, 7, v2
    v_and_b32 v3, 3, v0
    v_lshl_add_u32 v2, v3, 3, v2
    v_lshlrev_b32 v3, 5, v1
    v_add_u32 v3, 110592, v3
    v_lshlrev_b32 v4, 4, v0
    v_lshlrev_b32 v10, 3, v0
    v_add_u32 v10, 118784, v10
    s_mov_b32 s19, 0x3f803f80
    s_waitcnt lgkmcnt(0)
    s_barrier
f_w1_loop:
    s_lshr_b32 s16, s41, 1
    s_mul_i32 s16, s16, 18432
    s_and_b32 s43, s41, 1
    s_bfe_u32 s42, s41, 0x10001
    s_lshr_b32 s40, s41, 2
    s_mul_i32 s17, s42, 36864
    s_lshl_b32 s40, s40, 6
    s_add_u32 s17, s17, s40
    s_lshl_b32 s40, s43, 5
    s_add_u32 s17, s17, s40
    v_add_u32 v5, s17, v2
    s_mul_i32 s17, s42, 1152
    v_add_u32 v11, s17, v3
    s_mul_i32 s17, s38, 36864
    s_add_u32 s17, s17, s16
    s_lshl_b32 s43, s43, 10
    s_add_u32 s17, s17, s43
    s_add_u32 s17, s17, 4800512
    v_mov_b32 v6, 0
    v_mov_b32 v8, 0
    v_mov_b32 v9, 0
    ds_read_b64_tr_b16 v[64:65], v5 offset:0
    ds_read_b64_tr_b16 v[66:67], v5 offset:512
    ds_read_b128 v[68:71], v11 offset:0
    ds_read_b128 v[72:75], v11 offset:16
    ds_read_b128 v[76:79], v11 offset:2304
    ds_read_b128 v[80:83], v11 offset:2320
    ds_read_b64_tr_b16 v[84:85], v5 offset:4096
    ds_read_b64_tr_b16 v[86:87], v5 offset:4608
    ds_read_b128 v[88:91], v11 offset:128
    ds_read_b128 v[92:95], v11 offset:144
    ds_read_b128 v[96:99], v11 offset:2432
    ds_read_b128 v[100:103], v11 offset:2448
    ds_read_b64_tr_b16 v[104:105], v5 offset:8192
    ds_read_b64_tr_b16 v[106:107], v5 offset:8704
    ds_read_b128 v[108:111], v11 offset:256
    ds_read_b128 v[112:115], v11 offset:272
    ds_read_b128 v[116:119], v11 offset:2560
    ds_read_b128 v[120:123], v11 offset:2576
    s_waitcnt lgkmcnt(12)
    v_lshlrev_b32 v32, 16, v64
    v_and_b32 v33, 0xffff0000, v64
    v_pk_fma_f32 v[8:9], v[32:33], v[68:69], v[8:9]
    v_pk_mul_f32 v[32:33], v[32:33], v[76:77]
    v_cvt_pk_bf16_f32 v40, v32, v33
    v_dot2_f32_bf16 v6, v40, s19, v6
    v_lshlrev_b32 v34, 16, v65
    v_and_b32 v35, 0xffff0000, v65
    v_pk_fma_f32 v[8:9], v[34:35], v[70:71], v[8:9]
    v_pk_mul_f32 v[34:35], v[34:35], v[78:79]
    v_cvt_pk_bf16_f32 v41, v34, v35
    v_dot2_f32_bf16 v6, v41, s19, v6
    v_lshlrev_b32 v32, 16, v66
    v_and_b32 v33, 0xffff0000, v66
    v_pk_fma_f32 v[8:9], v[32:33], v[72:73], v[8:9]
    v_pk_mul_f32 v[32:33], v[32:33], v[80:81]
    v_cvt_pk_bf16_f32 v42, v32, v33
    v_dot2_f32_bf16 v6, v42, s19, v6
    v_lshlrev_b32 v34, 16, v67
    v_and_b32 v35, 0xffff0000, v67
    v_pk_fma_f32 v[8:9], v[34:35], v[74:75], v[8:9]
    v_pk_mul_f32 v[34:35], v[34:35], v[82:83]
    v_cvt_pk_bf16_f32 v43, v34, v35
    v_dot2_f32_bf16 v6, v43, s19, v6
    buffer_store_dwordx4 v[40:43], v4, s[8:11], s17 offen offset:0 sc1
    ds_read_b64_tr_b16 v[64:65], v5 offset:12288
    ds_read_b64_tr_b16 v[66:67], v5 offset:12800
    ds_read_b128 v[68:71], v11 offset:384
    ds_read_b128 v[72:75], v11 offset:400
    ds_read_b128 v[76:79], v11 offset:2688
    ds_read_b128 v[80:83], v11 offset:2704
    s_waitcnt lgkmcnt(12)
    v_lshlrev_b32 v32, 16, v84
    v_and_b32 v33, 0xffff0000, v84
    v_pk_fma_f32 v[8:9], v[32:33], v[88:89], v[8:9]
    v_pk_mul_f32 v[32:33], v[32:33], v[96:97]
    v_cvt_pk_bf16_f32 v44, v32, v33
    v_dot2_f32_bf16 v6, v44, s19, v6
    v_lshlrev_b32 v34, 16, v85
    v_and_b32 v35, 0xffff0000, v85
    v_pk_fma_f32 v[8:9], v[34:35], v[90:91], v[8:9]
    v_pk_mul_f32 v[34:35], v[34:35], v[98:99]
    v_cvt_pk_bf16_f32 v45, v34, v35
    v_dot2_f32_bf16 v6, v45, s19, v6
    v_lshlrev_b32 v32, 16, v86
    v_and_b32 v33, 0xffff0000, v86
    v_pk_fma_f32 v[8:9], v[32:33], v[92:93], v[8:9]
    v_pk_mul_f32 v[32:33], v[32:33], v[100:101]
    v_cvt_pk_bf16_f32 v46, v32, v33
    v_dot2_f32_bf16 v6, v46, s19, v6
    v_lshlrev_b32 v34, 16, v87
    v_and_b32 v35, 0xffff0000, v87
    v_pk_fma_f32 v[8:9], v[34:35], v[94:95], v[8:9]
    v_pk_mul_f32 v[34:35], v[34:35], v[102:103]
    v_cvt_pk_bf16_f32 v47, v34, v35
    v_dot2_f32_bf16 v6, v47, s19, v6
    buffer_store_dwordx4 v[44:47], v4, s[8:11], s17 offen offset:2048 sc1
    ds_read_b64_tr_b16 v[84:85], v5 offset:16384
    ds_read_b64_tr_b16 v[86:87], v5 offset:16896
    ds_read_b128 v[88:91], v11 offset:512
    ds_read_b128 v[92:95], v11 offset:528
    ds_read_b128 v[96:99], v11 offset:2816
    ds_read_b128 v[100:103], v11 offset:2832
    s_waitcnt lgkmcnt(12)
    v_lshlrev_b32 v32, 16, v104
    v_and_b32 v33, 0xffff0000, v104
    v_pk_fma_f32 v[8:9], v[32:33], v[108:109], v[8:9]
    v_pk_mul_f32 v[32:33], v[32:33], v[116:117]
    v_cvt_pk_bf16_f32 v40, v32, v33
    v_dot2_f32_bf16 v6, v40, s19, v6
    v_lshlrev_b32 v34, 16, v105
    v_and_b32 v35, 0xffff0000, v105
    v_pk_fma_f32 v[8:9], v[34:35], v[110:111], v[8:9]
    v_pk_mul_f32 v[34:35], v[34:35], v[118:119]
    v_cvt_pk_bf16_f32 v41, v34, v35
    v_dot2_f32_bf16 v6, v41, s19, v6
    v_lshlrev_b32 v32, 16, v106
    v_and_b32 v33, 0xffff0000, v106
    v_pk_fma_f32 v[8:9], v[32:33], v[112:113], v[8:9]
    v_pk_mul_f32 v[32:33], v[32:33], v[120:121]
    v_cvt_pk_bf16_f32 v42, v32, v33
    v_dot2_f32_bf16 v6, v42, s19, v6
    v_lshlrev_b32 v34, 16, v107
    v_and_b32 v35, 0xffff0000, v107
    v_pk_fma_f32 v[8:9], v[34:35], v[114:115], v[8:9]
    v_pk_mul_f32 v[34:35], v[34:35], v[122:123]
    v_cvt_pk_bf16_f32 v43, v34, v35
    v_dot2_f32_bf16 v6, v43, s19, v6
    s_add_u32 s17, s17, 4096
    buffer_store_dwordx4 v[40:43], v4, s[8:11], s17 offen offset:0 sc1
    ds_read_b64_tr_b16 v[104:105], v5 offset:20480
    ds_read_b64_tr_b16 v[106:107], v5 offset:20992
    ds_read_b128 v[108:111], v11 offset:640
    ds_read_b128 v[112:115], v11 offset:656
    ds_read_b128 v[116:119], v11 offset:2944
    ds_read_b128 v[120:123], v11 offset:2960
    s_waitcnt lgkmcnt(12)
    v_lshlrev_b32 v32, 16, v64
    v_and_b32 v33, 0xffff0000, v64
    v_pk_fma_f32 v[8:9], v[32:33], v[68:69], v[8:9]
    v_pk_mul_f32 v[32:33], v[32:33], v[76:77]
    v_cvt_pk_bf16_f32 v44, v32, v33
    v_dot2_f32_bf16 v6, v44, s19, v6
    v_lshlrev_b32 v34, 16, v65
    v_and_b32 v35, 0xffff0000, v65
    v_pk_fma_f32 v[8:9], v[34:35], v[70:71], v[8:9]
    v_pk_mul_f32 v[34:35], v[34:35], v[78:79]
    v_cvt_pk_bf16_f32 v45, v34, v35
    v_dot2_f32_bf16 v6, v45, s19, v6
    v_lshlrev_b32 v32, 16, v66
    v_and_b32 v33, 0xffff0000, v66
    v_pk_fma_f32 v[8:9], v[32:33], v[72:73], v[8:9]
    v_pk_mul_f32 v[32:33], v[32:33], v[80:81]
    v_cvt_pk_bf16_f32 v46, v32, v33
    v_dot2_f32_bf16 v6, v46, s19, v6
    v_lshlrev_b32 v34, 16, v67
    v_and_b32 v35, 0xffff0000, v67
    v_pk_fma_f32 v[8:9], v[34:35], v[74:75], v[8:9]
    v_pk_mul_f32 v[34:35], v[34:35], v[82:83]
    v_cvt_pk_bf16_f32 v47, v34, v35
    v_dot2_f32_bf16 v6, v47, s19, v6
    buffer_store_dwordx4 v[44:47], v4, s[8:11], s17 offen offset:2048 sc1
    ds_read_b64_tr_b16 v[64:65], v5 offset:24576
    ds_read_b64_tr_b16 v[66:67], v5 offset:25088
    ds_read_b128 v[68:71], v11 offset:768
    ds_read_b128 v[72:75], v11 offset:784
    ds_read_b128 v[76:79], v11 offset:3072
    ds_read_b128 v[80:83], v11 offset:3088
    s_waitcnt lgkmcnt(12)
    v_lshlrev_b32 v32, 16, v84
    v_and_b32 v33, 0xffff0000, v84
    v_pk_fma_f32 v[8:9], v[32:33], v[88:89], v[8:9]
    v_pk_mul_f32 v[32:33], v[32:33], v[96:97]
    v_cvt_pk_bf16_f32 v40, v32, v33
    v_dot2_f32_bf16 v6, v40, s19, v6
    v_lshlrev_b32 v34, 16, v85
    v_and_b32 v35, 0xffff0000, v85
    v_pk_fma_f32 v[8:9], v[34:35], v[90:91], v[8:9]
    v_pk_mul_f32 v[34:35], v[34:35], v[98:99]
    v_cvt_pk_bf16_f32 v41, v34, v35
    v_dot2_f32_bf16 v6, v41, s19, v6
    v_lshlrev_b32 v32, 16, v86
    v_and_b32 v33, 0xffff0000, v86
    v_pk_fma_f32 v[8:9], v[32:33], v[92:93], v[8:9]
    v_pk_mul_f32 v[32:33], v[32:33], v[100:101]
    v_cvt_pk_bf16_f32 v42, v32, v33
    v_dot2_f32_bf16 v6, v42, s19, v6
    v_lshlrev_b32 v34, 16, v87
    v_and_b32 v35, 0xffff0000, v87
    v_pk_fma_f32 v[8:9], v[34:35], v[94:95], v[8:9]
    v_pk_mul_f32 v[34:35], v[34:35], v[102:103]
    v_cvt_pk_bf16_f32 v43, v34, v35
    v_dot2_f32_bf16 v6, v43, s19, v6
    s_add_u32 s17, s17, 4096
    buffer_store_dwordx4 v[40:43], v4, s[8:11], s17 offen offset:0 sc1
    ds_read_b64_tr_b16 v[84:85], v5 offset:28672
    ds_read_b64_tr_b16 v[86:87], v5 offset:29184
    ds_read_b128 v[88:91], v11 offset:896
    ds_read_b128 v[92:95], v11 offset:912
    ds_read_b128 v[96:99], v11 offset:3200
    ds_read_b128 v[100:103], v11 offset:3216
    s_waitcnt lgkmcnt(12)
    v_lshlrev_b32 v32, 16, v104
    v_and_b32 v33, 0xffff0000, v104
    v_pk_fma_f32 v[8:9], v[32:33], v[108:109], v[8:9]
    v_pk_mul_f32 v[32:33], v[32:33], v[116:117]
    v_cvt_pk_bf16_f32 v44, v32, v33
    v_dot2_f32_bf16 v6, v44, s19, v6
    v_lshlrev_b32 v34, 16, v105
    v_and_b32 v35, 0xffff0000, v105
    v_pk_fma_f32 v[8:9], v[34:35], v[110:111], v[8:9]
    v_pk_mul_f32 v[34:35], v[34:35], v[118:119]
    v_cvt_pk_bf16_f32 v45, v34, v35
    v_dot2_f32_bf16 v6, v45, s19, v6
    v_lshlrev_b32 v32, 16, v106
    v_and_b32 v33, 0xffff0000, v106
    v_pk_fma_f32 v[8:9], v[32:33], v[112:113], v[8:9]
    v_pk_mul_f32 v[32:33], v[32:33], v[120:121]
    v_cvt_pk_bf16_f32 v46, v32, v33
    v_dot2_f32_bf16 v6, v46, s19, v6
    v_lshlrev_b32 v34, 16, v107
    v_and_b32 v35, 0xffff0000, v107
    v_pk_fma_f32 v[8:9], v[34:35], v[114:115], v[8:9]
    v_pk_mul_f32 v[34:35], v[34:35], v[122:123]
    v_cvt_pk_bf16_f32 v47, v34, v35
    v_dot2_f32_bf16 v6, v47, s19, v6
    buffer_store_dwordx4 v[44:47], v4, s[8:11], s17 offen offset:2048 sc1
    ds_read_b64_tr_b16 v[104:105], v5 offset:32768
    ds_read_b64_tr_b16 v[106:107], v5 offset:33280
    ds_read_b128 v[108:111], v11 offset:1024
    ds_read_b128 v[112:115], v11 offset:1040
    ds_read_b128 v[116:119], v11 offset:3328
    ds_read_b128 v[120:123], v11 offset:3344
    s_waitcnt lgkmcnt(12)
    v_lshlrev_b32 v32, 16, v64
    v_and_b32 v33, 0xffff0000, v64
    v_pk_fma_f32 v[8:9], v[32:33], v[68:69], v[8:9]
    v_pk_mul_f32 v[32:33], v[32:33], v[76:77]
    v_cvt_pk_bf16_f32 v40, v32, v33
    v_dot2_f32_bf16 v6, v40, s19, v6
    v_lshlrev_b32 v34, 16, v65
    v_and_b32 v35, 0xffff0000, v65
    v_pk_fma_f32 v[8:9], v[34:35], v[70:71], v[8:9]
    v_pk_mul_f32 v[34:35], v[34:35], v[78:79]
    v_cvt_pk_bf16_f32 v41, v34, v35
    v_dot2_f32_bf16 v6, v41, s19, v6
    v_lshlrev_b32 v32, 16, v66
    v_and_b32 v33, 0xffff0000, v66
    v_pk_fma_f32 v[8:9], v[32:33], v[72:73], v[8:9]
    v_pk_mul_f32 v[32:33], v[32:33], v[80:81]
    v_cvt_pk_bf16_f32 v42, v32, v33
    v_dot2_f32_bf16 v6, v42, s19, v6
    v_lshlrev_b32 v34, 16, v67
    v_and_b32 v35, 0xffff0000, v67
    v_pk_fma_f32 v[8:9], v[34:35], v[74:75], v[8:9]
    v_pk_mul_f32 v[34:35], v[34:35], v[82:83]
    v_cvt_pk_bf16_f32 v43, v34, v35
    v_dot2_f32_bf16 v6, v43, s19, v6
    s_add_u32 s17, s17, 4096
    buffer_store_dwordx4 v[40:43], v4, s[8:11], s17 offen offset:0 sc1
    s_waitcnt lgkmcnt(6)
    v_lshlrev_b32 v32, 16, v84
    v_and_b32 v33, 0xffff0000, v84
    v_pk_fma_f32 v[8:9], v[32:33], v[88:89], v[8:9]
    v_pk_mul_f32 v[32:33], v[32:33], v[96:97]
    v_cvt_pk_bf16_f32 v44, v32, v33
    v_dot2_f32_bf16 v6, v44, s19, v6
    v_lshlrev_b32 v34, 16, v85
    v_and_b32 v35, 0xffff0000, v85
    v_pk_fma_f32 v[8:9], v[34:35], v[90:91], v[8:9]
    v_pk_mul_f32 v[34:35], v[34:35], v[98:99]
    v_cvt_pk_bf16_f32 v45, v34, v35
    v_dot2_f32_bf16 v6, v45, s19, v6
    v_lshlrev_b32 v32, 16, v86
    v_and_b32 v33, 0xffff0000, v86
    v_pk_fma_f32 v[8:9], v[32:33], v[92:93], v[8:9]
    v_pk_mul_f32 v[32:33], v[32:33], v[100:101]
    v_cvt_pk_bf16_f32 v46, v32, v33
    v_dot2_f32_bf16 v6, v46, s19, v6
    v_lshlrev_b32 v34, 16, v87
    v_and_b32 v35, 0xffff0000, v87
    v_pk_fma_f32 v[8:9], v[34:35], v[94:95], v[8:9]
    v_pk_mul_f32 v[34:35], v[34:35], v[102:103]
    v_cvt_pk_bf16_f32 v47, v34, v35
    v_dot2_f32_bf16 v6, v47, s19, v6
    buffer_store_dwordx4 v[44:47], v4, s[8:11], s17 offen offset:2048 sc1
    s_waitcnt lgkmcnt(0)
    v_lshlrev_b32 v32, 16, v104
    v_and_b32 v33, 0xffff0000, v104
    v_pk_fma_f32 v[8:9], v[32:33], v[108:109], v[8:9]
    v_pk_mul_f32 v[32:33], v[32:33], v[116:117]
    v_cvt_pk_bf16_f32 v40, v32, v33
    v_dot2_f32_bf16 v6, v40, s19, v6
    v_lshlrev_b32 v34, 16, v105
    v_and_b32 v35, 0xffff0000, v105
    v_pk_fma_f32 v[8:9], v[34:35], v[110:111], v[8:9]
    v_pk_mul_f32 v[34:35], v[34:35], v[118:119]
    v_cvt_pk_bf16_f32 v41, v34, v35
    v_dot2_f32_bf16 v6, v41, s19, v6
    v_lshlrev_b32 v32, 16, v106
    v_and_b32 v33, 0xffff0000, v106
    v_pk_fma_f32 v[8:9], v[32:33], v[112:113], v[8:9]
    v_pk_mul_f32 v[32:33], v[32:33], v[120:121]
    v_cvt_pk_bf16_f32 v42, v32, v33
    v_dot2_f32_bf16 v6, v42, s19, v6
    v_lshlrev_b32 v34, 16, v107
    v_and_b32 v35, 0xffff0000, v107
    v_pk_fma_f32 v[8:9], v[34:35], v[114:115], v[8:9]
    v_pk_mul_f32 v[34:35], v[34:35], v[122:123]
    v_cvt_pk_bf16_f32 v43, v34, v35
    v_dot2_f32_bf16 v6, v43, s19, v6
    s_add_u32 s17, s17, 4096
    buffer_store_dwordx4 v[40:43], v4, s[8:11], s17 offen offset:0 sc1
    v_add_f32 v7, v8, v9
    s_lshl_b32 s16, s41, 9
    v_add_u32 v12, s16, v10
    s_add_u32 s41, s41, 8
    ds_write_b64 v12, v[6:7]
    s_cmp_lt_u32 s41, s39
    s_cbranch_scc1 f_w1_loop
    s_waitcnt lgkmcnt(0)
    s_barrier
    s_cmp_lt_u32 s14, 2
    s_cbranch_scc1 f_w1_fin
    s_cmp_lt_u32 s14, 4
    s_cbranch_scc1 f_aux_end
    s_cmp_ge_u32 s2, 64
    s_cbranch_scc1 f_aux_end
    s_add_u32 s38, s2, 80
    s_sub_u32 s41, s14, 4
    s_mov_b32 s39, 4
    s_mov_b32 s40, 73728
    s_branch f_w2_start
f_w1_fin:
    v_and_b32 v10, 15, v0
    v_lshlrev_b32 v10, 3, v10
    v_bfe_u32 v12, v0, 4, 1
    v_lshl_add_u32 v10, v12, 9, v10
    s_lshl_b32 s16, s14, 11
    s_add_u32 s16, s16, 118784
    v_add_u32 v10, s16, v10
    ds_read_b64 v[16:17], v10 offset:0
    ds_read_b64 v[18:19], v10 offset:128
    ds_read_b64 v[20:21], v10 offset:256
    ds_read_b64 v[22:23], v10 offset:384
    ds_read_b64 v[24:25], v10 offset:1024
    ds_read_b64 v[26:27], v10 offset:1152
    ds_read_b64 v[28:29], v10 offset:1280
    ds_read_b64 v[30:31], v10 offset:1408
    s_waitcnt lgkmcnt(0)
    v_pk_add_f32 v[16:17], v[16:17], v[18:19]
    v_pk_add_f32 v[16:17], v[16:17], v[20:21]
    v_pk_add_f32 v[16:17], v[16:17], v[22:23]
    v_pk_add_f32 v[16:17], v[16:17], v[24:25]
    v_pk_add_f32 v[16:17], v[16:17], v[26:27]
    v_pk_add_f32 v[16:17], v[16:17], v[28:29]
    v_pk_add_f32 v[16:17], v[16:17], v[30:31]
    v_cvt_pk_bf16_f32 v20, v16, v17
    v_lshlrev_b32 v22, 16, v20
    v_and_b32 v23, 0xffff0000, v20
    v_pk_add_f32 v[16:17], v[16:17], v[22:23] neg_lo:[0,1] neg_hi:[0,1]
    v_cvt_pk_bf16_f32 v21, v16, v17
    v_lshlrev_b32 v22, 16, v21
    v_and_b32 v23, 0xffff0000, v21
    v_pk_add_f32 v[16:17], v[16:17], v[22:23] neg_lo:[0,1] neg_hi:[0,1]
    v_cvt_pk_bf16_f32 v22, v16, v17
    s_mov_b32 s16, 0x05040100
    s_mov_b32 s17, 0x07060100
    s_mov_b32 s19, 0x07060302
    v_perm_b32 v24, v21, v20, s16
    v_perm_b32 v25, v20, v22, s17
    v_perm_b32 v26, v22, v21, s19
    v_mov_b32 v27, 0
    s_add_u32 s16, s38, s14
    s_lshl_b32 s16, s16, 9
    s_add_u32 s16, s16, 10108928
    s_mov_b32 exec_hi, 0
    buffer_store_dwordx4 v[24:27], v4, s[8:11], s16 offen sc1
    s_mov_b32 exec_hi, -1
f_aux_end:
    s_endpgm
f_conv:
    s_cmp_lt_u32 s14, 4
    s_cbranch_scc1 f_conv_go
    s_sub_u32 s12, s2, 112
    s_and_b32 s3, s12, 7
    s_lshr_b32 s12, s12, 3
    s_lshl_b32 s3, s3, 1
    s_and_b32 s13, s12, 1
    s_add_u32 s3, s3, s13
    s_lshr_b32 s12, s12, 1
    s_lshl_b32 s12, s12, 4
    s_add_u32 s12, s12, s3
    s_sub_u32 s13, s14, 4
    s_nop 0
f_h_nw:
    s_cmp_lg_u32 s14, 5
    s_cbranch_scc1 f_h_n5
    s_lshl_b32 s34, s12, 7
    s_add_u32 s34, s34, 53510144
    v_mov_b32 v60, 0
    buffer_load_dword v61, v60, s[8:11], s34 offen sc1
    s_waitcnt vmcnt(0)
    v_readfirstlane_b32 s31, v61
    buffer_load_dword v61, v60, s[52:55], 0 offen offset:64 sc1
    s_waitcnt vmcnt(0)
    v_readfirstlane_b32 s32, v61
    v_mov_b32 v60, s31
    v_mov_b32 v61, s32
    s_mov_b64 exec, 1
    ds_write_b64 v59, v[60:61] offset:8
    s_waitcnt lgkmcnt(0)
    ds_write_b32 v59, v58 offset:16
    s_mov_b64 exec, -1
f_h_n5:
    s_cmp_lg_u32 s14, 4
    s_cbranch_scc1 f_h_wait
    s_lshl_b32 s34, s12, 7
    s_add_u32 s34, s34, 53444608
    v_mov_b32 v60, 0
    buffer_load_dword v61, v60, s[8:11], s34 offen sc1
    s_waitcnt vmcnt(0)
    v_readfirstlane_b32 s31, v61
    buffer_load_dword v61, v60, s[52:55], 0 offen offset:0 sc1
    s_waitcnt vmcnt(0)
    v_readfirstlane_b32 s32, v61
    v_mov_b32 v60, 0
    s_mov_b32 s36, 0
    s_cmp_ge_u32 s32, 64
    s_cbranch_scc1 polled_c
poll_c:
    buffer_load_dword v61, v60, s[8:11], s34 offen sc1
    s_waitcnt vmcnt(0)
    v_readfirstlane_b32 s35, v61
    s_cmp_lg_u32 s35, s31
    s_cbranch_scc1 polled_c
    s_sleep 1
    s_add_u32 s36, s36, 1
    s_cmp_lt_u32 s36, 0x100000
    s_cbranch_scc1 poll_c
polled_c:
    s_mov_b64 exec, 1
    ds_add_u32 v59, v58
    s_mov_b64 exec, -1
f_h_wait:
    v_lshrrev_b32 v4, 5, v0
    v_and_b32 v3, 31, v0
    v_mul_u32_u24 v7, 36864, v4
    v_lshl_add_u32 v7, v3, 4, v7
    s_mul_i32 s28, s13, 589824
    s_lshr_b32 s29, s12, 1
    s_lshl_b32 s29, s29, 9
    s_add_u32 s28, s28, s29
    s_and_b32 s29, s12, 1
    s_lshl_b32 s29, s29, 3
    s_add_u32 s28, s28, s29
    s_add_u32 s27, s28, 73728
    s_add_u32 s28, s28, 2441216
    v_lshlrev_b32 v2, 2, v0
    s_lshl_b32 s24, s13, 11
    s_add_u32 s24, s24, 2433024
    v_mov_b32 v5, 0
    s_lshl_b32 s25, s12, 4
    s_add_u32 s25, s25, 0
    v_and_b32 v5, 3, v0
    v_mul_u32_u24 v5, 13824, v5
    v_and_b32 v1, 1, v0
    v_mul_u32_u24 v6, 76960, v1
    v_mul_u32_u24 v8, 80, v4
    v_and_b32 v9, 30, v0
    v_lshlrev_b32 v9, 1, v9
    v_add3_u32 v6, v6, v8, v9
    s_mul_i32 s26, s13, 1280
    s_add_u32 s26, s26, 33360
    v_add_u32 v6, s26, v6
    v_cmp_eq_u32 vcc, 1, v1
    v_mov_b32 v16, 0x05040100
    v_mov_b32 v17, 0x01000504
    v_mov_b32 v18, 0x07060302
    v_mov_b32 v19, 0x03020706
    v_cndmask_b32 v16, v16, v17, vcc
    v_cndmask_b32 v17, v18, v19, vcc
gb_3:
    s_sleep 1
    ds_read_b32 v60, v59 offset:0
    s_waitcnt lgkmcnt(0)
    v_readfirstlane_b32 s35, v60
    s_cmp_lt_u32 s35, 1
    s_cbranch_scc1 gb_3
    buffer_load_dwordx2 v[64:65], v7, s[8:11], s27 offen sc1
    buffer_load_dword v80, v2, s[8:11], s24 offen offset:0 sc1
    s_add_u32 s27, s27, 73728
    buffer_load_dwordx2 v[66:67], v7, s[8:11], s27 offen sc1
    buffer_load_dword v81, v2, s[8:11], s24 offen offset:256 sc1
    s_add_u32 s27, s27, 73728
    buffer_load_dwordx2 v[68:69], v7, s[8:11], s27 offen sc1
    buffer_load_dword v82, v2, s[8:11], s24 offen offset:512 sc1
    s_add_u32 s27, s27, 73728
    buffer_load_dwordx2 v[70:71], v7, s[8:11], s27 offen sc1
    buffer_load_dword v83, v2, s[8:11], s24 offen offset:768 sc1
    s_add_u32 s27, s27, 73728
    buffer_load_dwordx2 v[72:73], v7, s[8:11], s27 offen sc1
    buffer_load_dword v84, v2, s[8:11], s24 offen offset:1024 sc1
    s_add_u32 s27, s27, 73728
    buffer_load_dwordx2 v[74:75], v7, s[8:11], s27 offen sc1
    buffer_load_dword v85, v2, s[8:11], s24 offen offset:1280 sc1
    s_add_u32 s27, s27, 73728
    buffer_load_dwordx2 v[76:77], v7, s[8:11], s27 offen sc1
    buffer_load_dword v86, v2, s[8:11], s24 offen offset:1536 sc1
    s_add_u32 s27, s27, 73728
    buffer_load_dwordx2 v[78:79], v7, s[8:11], s27 offen sc1
    buffer_load_dword v87, v2, s[8:11], s24 offen offset:1792 sc1
    s_add_u32 s27, s27, 73728
    s_waitcnt vmcnt(14)
    v_and_b32 v9, 0xffff0000, v80
    v_lshlrev_b32 v8, 16, v80
    v_rcp_f32 v9, v9
    v_lshlrev_b32 v10, 16, v64
    v_and_b32 v11, 0xffff0000, v64
    v_lshlrev_b32 v12, 16, v65
    v_and_b32 v13, 0xffff0000, v65
    v_pk_add_f32 v[10:11], v[10:11], v[8:9] op_sel_hi:[1,0] neg_lo:[0,1] neg_hi:[0,1]
    v_pk_add_f32 v[12:13], v[12:13], v[8:9] op_sel_hi:[1,0] neg_lo:[0,1] neg_hi:[0,1]
    v_cvt_pk_bf16_f32 v14, v10, v11
    v_cvt_pk_bf16_f32 v15, v12, v13
    v_lshlrev_b32 v10, 16, v14
    v_and_b32 v11, 0xffff0000, v14
    v_lshlrev_b32 v12, 16, v15
    v_and_b32 v13, 0xffff0000, v15
    v_pk_mul_f32 v[10:11], v[10:11], v[8:9] op_sel:[0,1] op_sel_hi:[1,1]
    v_pk_mul_f32 v[12:13], v[12:13], v[8:9] op_sel:[0,1] op_sel_hi:[1,1]
    v_cvt_pk_bf16_f32 v14, v10, v11
    v_cvt_pk_bf16_f32 v15, v12, v13
    v_lshlrev_b32 v120, 16, v14
    v_and_b32 v121, 0xffff0000, v14
    v_lshlrev_b32 v122, 16, v15
    v_and_b32 v123, 0xffff0000, v15
    s_waitcnt vmcnt(12)
    v_and_b32 v9, 0xffff0000, v81
    v_lshlrev_b32 v8, 16, v81
    v_rcp_f32 v9, v9
    v_lshlrev_b32 v10, 16, v66
    v_and_b32 v11, 0xffff0000, v66
    v_lshlrev_b32 v12, 16, v67
    v_and_b32 v13, 0xffff0000, v67
    v_pk_add_f32 v[10:11], v[10:11], v[8:9] op_sel_hi:[1,0] neg_lo:[0,1] neg_hi:[0,1]
    v_pk_add_f32 v[12:13], v[12:13], v[8:9] op_sel_hi:[1,0] neg_lo:[0,1] neg_hi:[0,1]
    v_cvt_pk_bf16_f32 v14, v10, v11
    v_cvt_pk_bf16_f32 v15, v12, v13
    v_lshlrev_b32 v10, 16, v14
    v_and_b32 v11, 0xffff0000, v14
    v_lshlrev_b32 v12, 16, v15
    v_and_b32 v13, 0xffff0000, v15
    v_pk_mul_f32 v[10:11], v[10:11], v[8:9] op_sel:[0,1] op_sel_hi:[1,1]
    v_pk_mul_f32 v[12:13], v[12:13], v[8:9] op_sel:[0,1] op_sel_hi:[1,1]
    v_cvt_pk_bf16_f32 v14, v10, v11
    v_cvt_pk_bf16_f32 v15, v12, v13
    v_lshlrev_b32 v124, 16, v14
    v_and_b32 v125, 0xffff0000, v14
    v_lshlrev_b32 v126, 16, v15
    v_and_b32 v127, 0xffff0000, v15
    s_waitcnt vmcnt(10)
    v_and_b32 v9, 0xffff0000, v82
    v_lshlrev_b32 v8, 16, v82
    v_rcp_f32 v9, v9
    v_lshlrev_b32 v10, 16, v68
    v_and_b32 v11, 0xffff0000, v68
    v_lshlrev_b32 v12, 16, v69
    v_and_b32 v13, 0xffff0000, v69
    v_pk_add_f32 v[10:11], v[10:11], v[8:9] op_sel_hi:[1,0] neg_lo:[0,1] neg_hi:[0,1]
    v_pk_add_f32 v[12:13], v[12:13], v[8:9] op_sel_hi:[1,0] neg_lo:[0,1] neg_hi:[0,1]
    v_cvt_pk_bf16_f32 v14, v10, v11
    v_cvt_pk_bf16_f32 v15, v12, v13
    v_lshlrev_b32 v10, 16, v14
    v_and_b32 v11, 0xffff0000, v14
    v_lshlrev_b32 v12, 16, v15
    v_and_b32 v13, 0xffff0000, v15
    v_pk_mul_f32 v[10:11], v[10:11], v[8:9] op_sel:[0,1] op_sel_hi:[1,1]
    v_pk_mul_f32 v[12:13], v[12:13], v[8:9] op_sel:[0,1] op_sel_hi:[1,1]
    v_cvt_pk_bf16_f32 v14, v10, v11
    v_cvt_pk_bf16_f32 v15, v12, v13
    v_lshlrev_b32 v128, 16, v14
    v_and_b32 v129, 0xffff0000, v14
    v_lshlrev_b32 v130, 16, v15
    v_and_b32 v131, 0xffff0000, v15
    s_waitcnt vmcnt(8)
    v_and_b32 v9, 0xffff0000, v83
    v_lshlrev_b32 v8, 16, v83
    v_rcp_f32 v9, v9
    v_lshlrev_b32 v10, 16, v70
    v_and_b32 v11, 0xffff0000, v70
    v_lshlrev_b32 v12, 16, v71
    v_and_b32 v13, 0xffff0000, v71
    v_pk_add_f32 v[10:11], v[10:11], v[8:9] op_sel_hi:[1,0] neg_lo:[0,1] neg_hi:[0,1]
    v_pk_add_f32 v[12:13], v[12:13], v[8:9] op_sel_hi:[1,0] neg_lo:[0,1] neg_hi:[0,1]
    v_cvt_pk_bf16_f32 v14, v10, v11
    v_cvt_pk_bf16_f32 v15, v12, v13
    v_lshlrev_b32 v10, 16, v14
    v_and_b32 v11, 0xffff0000, v14
    v_lshlrev_b32 v12, 16, v15
    v_and_b32 v13, 0xffff0000, v15
    v_pk_mul_f32 v[10:11], v[10:11], v[8:9] op_sel:[0,1] op_sel_hi:[1,1]
    v_pk_mul_f32 v[12:13], v[12:13], v[8:9] op_sel:[0,1] op_sel_hi:[1,1]
    v_cvt_pk_bf16_f32 v14, v10, v11
    v_cvt_pk_bf16_f32 v15, v12, v13
    v_lshlrev_b32 v132, 16, v14
    v_and_b32 v133, 0xffff0000, v14
    v_lshlrev_b32 v134, 16, v15
    v_and_b32 v135, 0xffff0000, v15
    s_waitcnt vmcnt(6)
    v_and_b32 v9, 0xffff0000, v84
    v_lshlrev_b32 v8, 16, v84
    v_rcp_f32 v9, v9
    v_lshlrev_b32 v10, 16, v72
    v_and_b32 v11, 0xffff0000, v72
    v_lshlrev_b32 v12, 16, v73
    v_and_b32 v13, 0xffff0000, v73
    v_pk_add_f32 v[10:11], v[10:11], v[8:9] op_sel_hi:[1,0] neg_lo:[0,1] neg_hi:[0,1]
    v_pk_add_f32 v[12:13], v[12:13], v[8:9] op_sel_hi:[1,0] neg_lo:[0,1] neg_hi:[0,1]
    v_cvt_pk_bf16_f32 v14, v10, v11
    v_cvt_pk_bf16_f32 v15, v12, v13
    v_lshlrev_b32 v10, 16, v14
    v_and_b32 v11, 0xffff0000, v14
    v_lshlrev_b32 v12, 16, v15
    v_and_b32 v13, 0xffff0000, v15
    v_pk_mul_f32 v[10:11], v[10:11], v[8:9] op_sel:[0,1] op_sel_hi:[1,1]
    v_pk_mul_f32 v[12:13], v[12:13], v[8:9] op_sel:[0,1] op_sel_hi:[1,1]
    v_cvt_pk_bf16_f32 v14, v10, v11
    v_cvt_pk_bf16_f32 v15, v12, v13
    v_lshlrev_b32 v136, 16, v14
    v_and_b32 v137, 0xffff0000, v14
    v_lshlrev_b32 v138, 16, v15
    v_and_b32 v139, 0xffff0000, v15
    s_waitcnt vmcnt(4)
    v_and_b32 v9, 0xffff0000, v85
    v_lshlrev_b32 v8, 16, v85
    v_rcp_f32 v9, v9
    v_lshlrev_b32 v10, 16, v74
    v_and_b32 v11, 0xffff0000, v74
    v_lshlrev_b32 v12, 16, v75
    v_and_b32 v13, 0xffff0000, v75
    v_pk_add_f32 v[10:11], v[10:11], v[8:9] op_sel_hi:[1,0] neg_lo:[0,1] neg_hi:[0,1]
    v_pk_add_f32 v[12:13], v[12:13], v[8:9] op_sel_hi:[1,0] neg_lo:[0,1] neg_hi:[0,1]
    v_cvt_pk_bf16_f32 v14, v10, v11
    v_cvt_pk_bf16_f32 v15, v12, v13
    v_lshlrev_b32 v10, 16, v14
    v_and_b32 v11, 0xffff0000, v14
    v_lshlrev_b32 v12, 16, v15
    v_and_b32 v13, 0xffff0000, v15
    v_pk_mul_f32 v[10:11], v[10:11], v[8:9] op_sel:[0,1] op_sel_hi:[1,1]
    v_pk_mul_f32 v[12:13], v[12:13], v[8:9] op_sel:[0,1] op_sel_hi:[1,1]
    v_cvt_pk_bf16_f32 v14, v10, v11
    v_cvt_pk_bf16_f32 v15, v12, v13
    v_lshlrev_b32 v140, 16, v14
    v_and_b32 v141, 0xffff0000, v14
    v_lshlrev_b32 v142, 16, v15
    v_and_b32 v143, 0xffff0000, v15
    s_waitcnt vmcnt(2)
    v_and_b32 v9, 0xffff0000, v86
    v_lshlrev_b32 v8, 16, v86
    v_rcp_f32 v9, v9
    v_lshlrev_b32 v10, 16, v76
    v_and_b32 v11, 0xffff0000, v76
    v_lshlrev_b32 v12, 16, v77
    v_and_b32 v13, 0xffff0000, v77
    v_pk_add_f32 v[10:11], v[10:11], v[8:9] op_sel_hi:[1,0] neg_lo:[0,1] neg_hi:[0,1]
    v_pk_add_f32 v[12:13], v[12:13], v[8:9] op_sel_hi:[1,0] neg_lo:[0,1] neg_hi:[0,1]
    v_cvt_pk_bf16_f32 v14, v10, v11
    v_cvt_pk_bf16_f32 v15, v12, v13
    v_lshlrev_b32 v10, 16, v14
    v_and_b32 v11, 0xffff0000, v14
    v_lshlrev_b32 v12, 16, v15
    v_and_b32 v13, 0xffff0000, v15
    v_pk_mul_f32 v[10:11], v[10:11], v[8:9] op_sel:[0,1] op_sel_hi:[1,1]
    v_pk_mul_f32 v[12:13], v[12:13], v[8:9] op_sel:[0,1] op_sel_hi:[1,1]
    v_cvt_pk_bf16_f32 v14, v10, v11
    v_cvt_pk_bf16_f32 v15, v12, v13
    v_lshlrev_b32 v144, 16, v14
    v_and_b32 v145, 0xffff0000, v14
    v_lshlrev_b32 v146, 16, v15
    v_and_b32 v147, 0xffff0000, v15
    s_waitcnt vmcnt(0)
    v_and_b32 v9, 0xffff0000, v87
    v_lshlrev_b32 v8, 16, v87
    v_rcp_f32 v9, v9
    v_lshlrev_b32 v10, 16, v78
    v_and_b32 v11, 0xffff0000, v78
    v_lshlrev_b32 v12, 16, v79
    v_and_b32 v13, 0xffff0000, v79
    v_pk_add_f32 v[10:11], v[10:11], v[8:9] op_sel_hi:[1,0] neg_lo:[0,1] neg_hi:[0,1]
    v_pk_add_f32 v[12:13], v[12:13], v[8:9] op_sel_hi:[1,0] neg_lo:[0,1] neg_hi:[0,1]
    v_cvt_pk_bf16_f32 v14, v10, v11
    v_cvt_pk_bf16_f32 v15, v12, v13
    v_lshlrev_b32 v10, 16, v14
    v_and_b32 v11, 0xffff0000, v14
    v_lshlrev_b32 v12, 16, v15
    v_and_b32 v13, 0xffff0000, v15
    v_pk_mul_f32 v[10:11], v[10:11], v[8:9] op_sel:[0,1] op_sel_hi:[1,1]
    v_pk_mul_f32 v[12:13], v[12:13], v[8:9] op_sel:[0,1] op_sel_hi:[1,1]
    v_cvt_pk_bf16_f32 v14, v10, v11
    v_cvt_pk_bf16_f32 v15, v12, v13
    v_lshlrev_b32 v148, 16, v14
    v_and_b32 v149, 0xffff0000, v14
    v_lshlrev_b32 v150, 16, v15
    v_and_b32 v151, 0xffff0000, v15
gb_4:
    s_sleep 1
    ds_read_b32 v60, v59 offset:4
    s_waitcnt lgkmcnt(0)
    v_readfirstlane_b32 s35, v60
    s_cmp_lt_u32 s35, 1
    s_cbranch_scc1 gb_4
    ds_read_b128 v[88:91], v59 offset:32
    ds_read_b128 v[92:95], v59 offset:48
    s_waitcnt lgkmcnt(0)
    v_pk_mul_f32 v[10:11], v[120:121], v[92:93]
    v_pk_mul_f32 v[12:13], v[122:123], v[94:95]
    v_cvt_pk_bf16_f32 v14, v10, v11
    v_cvt_pk_bf16_f32 v15, v12, v13
    v_lshlrev_b32 v10, 16, v14
    v_and_b32 v11, 0xffff0000, v14
    v_lshlrev_b32 v12, 16, v15
    v_and_b32 v13, 0xffff0000, v15
    v_pk_add_f32 v[10:11], v[10:11], v[88:89]
    v_pk_add_f32 v[12:13], v[12:13], v[90:91]
    v_cvt_pk_bf16_f32 v14, v10, v11
    v_cvt_pk_bf16_f32 v15, v12, v13
    v_cndmask_b32 v10, v15, v14, vcc
    v_cndmask_b32 v11, v14, v15, vcc
    s_nop 0
    v_mov_b32_dpp v12, v10 quad_perm:[1,0,3,2] row_mask:0xf bank_mask:0xf
    v_perm_b32 v100, v12, v11, v16
    v_perm_b32 v101, v12, v11, v17
    v_pk_mul_f32 v[10:11], v[124:125], v[92:93]
    v_pk_mul_f32 v[12:13], v[126:127], v[94:95]
    v_cvt_pk_bf16_f32 v14, v10, v11
    v_cvt_pk_bf16_f32 v15, v12, v13
    v_lshlrev_b32 v10, 16, v14
    v_and_b32 v11, 0xffff0000, v14
    v_lshlrev_b32 v12, 16, v15
    v_and_b32 v13, 0xffff0000, v15
    v_pk_add_f32 v[10:11], v[10:11], v[88:89]
    v_pk_add_f32 v[12:13], v[12:13], v[90:91]
    v_cvt_pk_bf16_f32 v14, v10, v11
    v_cvt_pk_bf16_f32 v15, v12, v13
    v_cndmask_b32 v10, v15, v14, vcc
    v_cndmask_b32 v11, v14, v15, vcc
    s_nop 0
    v_mov_b32_dpp v12, v10 quad_perm:[1,0,3,2] row_mask:0xf bank_mask:0xf
    v_perm_b32 v102, v12, v11, v16
    v_perm_b32 v103, v12, v11, v17
    v_pk_mul_f32 v[10:11], v[128:129], v[92:93]
    v_pk_mul_f32 v[12:13], v[130:131], v[94:95]
    v_cvt_pk_bf16_f32 v14, v10, v11
    v_cvt_pk_bf16_f32 v15, v12, v13
    v_lshlrev_b32 v10, 16, v14
    v_and_b32 v11, 0xffff0000, v14
    v_lshlrev_b32 v12, 16, v15
    v_and_b32 v13, 0xffff0000, v15
    v_pk_add_f32 v[10:11], v[10:11], v[88:89]
    v_pk_add_f32 v[12:13], v[12:13], v[90:91]
    v_cvt_pk_bf16_f32 v14, v10, v11
    v_cvt_pk_bf16_f32 v15, v12, v13
    v_cndmask_b32 v10, v15, v14, vcc
    v_cndmask_b32 v11, v14, v15, vcc
    s_nop 0
    v_mov_b32_dpp v12, v10 quad_perm:[1,0,3,2] row_mask:0xf bank_mask:0xf
    v_perm_b32 v104, v12, v11, v16
    v_perm_b32 v105, v12, v11, v17
    v_pk_mul_f32 v[10:11], v[132:133], v[92:93]
    v_pk_mul_f32 v[12:13], v[134:135], v[94:95]
    v_cvt_pk_bf16_f32 v14, v10, v11
    v_cvt_pk_bf16_f32 v15, v12, v13
    v_lshlrev_b32 v10, 16, v14
    v_and_b32 v11, 0xffff0000, v14
    v_lshlrev_b32 v12, 16, v15
    v_and_b32 v13, 0xffff0000, v15
    v_pk_add_f32 v[10:11], v[10:11], v[88:89]
    v_pk_add_f32 v[12:13], v[12:13], v[90:91]
    v_cvt_pk_bf16_f32 v14, v10, v11
    v_cvt_pk_bf16_f32 v15, v12, v13
    v_cndmask_b32 v10, v15, v14, vcc
    v_cndmask_b32 v11, v14, v15, vcc
    s_nop 0
    v_mov_b32_dpp v12, v10 quad_perm:[1,0,3,2] row_mask:0xf bank_mask:0xf
    v_perm_b32 v106, v12, v11, v16
    v_perm_b32 v107, v12, v11, v17
    v_pk_mul_f32 v[10:11], v[136:137], v[92:93]
    v_pk_mul_f32 v[12:13], v[138:139], v[94:95]
    v_cvt_pk_bf16_f32 v14, v10, v11
    v_cvt_pk_bf16_f32 v15, v12, v13
    v_lshlrev_b32 v10, 16, v14
    v_and_b32 v11, 0xffff0000, v14
    v_lshlrev_b32 v12, 16, v15
    v_and_b32 v13, 0xffff0000, v15
    v_pk_add_f32 v[10:11], v[10:11], v[88:89]
    v_pk_add_f32 v[12:13], v[12:13], v[90:91]
    v_cvt_pk_bf16_f32 v14, v10, v11
    v_cvt_pk_bf16_f32 v15, v12, v13
    v_cndmask_b32 v10, v15, v14, vcc
    v_cndmask_b32 v11, v14, v15, vcc
    s_nop 0
    v_mov_b32_dpp v12, v10 quad_perm:[1,0,3,2] row_mask:0xf bank_mask:0xf
    v_perm_b32 v108, v12, v11, v16
    v_perm_b32 v109, v12, v11, v17
    v_pk_mul_f32 v[10:11], v[140:141], v[92:93]
    v_pk_mul_f32 v[12:13], v[142:143], v[94:95]
    v_cvt_pk_bf16_f32 v14, v10, v11
    v_cvt_pk_bf16_f32 v15, v12, v13
    v_lshlrev_b32 v10, 16, v14
    v_and_b32 v11, 0xffff0000, v14
    v_lshlrev_b32 v12, 16, v15
    v_and_b32 v13, 0xffff0000, v15
    v_pk_add_f32 v[10:11], v[10:11], v[88:89]
    v_pk_add_f32 v[12:13], v[12:13], v[90:91]
    v_cvt_pk_bf16_f32 v14, v10, v11
    v_cvt_pk_bf16_f32 v15, v12, v13
    v_cndmask_b32 v10, v15, v14, vcc
    v_cndmask_b32 v11, v14, v15, vcc
    s_nop 0
    v_mov_b32_dpp v12, v10 quad_perm:[1,0,3,2] row_mask:0xf bank_mask:0xf
    v_perm_b32 v110, v12, v11, v16
    v_perm_b32 v111, v12, v11, v17
    v_pk_mul_f32 v[10:11], v[144:145], v[92:93]
    v_pk_mul_f32 v[12:13], v[146:147], v[94:95]
    v_cvt_pk_bf16_f32 v14, v10, v11
    v_cvt_pk_bf16_f32 v15, v12, v13
    v_lshlrev_b32 v10, 16, v14
    v_and_b32 v11, 0xffff0000, v14
    v_lshlrev_b32 v12, 16, v15
    v_and_b32 v13, 0xffff0000, v15
    v_pk_add_f32 v[10:11], v[10:11], v[88:89]
    v_pk_add_f32 v[12:13], v[12:13], v[90:91]
    v_cvt_pk_bf16_f32 v14, v10, v11
    v_cvt_pk_bf16_f32 v15, v12, v13
    v_cndmask_b32 v10, v15, v14, vcc
    v_cndmask_b32 v11, v14, v15, vcc
    s_nop 0
    v_mov_b32_dpp v12, v10 quad_perm:[1,0,3,2] row_mask:0xf bank_mask:0xf
    v_perm_b32 v112, v12, v11, v16
    v_perm_b32 v113, v12, v11, v17
    v_pk_mul_f32 v[10:11], v[148:149], v[92:93]
    v_pk_mul_f32 v[12:13], v[150:151], v[94:95]
    v_cvt_pk_bf16_f32 v14, v10, v11
    v_cvt_pk_bf16_f32 v15, v12, v13
    v_lshlrev_b32 v10, 16, v14
    v_and_b32 v11, 0xffff0000, v14
    v_lshlrev_b32 v12, 16, v15
    v_and_b32 v13, 0xffff0000, v15
    v_pk_add_f32 v[10:11], v[10:11], v[88:89]
    v_pk_add_f32 v[12:13], v[12:13], v[90:91]
    v_cvt_pk_bf16_f32 v14, v10, v11
    v_cvt_pk_bf16_f32 v15, v12, v13
    v_cndmask_b32 v10, v15, v14, vcc
    v_cndmask_b32 v11, v14, v15, vcc
    s_nop 0
    v_mov_b32_dpp v12, v10 quad_perm:[1,0,3,2] row_mask:0xf bank_mask:0xf
    v_perm_b32 v114, v12, v11, v16
    v_perm_b32 v115, v12, v11, v17
    s_barrier
    ds_write_b32 v6, v100 offset:0
    ds_write_b32 v6, v101 offset:38480
    ds_write_b32 v6, v102 offset:160
    ds_write_b32 v6, v103 offset:38640
    ds_write_b32 v6, v104 offset:320
    ds_write_b32 v6, v105 offset:38800
    ds_write_b32 v6, v106 offset:480
    ds_write_b32 v6, v107 offset:38960
    ds_write_b32 v6, v108 offset:640
    ds_write_b32 v6, v109 offset:39120
    ds_write_b32 v6, v110 offset:800
    ds_write_b32 v6, v111 offset:39280
    ds_write_b32 v6, v112 offset:960
    ds_write_b32 v6, v113 offset:39440
    ds_write_b32 v6, v114 offset:1120
    ds_write_b32 v6, v115 offset:39600
    s_waitcnt lgkmcnt(0)
    s_barrier
    s_mul_i32 s15, s13, 38480
    s_add_u32 s16, s15, 33360
    v_lshlrev_b32 v21, 1, v0
    v_add_u32 v21, 4294967294, v21
    v_ashrrev_i32 v22, 2, v21
    v_mul_i32_i24 v22, 80, v22
    v_and_b32 v21, 3, v21
    v_lshl_add_u32 v22, v21, 4, v22
    v_add_u32 v28, s16, v22
    v_lshlrev_b32 v21, 1, v0
    v_add_u32 v21, 0, v21
    v_ashrrev_i32 v22, 2, v21
    v_mul_i32_i24 v22, 80, v22
    v_and_b32 v21, 3, v21
    v_lshl_add_u32 v22, v21, 4, v22
    v_add_u32 v29, s16, v22
    ds_read_b128 v[120:123], v28 offset:0
    ds_read_b128 v[124:127], v28 offset:16
    ds_read_b128 v[128:131], v29 offset:0
    ds_read_b128 v[132:135], v29 offset:16
    v_mul_u32_u24 v21, 144, v0
    v_add_u32 v21, s15, v21
    s_mov_b32 s16, 0x05040100
    s_mov_b32 s17, 0x07060302
    s_waitcnt lgkmcnt(0)
    v_lshlrev_b32 v136, 16, v122
    v_and_b32 v137, 0xffff0000, v122
    v_lshlrev_b32 v138, 16, v123
    v_and_b32 v139, 0xffff0000, v123
    v_lshlrev_b32 v140, 16, v124
    v_and_b32 v141, 0xffff0000, v124
    v_lshlrev_b32 v142, 16, v125
    v_and_b32 v143, 0xffff0000, v125
    v_lshlrev_b32 v144, 16, v126
    v_and_b32 v145, 0xffff0000, v126
    v_lshlrev_b32 v146, 16, v127
    v_and_b32 v147, 0xffff0000, v127
    v_lshlrev_b32 v148, 16, v128
    v_and_b32 v149, 0xffff0000, v128
    v_lshlrev_b32 v150, 16, v129
    v_and_b32 v151, 0xffff0000, v129
    v_lshlrev_b32 v152, 16, v130
    v_and_b32 v153, 0xffff0000, v130
    v_lshlrev_b32 v154, 16, v131
    v_and_b32 v155, 0xffff0000, v131
    v_lshlrev_b32 v156, 16, v132
    v_and_b32 v157, 0xffff0000, v132
    v_lshlrev_b32 v158, 16, v133
    v_and_b32 v159, 0xffff0000, v133
    v_add_f32 v160, v137, v138
    v_add_f32 v161, v139, v140
    v_add_f32 v162, v141, v142
    v_add_f32 v160, v160, v143
    v_add_f32 v161, v161, v162
    v_add_f32 v160, v160, v161
    v_sub_f32 v176, v144, v137
    v_sub_f32 v177, v145, v138
    v_sub_f32 v178, v146, v139
    v_sub_f32 v179, v147, v140
    v_sub_f32 v180, v148, v141
    v_sub_f32 v181, v149, v142
    v_sub_f32 v182, v150, v143
    v_sub_f32 v183, v151, v144
    v_sub_f32 v184, v152, v145
    v_sub_f32 v185, v153, v146
    v_sub_f32 v186, v154, v147
    v_sub_f32 v187, v155, v148
    v_sub_f32 v188, v156, v149
    v_sub_f32 v189, v157, v150
    v_sub_f32 v190, v158, v151
    v_add_f32 v161, v160, v176
    v_add_f32 v162, v161, v177
    v_add_f32 v163, v162, v178
    v_add_f32 v164, v163, v179
    v_add_f32 v165, v164, v180
    v_add_f32 v166, v165, v181
    v_add_f32 v167, v166, v182
    v_add_f32 v168, v167, v183
    v_add_f32 v169, v168, v184
    v_add_f32 v170, v169, v185
    v_add_f32 v171, v170, v186
    v_add_f32 v172, v171, v187
    v_add_f32 v173, v172, v188
    v_add_f32 v174, v173, v189
    v_add_f32 v175, v174, v190
    v_add_f32 v176, v136, v144
    v_add_f32 v176, v176, v160
    v_add_f32 v177, v137, v145
    v_add_f32 v177, v177, v161
    v_add_f32 v178, v138, v146
    v_add_f32 v178, v178, v162
    v_add_f32 v179, v139, v147
    v_add_f32 v179, v179, v163
    v_add_f32 v180, v140, v148
    v_add_f32 v180, v180, v164
    v_add_f32 v181, v141, v149
    v_add_f32 v181, v181, v165
    v_add_f32 v182, v142, v150
    v_add_f32 v182, v182, v166
    v_add_f32 v183, v143, v151
    v_add_f32 v183, v183, v167
    v_add_f32 v184, v144, v152
    v_add_f32 v184, v184, v168
    v_add_f32 v185, v145, v153
    v_add_f32 v185, v185, v169
    v_add_f32 v186, v146, v154
    v_add_f32 v186, v186, v170
    v_add_f32 v187, v147, v155
    v_add_f32 v187, v187, v171
    v_add_f32 v188, v148, v156
    v_add_f32 v188, v188, v172
    v_add_f32 v189, v149, v157
    v_add_f32 v189, v189, v173
    v_add_f32 v190, v150, v158
    v_add_f32 v190, v190, v174
    v_add_f32 v191, v151, v159
    v_add_f32 v191, v191, v175
    v_cvt_pk_bf16_f32 v192, v160, v161
    v_cvt_pk_bf16_f32 v193, v162, v163
    v_cvt_pk_bf16_f32 v194, v164, v165
    v_cvt_pk_bf16_f32 v195, v166, v167
    v_cvt_pk_bf16_f32 v196, v168, v169
    v_cvt_pk_bf16_f32 v197, v170, v171
    v_cvt_pk_bf16_f32 v198, v172, v173
    v_cvt_pk_bf16_f32 v199, v174, v175
    v_cvt_pk_bf16_f32 v200, v176, v177
    v_cvt_pk_bf16_f32 v201, v178, v179
    v_cvt_pk_bf16_f32 v202, v180, v181
    v_cvt_pk_bf16_f32 v203, v182, v183
    v_cvt_pk_bf16_f32 v204, v184, v185
    v_cvt_pk_bf16_f32 v205, v186, v187
    v_cvt_pk_bf16_f32 v206, v188, v189
    v_cvt_pk_bf16_f32 v207, v190, v191
    s_nop 1
    v_mov_b32_dpp v208, v192 wave_shr:1 row_mask:0xf bank_mask:0xf bound_ctrl:0
    v_mov_b32_dpp v209, v193 wave_shr:1 row_mask:0xf bank_mask:0xf bound_ctrl:0
    v_mov_b32_dpp v210, v194 wave_shr:1 row_mask:0xf bank_mask:0xf bound_ctrl:0
    v_mov_b32_dpp v211, v195 wave_shr:1 row_mask:0xf bank_mask:0xf bound_ctrl:0
    v_mov_b32_dpp v212, v196 wave_shr:1 row_mask:0xf bank_mask:0xf bound_ctrl:0
    v_mov_b32_dpp v213, v197 wave_shr:1 row_mask:0xf bank_mask:0xf bound_ctrl:0
    v_mov_b32_dpp v214, v198 wave_shr:1 row_mask:0xf bank_mask:0xf bound_ctrl:0
    v_mov_b32_dpp v215, v199 wave_shr:1 row_mask:0xf bank_mask:0xf bound_ctrl:0
    v_mov_b32_dpp v216, v200 wave_shr:1 row_mask:0xf bank_mask:0xf bound_ctrl:0
    v_mov_b32_dpp v217, v201 wave_shr:1 row_mask:0xf bank_mask:0xf bound_ctrl:0
    v_mov_b32_dpp v218, v202 wave_shr:1 row_mask:0xf bank_mask:0xf bound_ctrl:0
    v_mov_b32_dpp v219, v203 wave_shr:1 row_mask:0xf bank_mask:0xf bound_ctrl:0
    v_mov_b32_dpp v220, v204 wave_shr:1 row_mask:0xf bank_mask:0xf bound_ctrl:0
    v_mov_b32_dpp v221, v205 wave_shr:1 row_mask:0xf bank_mask:0xf bound_ctrl:0
    v_mov_b32_dpp v222, v206 wave_shr:1 row_mask:0xf bank_mask:0xf bound_ctrl:0
    v_mov_b32_dpp v223, v207 wave_shr:1 row_mask:0xf bank_mask:0xf bound_ctrl:0
    s_nop 1
    v_mov_b32_dpp v224, v220 wave_shr:1 row_mask:0xf bank_mask:0xf bound_ctrl:0
    v_mov_b32_dpp v225, v221 wave_shr:1 row_mask:0xf bank_mask:0xf bound_ctrl:0
    v_mov_b32_dpp v226, v222 wave_shr:1 row_mask:0xf bank_mask:0xf bound_ctrl:0
    v_mov_b32_dpp v227, v223 wave_shr:1 row_mask:0xf bank_mask:0xf bound_ctrl:0
    v_perm_b32 v120, v220, v192, s16
    v_perm_b32 v121, v224, v208, s16
    v_perm_b32 v122, v220, v192, s17
    v_perm_b32 v123, v224, v208, s17
    ds_write_b128 v21, v[120:123] offset:18944
    v_perm_b32 v124, v221, v193, s16
    v_perm_b32 v125, v225, v209, s16
    v_perm_b32 v126, v221, v193, s17
    v_perm_b32 v127, v225, v209, s17
    ds_write_b128 v21, v[124:127] offset:18960
    v_perm_b32 v128, v222, v194, s16
    v_perm_b32 v129, v226, v210, s16
    v_perm_b32 v130, v222, v194, s17
    v_perm_b32 v131, v226, v210, s17
    ds_write_b128 v21, v[128:131] offset:18976
    v_perm_b32 v132, v223, v195, s16
    v_perm_b32 v133, v227, v211, s16
    v_perm_b32 v134, v223, v195, s17
    v_perm_b32 v135, v227, v211, s17
    ds_write_b128 v21, v[132:135] offset:18992
    v_perm_b32 v136, v200, v196, s16
    v_perm_b32 v137, v216, v212, s16
    v_perm_b32 v138, v200, v196, s17
    v_perm_b32 v139, v216, v212, s17
    ds_write_b128 v21, v[136:139] offset:19008
    v_perm_b32 v140, v201, v197, s16
    v_perm_b32 v141, v217, v213, s16
    v_perm_b32 v142, v201, v197, s17
    v_perm_b32 v143, v217, v213, s17
    ds_write_b128 v21, v[140:143] offset:19024
    v_perm_b32 v144, v202, v198, s16
    v_perm_b32 v145, v218, v214, s16
    v_perm_b32 v146, v202, v198, s17
    v_perm_b32 v147, v218, v214, s17
    ds_write_b128 v21, v[144:147] offset:19040
    v_perm_b32 v148, v203, v199, s16
    v_perm_b32 v149, v219, v215, s16
    v_perm_b32 v150, v203, v199, s17
    v_perm_b32 v151, v219, v215, s17
    ds_write_b128 v21, v[148:151] offset:19056
    s_waitcnt lgkmcnt(0)
    s_barrier
    v_bfe_u32 v6, v0, 2, 2
    v_mul_u32_u24 v6, 38480, v6
    v_lshrrev_b32 v8, 4, v0
    v_lshl_add_u32 v6, v8, 5, v6
    v_and_b32 v8, 3, v0
    v_lshl_add_u32 v6, v8, 3, v6
    s_lshl_b32 s29, s13, 10
    v_add_u32 v6, s29, v6
    s_barrier
    ds_read_b64_tr_b16 v[80:81], v6 offset:0
    ds_read_b64_tr_b16 v[82:83], v6 offset:128
    ds_read_b64_tr_b16 v[84:85], v6 offset:256
    ds_read_b64_tr_b16 v[86:87], v6 offset:384
    ds_read_b64_tr_b16 v[88:89], v6 offset:512
    ds_read_b64_tr_b16 v[90:91], v6 offset:640
    ds_read_b64_tr_b16 v[92:93], v6 offset:768
    ds_read_b64_tr_b16 v[94:95], v6 offset:896
    s_waitcnt lgkmcnt(7)
    v_lshlrev_b32 v10, 16, v80
    v_and_b32 v11, 0xffff0000, v80
    v_lshlrev_b32 v12, 16, v64
    v_and_b32 v13, 0xffff0000, v64
    v_pk_add_f32 v[10:11], v[10:11], v[12:13]
    v_cvt_pk_bf16_f32 v100, v10, v11
    v_lshlrev_b32 v10, 16, v81
    v_and_b32 v11, 0xffff0000, v81
    v_lshlrev_b32 v12, 16, v65
    v_and_b32 v13, 0xffff0000, v65
    v_pk_add_f32 v[10:11], v[10:11], v[12:13]
    v_cvt_pk_bf16_f32 v101, v10, v11
    buffer_store_dwordx2 v[100:101], v7, s[8:11], s28 offen
    s_add_u32 s28, s28, 73728
    s_waitcnt lgkmcnt(6)
    v_lshlrev_b32 v10, 16, v82
    v_and_b32 v11, 0xffff0000, v82
    v_lshlrev_b32 v12, 16, v66
    v_and_b32 v13, 0xffff0000, v66
    v_pk_add_f32 v[10:11], v[10:11], v[12:13]
    v_cvt_pk_bf16_f32 v102, v10, v11
    v_lshlrev_b32 v10, 16, v83
    v_and_b32 v11, 0xffff0000, v83
    v_lshlrev_b32 v12, 16, v67
    v_and_b32 v13, 0xffff0000, v67
    v_pk_add_f32 v[10:11], v[10:11], v[12:13]
    v_cvt_pk_bf16_f32 v103, v10, v11
    buffer_store_dwordx2 v[102:103], v7, s[8:11], s28 offen
    s_add_u32 s28, s28, 73728
    s_waitcnt lgkmcnt(5)
    v_lshlrev_b32 v10, 16, v84
    v_and_b32 v11, 0xffff0000, v84
    v_lshlrev_b32 v12, 16, v68
    v_and_b32 v13, 0xffff0000, v68
    v_pk_add_f32 v[10:11], v[10:11], v[12:13]
    v_cvt_pk_bf16_f32 v104, v10, v11
    v_lshlrev_b32 v10, 16, v85
    v_and_b32 v11, 0xffff0000, v85
    v_lshlrev_b32 v12, 16, v69
    v_and_b32 v13, 0xffff0000, v69
    v_pk_add_f32 v[10:11], v[10:11], v[12:13]
    v_cvt_pk_bf16_f32 v105, v10, v11
    buffer_store_dwordx2 v[104:105], v7, s[8:11], s28 offen
    s_add_u32 s28, s28, 73728
    s_waitcnt lgkmcnt(4)
    v_lshlrev_b32 v10, 16, v86
    v_and_b32 v11, 0xffff0000, v86
    v_lshlrev_b32 v12, 16, v70
    v_and_b32 v13, 0xffff0000, v70
    v_pk_add_f32 v[10:11], v[10:11], v[12:13]
    v_cvt_pk_bf16_f32 v106, v10, v11
    v_lshlrev_b32 v10, 16, v87
    v_and_b32 v11, 0xffff0000, v87
    v_lshlrev_b32 v12, 16, v71
    v_and_b32 v13, 0xffff0000, v71
    v_pk_add_f32 v[10:11], v[10:11], v[12:13]
    v_cvt_pk_bf16_f32 v107, v10, v11
    buffer_store_dwordx2 v[106:107], v7, s[8:11], s28 offen
    s_add_u32 s28, s28, 73728
    s_waitcnt lgkmcnt(3)
    v_lshlrev_b32 v10, 16, v88
    v_and_b32 v11, 0xffff0000, v88
    v_lshlrev_b32 v12, 16, v72
    v_and_b32 v13, 0xffff0000, v72
    v_pk_add_f32 v[10:11], v[10:11], v[12:13]
    v_cvt_pk_bf16_f32 v108, v10, v11
    v_lshlrev_b32 v10, 16, v89
    v_and_b32 v11, 0xffff0000, v89
    v_lshlrev_b32 v12, 16, v73
    v_and_b32 v13, 0xffff0000, v73
    v_pk_add_f32 v[10:11], v[10:11], v[12:13]
    v_cvt_pk_bf16_f32 v109, v10, v11
    buffer_store_dwordx2 v[108:109], v7, s[8:11], s28 offen
    s_add_u32 s28, s28, 73728
    s_waitcnt lgkmcnt(2)
    v_lshlrev_b32 v10, 16, v90
    v_and_b32 v11, 0xffff0000, v90
    v_lshlrev_b32 v12, 16, v74
    v_and_b32 v13, 0xffff0000, v74
    v_pk_add_f32 v[10:11], v[10:11], v[12:13]
    v_cvt_pk_bf16_f32 v110, v10, v11
    v_lshlrev_b32 v10, 16, v91
    v_and_b32 v11, 0xffff0000, v91
    v_lshlrev_b32 v12, 16, v75
    v_and_b32 v13, 0xffff0000, v75
    v_pk_add_f32 v[10:11], v[10:11], v[12:13]
    v_cvt_pk_bf16_f32 v111, v10, v11
    buffer_store_dwordx2 v[110:111], v7, s[8:11], s28 offen
    s_add_u32 s28, s28, 73728
    s_waitcnt lgkmcnt(1)
    v_lshlrev_b32 v10, 16, v92
    v_and_b32 v11, 0xffff0000, v92
    v_lshlrev_b32 v12, 16, v76
    v_and_b32 v13, 0xffff0000, v76
    v_pk_add_f32 v[10:11], v[10:11], v[12:13]
    v_cvt_pk_bf16_f32 v112, v10, v11
    v_lshlrev_b32 v10, 16, v93
    v_and_b32 v11, 0xffff0000, v93
    v_lshlrev_b32 v12, 16, v77
    v_and_b32 v13, 0xffff0000, v77
    v_pk_add_f32 v[10:11], v[10:11], v[12:13]
    v_cvt_pk_bf16_f32 v113, v10, v11
    buffer_store_dwordx2 v[112:113], v7, s[8:11], s28 offen
    s_add_u32 s28, s28, 73728
    s_waitcnt lgkmcnt(0)
    v_lshlrev_b32 v10, 16, v94
    v_and_b32 v11, 0xffff0000, v94
    v_lshlrev_b32 v12, 16, v78
    v_and_b32 v13, 0xffff0000, v78
    v_pk_add_f32 v[10:11], v[10:11], v[12:13]
    v_cvt_pk_bf16_f32 v114, v10, v11
    v_lshlrev_b32 v10, 16, v95
    v_and_b32 v11, 0xffff0000, v95
    v_lshlrev_b32 v12, 16, v79
    v_and_b32 v13, 0xffff0000, v79
    v_pk_add_f32 v[10:11], v[10:11], v[12:13]
    v_cvt_pk_bf16_f32 v115, v10, v11
    buffer_store_dwordx2 v[114:115], v7, s[8:11], s28 offen
    s_add_u32 s28, s28, 73728
    s_endpgm
f_conv_go:
    s_load_dwordx4 s[16:19], s[0:1], 8
    s_load_dwordx4 s[20:23], s[0:1], 24
    s_load_dwordx4 s[24:27], s[0:1], 40
    s_sub_u32 s12, s2, 112
    s_and_b32 s3, s12, 7
    s_lshr_b32 s12, s12, 3
    s_lshl_b32 s3, s3, 1
    s_and_b32 s13, s12, 1
    s_add_u32 s3, s3, s13
    s_lshr_b32 s12, s12, 1
    s_lshl_b32 s12, s12, 4
    s_add_u32 s12, s12, s3
    s_lshl_b32 s13, s12, 2
    s_add_u32 s13, s13, s14
    s_mul_i32 s15, s14, 38480
    s_waitcnt lgkmcnt(0)
    v_lshlrev_b32 v1, 2, v0
    s_lshl_b32 s28, s13, 8
    v_mov_b32 v2, 0
    s_lshl_b32 s29, s13, 1
    s_mov_b32 s56, s16
    s_mov_b32 s57, s17
    s_mov_b32 s58, 147456
    s_mov_b32 s59, 0x00020000
    buffer_load_dword v4, v1, s[56:59], s28 offen
    s_mov_b32 s56, s18
    s_mov_b32 s57, s19
    s_mov_b32 s58, 147456
    s_mov_b32 s59, 0x00020000
    buffer_load_dword v5, v1, s[56:59], s28 offen
    s_mov_b32 s56, s20
    s_mov_b32 s57, s21
    s_mov_b32 s58, 147456
    s_mov_b32 s59, 0x00020000
    buffer_load_dword v6, v1, s[56:59], s28 offen
    s_mov_b32 s56, s22
    s_mov_b32 s57, s23
    s_mov_b32 s58, 147456
    s_mov_b32 s59, 0x00020000
    buffer_load_dword v7, v1, s[56:59], s28 offen
    s_mov_b32 s56, s24
    s_mov_b32 s57, s25
    s_mov_b32 s58, 1152
    s_mov_b32 s59, 0x00020000
    buffer_load_ushort v8, v2, s[56:59], s29 offen
    s_mov_b32 s56, s26
    s_mov_b32 s57, s27
    s_mov_b32 s58, 1152
    s_mov_b32 s59, 0x00020000
    buffer_load_ushort v9, v2, s[56:59], s29 offen
    s_mov_b32 s30, 0x3fb8aa3b
    s_mov_b32 s31, 0x3e22f983
    s_waitcnt vmcnt(0)
    v_lshlrev_b32 v8, 16, v8
    v_lshlrev_b32 v9, 16, v9
    v_mul_f32 v8, s30, v8
    v_exp_f32 v8, v8
    s_nop 0
    v_cvt_pk_bf16_f32 v8, v8, v8
    v_lshlrev_b32 v8, 16, v8
    v_lshlrev_b32 v10, 16, v4
    v_lshlrev_b32 v12, 16, v5
    v_lshlrev_b32 v14, 16, v6
    v_lshlrev_b32 v15, 16, v7
    v_and_b32 v11, 0xffff0000, v4
    v_and_b32 v13, 0xffff0000, v5
    v_and_b32 v16, 0xffff0000, v6
    v_and_b32 v17, 0xffff0000, v7
    v_mul_f32 v10, s30, v10
    v_exp_f32 v10, v10
    v_mul_f32 v12, v8, v12
    v_cvt_pk_bf16_f32 v10, v10, v10
    v_lshlrev_b32 v10, 16, v10
    v_mul_f32 v10, v8, v10
    v_mul_f32 v10, s30, v10
    v_mul_f32 v12, s31, v12
    v_mul_f32 v11, s30, v11
    v_exp_f32 v11, v11
    v_mul_f32 v13, v8, v13
    v_cvt_pk_bf16_f32 v11, v11, v11
    v_lshlrev_b32 v11, 16, v11
    v_mul_f32 v11, v8, v11
    v_mul_f32 v11, s30, v11
    v_mul_f32 v13, s31, v13
    v_max3_f32 v18, abs(v14), abs(v15), abs(v16)
    v_max_f32 v18, abs(v17), v18
    s_nop 1
    v_max_f32_dpp v18, v18, v18 row_shr:1 row_mask:0xf bank_mask:0xf
    s_nop 1
    v_max_f32_dpp v18, v18, v18 row_shr:2 row_mask:0xf bank_mask:0xf
    s_nop 1
    v_max_f32_dpp v18, v18, v18 row_shr:4 row_mask:0xf bank_mask:0xf
    s_nop 1
    v_max_f32_dpp v18, v18, v18 row_shr:8 row_mask:0xf bank_mask:0xf
    s_nop 1
    v_readlane_b32 s32, v18, 15
    v_readlane_b32 s33, v18, 31
    v_readlane_b32 s34, v18, 47
    v_readlane_b32 s35, v18, 63
    s_max_u32 s32, s32, s33
    s_max_u32 s34, s34, s35
    s_max_u32 s32, s32, s34
    s_and_b32 s32, s32, 0x7f800000
    s_cmp_eq_u32 s32, 0
    s_cselect_b32 s32, 0x3f800000, s32
    s_min_u32 s32, s32, 0x7e800000
    s_sub_u32 s33, 0x7f000000, s32
    v_mul_f32 v14, s33, v14
    v_mul_f32 v15, s33, v15
    v_mul_f32 v16, s33, v16
    v_mul_f32 v17, s33, v17
    v_mul_f32 v19, s32, v8
    v_add_f32 v19, v19, v19
    s_mov_b32 s34, 0x3f800000
    v_mul_f32 v32, s34, v10
    v_mul_f32 v33, s34, v12
    v_exp_f32 v32, -v32
    v_fract_f32 v33, v33
    v_cos_f32 v20, v33
    v_sin_f32 v21, v33
    s_nop 0
    v_mul_f32 v20, v32, v20
    v_mul_f32 v21, v32, v21
    s_mov_b32 s34, 0x3f800000
    v_mul_f32 v32, s34, v11
    v_mul_f32 v33, s34, v13
    v_exp_f32 v32, -v32
    v_fract_f32 v33, v33
    v_cos_f32 v22, v33
    v_sin_f32 v23, v33
    s_nop 0
    v_mul_f32 v22, v32, v22
    v_mul_f32 v23, v32, v23
    s_mov_b32 s34, 0x41000000
    v_mul_f32 v32, s34, v10
    v_mul_f32 v33, s34, v12
    v_exp_f32 v32, -v32
    v_fract_f32 v33, v33
    v_cos_f32 v24, v33
    v_sin_f32 v25, v33
    s_nop 0
    v_mul_f32 v24, v32, v24
    v_mul_f32 v25, v32, v25
    s_mov_b32 s34, 0x41000000
    v_mul_f32 v32, s34, v11
    v_mul_f32 v33, s34, v13
    v_exp_f32 v32, -v32
    v_fract_f32 v33, v33
    v_cos_f32 v26, v33
    v_sin_f32 v27, v33
    s_nop 0
    v_mul_f32 v26, v32, v26
    v_mul_f32 v27, v32, v27
    s_mov_b32 s34, 0x43000000
    v_mul_f32 v32, s34, v10
    v_mul_f32 v33, s34, v12
    v_exp_f32 v32, -v32
    v_fract_f32 v33, v33
    v_cos_f32 v28, v33
    v_sin_f32 v29, v33
    s_nop 0
    v_mul_f32 v28, v32, v28
    v_mul_f32 v29, v32, v29
    s_mov_b32 s34, 0x43000000
    v_mul_f32 v32, s34, v11
    v_mul_f32 v33, s34, v13
    v_exp_f32 v32, -v32
    v_fract_f32 v33, v33
    v_cos_f32 v30, v33
    v_sin_f32 v31, v33
    s_nop 0
    v_mul_f32 v30, v32, v30
    v_mul_f32 v31, v32, v31
    v_lshlrev_b32 v2, 3, v0
    v_add_u32 v2, s15, v2
    v_mov_b32 v48, v14
    v_mov_b32 v49, v15
    v_mov_b32 v50, v16
    v_mov_b32 v51, v17
    v_cvt_pk_f16_f32 v36, v48, v49
    v_cvt_pk_f16_f32 v37, v50, v51
    ds_write_b64 v2, v[36:37] offset:0
    v_pk_mul_f32 v[52:53], v[48:49], v[20:21] op_sel:[0,0] op_sel_hi:[0,1]
    v_pk_fma_f32 v[52:53], v[48:49], v[20:21], v[52:53] op_sel:[1,1,0] op_sel_hi:[1,0,1] neg_lo:[1,0,0]
    v_pk_mul_f32 v[54:55], v[50:51], v[22:23] op_sel:[0,0] op_sel_hi:[0,1]
    v_pk_fma_f32 v[54:55], v[50:51], v[22:23], v[54:55] op_sel:[1,1,0] op_sel_hi:[1,0,1] neg_lo:[1,0,0]
    v_cvt_pk_f16_f32 v38, v52, v53
    v_cvt_pk_f16_f32 v39, v54, v55
    ds_write_b64 v2, v[38:39] offset:528
    v_pk_mul_f32 v[56:57], v[52:53], v[20:21] op_sel:[0,0] op_sel_hi:[0,1]
    v_pk_fma_f32 v[56:57], v[52:53], v[20:21], v[56:57] op_sel:[1,1,0] op_sel_hi:[1,0,1] neg_lo:[1,0,0]
    v_pk_mul_f32 v[58:59], v[54:55], v[22:23] op_sel:[0,0] op_sel_hi:[0,1]
    v_pk_fma_f32 v[58:59], v[54:55], v[22:23], v[58:59] op_sel:[1,1,0] op_sel_hi:[1,0,1] neg_lo:[1,0,0]
    v_cvt_pk_f16_f32 v40, v56, v57
    v_cvt_pk_f16_f32 v41, v58, v59
    ds_write_b64 v2, v[40:41] offset:1056
    v_pk_mul_f32 v[60:61], v[56:57], v[20:21] op_sel:[0,0] op_sel_hi:[0,1]
    v_pk_fma_f32 v[60:61], v[56:57], v[20:21], v[60:61] op_sel:[1,1,0] op_sel_hi:[1,0,1] neg_lo:[1,0,0]
    v_pk_mul_f32 v[62:63], v[58:59], v[22:23] op_sel:[0,0] op_sel_hi:[0,1]
    v_pk_fma_f32 v[62:63], v[58:59], v[22:23], v[62:63] op_sel:[1,1,0] op_sel_hi:[1,0,1] neg_lo:[1,0,0]
    v_cvt_pk_f16_f32 v42, v60, v61
    v_cvt_pk_f16_f32 v43, v62, v63
    ds_write_b64 v2, v[42:43] offset:1584
    v_pk_mul_f32 v[64:65], v[60:61], v[20:21] op_sel:[0,0] op_sel_hi:[0,1]
    v_pk_fma_f32 v[64:65], v[60:61], v[20:21], v[64:65] op_sel:[1,1,0] op_sel_hi:[1,0,1] neg_lo:[1,0,0]
    v_pk_mul_f32 v[66:67], v[62:63], v[22:23] op_sel:[0,0] op_sel_hi:[0,1]
    v_pk_fma_f32 v[66:67], v[62:63], v[22:23], v[66:67] op_sel:[1,1,0] op_sel_hi:[1,0,1] neg_lo:[1,0,0]
    v_cvt_pk_f16_f32 v36, v64, v65
    v_cvt_pk_f16_f32 v37, v66, v67
    ds_write_b64 v2, v[36:37] offset:2112
    v_pk_mul_f32 v[68:69], v[64:65], v[20:21] op_sel:[0,0] op_sel_hi:[0,1]
    v_pk_fma_f32 v[68:69], v[64:65], v[20:21], v[68:69] op_sel:[1,1,0] op_sel_hi:[1,0,1] neg_lo:[1,0,0]
    v_pk_mul_f32 v[70:71], v[66:67], v[22:23] op_sel:[0,0] op_sel_hi:[0,1]
    v_pk_fma_f32 v[70:71], v[66:67], v[22:23], v[70:71] op_sel:[1,1,0] op_sel_hi:[1,0,1] neg_lo:[1,0,0]
    v_cvt_pk_f16_f32 v38, v68, v69
    v_cvt_pk_f16_f32 v39, v70, v71
    ds_write_b64 v2, v[38:39] offset:2640
    v_pk_mul_f32 v[72:73], v[68:69], v[20:21] op_sel:[0,0] op_sel_hi:[0,1]
    v_pk_fma_f32 v[72:73], v[68:69], v[20:21], v[72:73] op_sel:[1,1,0] op_sel_hi:[1,0,1] neg_lo:[1,0,0]
    v_pk_mul_f32 v[74:75], v[70:71], v[22:23] op_sel:[0,0] op_sel_hi:[0,1]
    v_pk_fma_f32 v[74:75], v[70:71], v[22:23], v[74:75] op_sel:[1,1,0] op_sel_hi:[1,0,1] neg_lo:[1,0,0]
    v_cvt_pk_f16_f32 v40, v72, v73
    v_cvt_pk_f16_f32 v41, v74, v75
    ds_write_b64 v2, v[40:41] offset:3168
    v_pk_mul_f32 v[76:77], v[72:73], v[20:21] op_sel:[0,0] op_sel_hi:[0,1]
    v_pk_fma_f32 v[76:77], v[72:73], v[20:21], v[76:77] op_sel:[1,1,0] op_sel_hi:[1,0,1] neg_lo:[1,0,0]
    v_pk_mul_f32 v[78:79], v[74:75], v[22:23] op_sel:[0,0] op_sel_hi:[0,1]
    v_pk_fma_f32 v[78:79], v[74:75], v[22:23], v[78:79] op_sel:[1,1,0] op_sel_hi:[1,0,1] neg_lo:[1,0,0]
    v_cvt_pk_f16_f32 v42, v76, v77
    v_cvt_pk_f16_f32 v43, v78, v79
    ds_write_b64 v2, v[42:43] offset:3696
    v_mov_b32 v44, 0x3c00
    v_mov_b32 v45, 0x3c00
    ds_write_b64 v2, v[44:45] offset:25344
    v_cvt_pk_f16_f32 v36, v24, -v25
    v_cvt_pk_f16_f32 v37, v26, -v27
    ds_write_b64 v2, v[36:37] offset:25872
    v_pk_mul_f32 v[80:81], v[48:49], v[28:29] op_sel:[0,0] op_sel_hi:[0,1]
    v_pk_fma_f32 v[80:81], v[48:49], v[28:29], v[80:81] op_sel:[1,1,0] op_sel_hi:[1,0,1] neg_lo:[1,0,0]
    v_pk_mul_f32 v[82:83], v[50:51], v[30:31] op_sel:[0,0] op_sel_hi:[0,1]
    v_pk_fma_f32 v[82:83], v[50:51], v[30:31], v[82:83] op_sel:[1,1,0] op_sel_hi:[1,0,1] neg_lo:[1,0,0]
    v_cvt_pk_f16_f32 v38, v80, v81
    v_cvt_pk_f16_f32 v39, v82, v83
    ds_write_b64 v2, v[38:39] offset:4224
    v_pk_mul_f32 v[84:85], v[52:53], v[28:29] op_sel:[0,0] op_sel_hi:[0,1]
    v_pk_fma_f32 v[84:85], v[52:53], v[28:29], v[84:85] op_sel:[1,1,0] op_sel_hi:[1,0,1] neg_lo:[1,0,0]
    v_pk_mul_f32 v[86:87], v[54:55], v[30:31] op_sel:[0,0] op_sel_hi:[0,1]
    v_pk_fma_f32 v[86:87], v[54:55], v[30:31], v[86:87] op_sel:[1,1,0] op_sel_hi:[1,0,1] neg_lo:[1,0,0]
    v_cvt_pk_f16_f32 v40, v84, v85
    v_cvt_pk_f16_f32 v41, v86, v87
    ds_write_b64 v2, v[40:41] offset:4752
    v_pk_mul_f32 v[88:89], v[56:57], v[28:29] op_sel:[0,0] op_sel_hi:[0,1]
    v_pk_fma_f32 v[88:89], v[56:57], v[28:29], v[88:89] op_sel:[1,1,0] op_sel_hi:[1,0,1] neg_lo:[1,0,0]
    v_pk_mul_f32 v[90:91], v[58:59], v[30:31] op_sel:[0,0] op_sel_hi:[0,1]
    v_pk_fma_f32 v[90:91], v[58:59], v[30:31], v[90:91] op_sel:[1,1,0] op_sel_hi:[1,0,1] neg_lo:[1,0,0]
    v_cvt_pk_f16_f32 v42, v88, v89
    v_cvt_pk_f16_f32 v43, v90, v91
    ds_write_b64 v2, v[42:43] offset:5280
    v_pk_mul_f32 v[92:93], v[60:61], v[28:29] op_sel:[0,0] op_sel_hi:[0,1]
    v_pk_fma_f32 v[92:93], v[60:61], v[28:29], v[92:93] op_sel:[1,1,0] op_sel_hi:[1,0,1] neg_lo:[1,0,0]
    v_pk_mul_f32 v[94:95], v[62:63], v[30:31] op_sel:[0,0] op_sel_hi:[0,1]
    v_pk_fma_f32 v[94:95], v[62:63], v[30:31], v[94:95] op_sel:[1,1,0] op_sel_hi:[1,0,1] neg_lo:[1,0,0]
    v_cvt_pk_f16_f32 v36, v92, v93
    v_cvt_pk_f16_f32 v37, v94, v95
    ds_write_b64 v2, v[36:37] offset:5808
    v_pk_mul_f32 v[96:97], v[64:65], v[28:29] op_sel:[0,0] op_sel_hi:[0,1]
    v_pk_fma_f32 v[96:97], v[64:65], v[28:29], v[96:97] op_sel:[1,1,0] op_sel_hi:[1,0,1] neg_lo:[1,0,0]
    v_pk_mul_f32 v[98:99], v[66:67], v[30:31] op_sel:[0,0] op_sel_hi:[0,1]
    v_pk_fma_f32 v[98:99], v[66:67], v[30:31], v[98:99] op_sel:[1,1,0] op_sel_hi:[1,0,1] neg_lo:[1,0,0]
    v_cvt_pk_f16_f32 v38, v96, v97
    v_cvt_pk_f16_f32 v39, v98, v99
    ds_write_b64 v2, v[38:39] offset:6336
    v_pk_mul_f32 v[100:101], v[68:69], v[28:29] op_sel:[0,0] op_sel_hi:[0,1]
    v_pk_fma_f32 v[100:101], v[68:69], v[28:29], v[100:101] op_sel:[1,1,0] op_sel_hi:[1,0,1] neg_lo:[1,0,0]
    v_pk_mul_f32 v[102:103], v[70:71], v[30:31] op_sel:[0,0] op_sel_hi:[0,1]
    v_pk_fma_f32 v[102:103], v[70:71], v[30:31], v[102:103] op_sel:[1,1,0] op_sel_hi:[1,0,1] neg_lo:[1,0,0]
    v_cvt_pk_f16_f32 v40, v100, v101
    v_cvt_pk_f16_f32 v41, v102, v103
    ds_write_b64 v2, v[40:41] offset:6864
    v_pk_mul_f32 v[104:105], v[72:73], v[28:29] op_sel:[0,0] op_sel_hi:[0,1]
    v_pk_fma_f32 v[104:105], v[72:73], v[28:29], v[104:105] op_sel:[1,1,0] op_sel_hi:[1,0,1] neg_lo:[1,0,0]
    v_pk_mul_f32 v[106:107], v[74:75], v[30:31] op_sel:[0,0] op_sel_hi:[0,1]
    v_pk_fma_f32 v[106:107], v[74:75], v[30:31], v[106:107] op_sel:[1,1,0] op_sel_hi:[1,0,1] neg_lo:[1,0,0]
    v_cvt_pk_f16_f32 v42, v104, v105
    v_cvt_pk_f16_f32 v43, v106, v107
    ds_write_b64 v2, v[42:43] offset:7392
    v_pk_mul_f32 v[108:109], v[76:77], v[28:29] op_sel:[0,0] op_sel_hi:[0,1]
    v_pk_fma_f32 v[108:109], v[76:77], v[28:29], v[108:109] op_sel:[1,1,0] op_sel_hi:[1,0,1] neg_lo:[1,0,0]
    v_pk_mul_f32 v[110:111], v[78:79], v[30:31] op_sel:[0,0] op_sel_hi:[0,1]
    v_pk_fma_f32 v[110:111], v[78:79], v[30:31], v[110:111] op_sel:[1,1,0] op_sel_hi:[1,0,1] neg_lo:[1,0,0]
    v_cvt_pk_f16_f32 v36, v108, v109
    v_cvt_pk_f16_f32 v37, v110, v111
    ds_write_b64 v2, v[36:37] offset:7920
    v_pk_mul_f32 v[48:49], v[80:81], v[28:29] op_sel:[0,0] op_sel_hi:[0,1]
    v_pk_fma_f32 v[48:49], v[80:81], v[28:29], v[48:49] op_sel:[1,1,0] op_sel_hi:[1,0,1] neg_lo:[1,0,0]
    v_pk_mul_f32 v[50:51], v[82:83], v[30:31] op_sel:[0,0] op_sel_hi:[0,1]
    v_pk_fma_f32 v[50:51], v[82:83], v[30:31], v[50:51] op_sel:[1,1,0] op_sel_hi:[1,0,1] neg_lo:[1,0,0]
    v_cvt_pk_f16_f32 v38, v48, v49
    v_cvt_pk_f16_f32 v39, v50, v51
    ds_write_b64 v2, v[38:39] offset:8448
    v_pk_mul_f32 v[56:57], v[88:89], v[28:29] op_sel:[0,0] op_sel_hi:[0,1]
    v_pk_fma_f32 v[56:57], v[88:89], v[28:29], v[56:57] op_sel:[1,1,0] op_sel_hi:[1,0,1] neg_lo:[1,0,0]
    v_pk_mul_f32 v[58:59], v[90:91], v[30:31] op_sel:[0,0] op_sel_hi:[0,1]
    v_pk_fma_f32 v[58:59], v[90:91], v[30:31], v[58:59] op_sel:[1,1,0] op_sel_hi:[1,0,1] neg_lo:[1,0,0]
    v_cvt_pk_f16_f32 v40, v56, v57
    v_cvt_pk_f16_f32 v41, v58, v59
    ds_write_b64 v2, v[40:41] offset:8976
    v_pk_mul_f32 v[64:65], v[96:97], v[28:29] op_sel:[0,0] op_sel_hi:[0,1]
    v_pk_fma_f32 v[64:65], v[96:97], v[28:29], v[64:65] op_sel:[1,1,0] op_sel_hi:[1,0,1] neg_lo:[1,0,0]
    v_pk_mul_f32 v[66:67], v[98:99], v[30:31] op_sel:[0,0] op_sel_hi:[0,1]
    v_pk_fma_f32 v[66:67], v[98:99], v[30:31], v[66:67] op_sel:[1,1,0] op_sel_hi:[1,0,1] neg_lo:[1,0,0]
    v_cvt_pk_f16_f32 v42, v64, v65
    v_cvt_pk_f16_f32 v43, v66, v67
    ds_write_b64 v2, v[42:43] offset:9504
    v_pk_mul_f32 v[72:73], v[104:105], v[28:29] op_sel:[0,0] op_sel_hi:[0,1]
    v_pk_fma_f32 v[72:73], v[104:105], v[28:29], v[72:73] op_sel:[1,1,0] op_sel_hi:[1,0,1] neg_lo:[1,0,0]
    v_pk_mul_f32 v[74:75], v[106:107], v[30:31] op_sel:[0,0] op_sel_hi:[0,1]
    v_pk_fma_f32 v[74:75], v[106:107], v[30:31], v[74:75] op_sel:[1,1,0] op_sel_hi:[1,0,1] neg_lo:[1,0,0]
    v_cvt_pk_f16_f32 v36, v72, v73
    v_cvt_pk_f16_f32 v37, v74, v75
    ds_write_b64 v2, v[36:37] offset:10032
    v_pk_mul_f32 v[80:81], v[48:49], v[28:29] op_sel:[0,0] op_sel_hi:[0,1]
    v_pk_fma_f32 v[80:81], v[48:49], v[28:29], v[80:81] op_sel:[1,1,0] op_sel_hi:[1,0,1] neg_lo:[1,0,0]
    v_pk_mul_f32 v[82:83], v[50:51], v[30:31] op_sel:[0,0] op_sel_hi:[0,1]
    v_pk_fma_f32 v[82:83], v[50:51], v[30:31], v[82:83] op_sel:[1,1,0] op_sel_hi:[1,0,1] neg_lo:[1,0,0]
    v_cvt_pk_f16_f32 v38, v80, v81
    v_cvt_pk_f16_f32 v39, v82, v83
    ds_write_b64 v2, v[38:39] offset:10560
    v_pk_mul_f32 v[88:89], v[56:57], v[28:29] op_sel:[0,0] op_sel_hi:[0,1]
    v_pk_fma_f32 v[88:89], v[56:57], v[28:29], v[88:89] op_sel:[1,1,0] op_sel_hi:[1,0,1] neg_lo:[1,0,0]
    v_pk_mul_f32 v[90:91], v[58:59], v[30:31] op_sel:[0,0] op_sel_hi:[0,1]
    v_pk_fma_f32 v[90:91], v[58:59], v[30:31], v[90:91] op_sel:[1,1,0] op_sel_hi:[1,0,1] neg_lo:[1,0,0]
    v_cvt_pk_f16_f32 v40, v88, v89
    v_cvt_pk_f16_f32 v41, v90, v91
    ds_write_b64 v2, v[40:41] offset:11088
    v_pk_mul_f32 v[96:97], v[64:65], v[28:29] op_sel:[0,0] op_sel_hi:[0,1]
    v_pk_fma_f32 v[96:97], v[64:65], v[28:29], v[96:97] op_sel:[1,1,0] op_sel_hi:[1,0,1] neg_lo:[1,0,0]
    v_pk_mul_f32 v[98:99], v[66:67], v[30:31] op_sel:[0,0] op_sel_hi:[0,1]
    v_pk_fma_f32 v[98:99], v[66:67], v[30:31], v[98:99] op_sel:[1,1,0] op_sel_hi:[1,0,1] neg_lo:[1,0,0]
    v_cvt_pk_f16_f32 v42, v96, v97
    v_cvt_pk_f16_f32 v43, v98, v99
    ds_write_b64 v2, v[42:43] offset:11616
    v_pk_mul_f32 v[104:105], v[72:73], v[28:29] op_sel:[0,0] op_sel_hi:[0,1]
    v_pk_fma_f32 v[104:105], v[72:73], v[28:29], v[104:105] op_sel:[1,1,0] op_sel_hi:[1,0,1] neg_lo:[1,0,0]
    v_pk_mul_f32 v[106:107], v[74:75], v[30:31] op_sel:[0,0] op_sel_hi:[0,1]
    v_pk_fma_f32 v[106:107], v[74:75], v[30:31], v[106:107] op_sel:[1,1,0] op_sel_hi:[1,0,1] neg_lo:[1,0,0]
    v_cvt_pk_f16_f32 v36, v104, v105
    v_cvt_pk_f16_f32 v37, v106, v107
    ds_write_b64 v2, v[36:37] offset:12144
    v_pk_mul_f32 v[48:49], v[80:81], v[28:29] op_sel:[0,0] op_sel_hi:[0,1]
    v_pk_fma_f32 v[48:49], v[80:81], v[28:29], v[48:49] op_sel:[1,1,0] op_sel_hi:[1,0,1] neg_lo:[1,0,0]
    v_pk_mul_f32 v[50:51], v[82:83], v[30:31] op_sel:[0,0] op_sel_hi:[0,1]
    v_pk_fma_f32 v[50:51], v[82:83], v[30:31], v[50:51] op_sel:[1,1,0] op_sel_hi:[1,0,1] neg_lo:[1,0,0]
    v_cvt_pk_f16_f32 v38, v48, v49
    v_cvt_pk_f16_f32 v39, v50, v51
    ds_write_b64 v2, v[38:39] offset:12672
    v_pk_mul_f32 v[64:65], v[96:97], v[28:29] op_sel:[0,0] op_sel_hi:[0,1]
    v_pk_fma_f32 v[64:65], v[96:97], v[28:29], v[64:65] op_sel:[1,1,0] op_sel_hi:[1,0,1] neg_lo:[1,0,0]
    v_pk_mul_f32 v[66:67], v[98:99], v[30:31] op_sel:[0,0] op_sel_hi:[0,1]
    v_pk_fma_f32 v[66:67], v[98:99], v[30:31], v[66:67] op_sel:[1,1,0] op_sel_hi:[1,0,1] neg_lo:[1,0,0]
    v_cvt_pk_f16_f32 v40, v64, v65
    v_cvt_pk_f16_f32 v41, v66, v67
    ds_write_b64 v2, v[40:41] offset:14784
    v_pk_mul_f32 v[112:113], v[24:25], v[24:25] op_sel:[0,0] op_sel_hi:[0,1]
    v_pk_fma_f32 v[112:113], v[24:25], v[24:25], v[112:113] op_sel:[1,1,0] op_sel_hi:[1,0,1] neg_lo:[1,0,0]
    v_pk_mul_f32 v[114:115], v[26:27], v[26:27] op_sel:[0,0] op_sel_hi:[0,1]
    v_pk_fma_f32 v[114:115], v[26:27], v[26:27], v[114:115] op_sel:[1,1,0] op_sel_hi:[1,0,1] neg_lo:[1,0,0]
    v_cvt_pk_f16_f32 v42, v112, -v113
    v_cvt_pk_f16_f32 v43, v114, -v115
    ds_write_b64 v2, v[42:43] offset:26400
    v_pk_mul_f32 v[80:81], v[48:49], v[28:29] op_sel:[0,0] op_sel_hi:[0,1]
    v_pk_fma_f32 v[80:81], v[48:49], v[28:29], v[80:81] op_sel:[1,1,0] op_sel_hi:[1,0,1] neg_lo:[1,0,0]
    v_pk_mul_f32 v[82:83], v[50:51], v[30:31] op_sel:[0,0] op_sel_hi:[0,1]
    v_pk_fma_f32 v[82:83], v[50:51], v[30:31], v[82:83] op_sel:[1,1,0] op_sel_hi:[1,0,1] neg_lo:[1,0,0]
    v_cvt_pk_f16_f32 v36, v80, v81
    v_cvt_pk_f16_f32 v37, v82, v83
    ds_write_b64 v2, v[36:37] offset:13200
    v_pk_mul_f32 v[96:97], v[64:65], v[28:29] op_sel:[0,0] op_sel_hi:[0,1]
    v_pk_fma_f32 v[96:97], v[64:65], v[28:29], v[96:97] op_sel:[1,1,0] op_sel_hi:[1,0,1] neg_lo:[1,0,0]
    v_pk_mul_f32 v[98:99], v[66:67], v[30:31] op_sel:[0,0] op_sel_hi:[0,1]
    v_pk_fma_f32 v[98:99], v[66:67], v[30:31], v[98:99] op_sel:[1,1,0] op_sel_hi:[1,0,1] neg_lo:[1,0,0]
    v_cvt_pk_f16_f32 v38, v96, v97
    v_cvt_pk_f16_f32 v39, v98, v99
    ds_write_b64 v2, v[38:39] offset:15312
    v_pk_mul_f32 v[116:117], v[112:113], v[24:25] op_sel:[0,0] op_sel_hi:[0,1]
    v_pk_fma_f32 v[116:117], v[112:113], v[24:25], v[116:117] op_sel:[1,1,0] op_sel_hi:[1,0,1] neg_lo:[1,0,0]
    v_pk_mul_f32 v[118:119], v[114:115], v[26:27] op_sel:[0,0] op_sel_hi:[0,1]
    v_pk_fma_f32 v[118:119], v[114:115], v[26:27], v[118:119] op_sel:[1,1,0] op_sel_hi:[1,0,1] neg_lo:[1,0,0]
    v_cvt_pk_f16_f32 v40, v116, -v117
    v_cvt_pk_f16_f32 v41, v118, -v119
    ds_write_b64 v2, v[40:41] offset:26928
    v_pk_mul_f32 v[48:49], v[80:81], v[28:29] op_sel:[0,0] op_sel_hi:[0,1]
    v_pk_fma_f32 v[48:49], v[80:81], v[28:29], v[48:49] op_sel:[1,1,0] op_sel_hi:[1,0,1] neg_lo:[1,0,0]
    v_pk_mul_f32 v[50:51], v[82:83], v[30:31] op_sel:[0,0] op_sel_hi:[0,1]
    v_pk_fma_f32 v[50:51], v[82:83], v[30:31], v[50:51] op_sel:[1,1,0] op_sel_hi:[1,0,1] neg_lo:[1,0,0]
    v_cvt_pk_f16_f32 v42, v48, v49
    v_cvt_pk_f16_f32 v43, v50, v51
    ds_write_b64 v2, v[42:43] offset:13728
    v_pk_mul_f32 v[64:65], v[96:97], v[28:29] op_sel:[0,0] op_sel_hi:[0,1]
    v_pk_fma_f32 v[64:65], v[96:97], v[28:29], v[64:65] op_sel:[1,1,0] op_sel_hi:[1,0,1] neg_lo:[1,0,0]
    v_pk_mul_f32 v[66:67], v[98:99], v[30:31] op_sel:[0,0] op_sel_hi:[0,1]
    v_pk_fma_f32 v[66:67], v[98:99], v[30:31], v[66:67] op_sel:[1,1,0] op_sel_hi:[1,0,1] neg_lo:[1,0,0]
    v_cvt_pk_f16_f32 v36, v64, v65
    v_cvt_pk_f16_f32 v37, v66, v67
    ds_write_b64 v2, v[36:37] offset:15840
    v_pk_mul_f32 v[112:113], v[116:117], v[24:25] op_sel:[0,0] op_sel_hi:[0,1]
    v_pk_fma_f32 v[112:113], v[116:117], v[24:25], v[112:113] op_sel:[1,1,0] op_sel_hi:[1,0,1] neg_lo:[1,0,0]
    v_pk_mul_f32 v[114:115], v[118:119], v[26:27] op_sel:[0,0] op_sel_hi:[0,1]
    v_pk_fma_f32 v[114:115], v[118:119], v[26:27], v[114:115] op_sel:[1,1,0] op_sel_hi:[1,0,1] neg_lo:[1,0,0]
    v_cvt_pk_f16_f32 v38, v112, -v113
    v_cvt_pk_f16_f32 v39, v114, -v115
    ds_write_b64 v2, v[38:39] offset:27456
    v_pk_mul_f32 v[80:81], v[48:49], v[28:29] op_sel:[0,0] op_sel_hi:[0,1]
    v_pk_fma_f32 v[80:81], v[48:49], v[28:29], v[80:81] op_sel:[1,1,0] op_sel_hi:[1,0,1] neg_lo:[1,0,0]
    v_pk_mul_f32 v[82:83], v[50:51], v[30:31] op_sel:[0,0] op_sel_hi:[0,1]
    v_pk_fma_f32 v[82:83], v[50:51], v[30:31], v[82:83] op_sel:[1,1,0] op_sel_hi:[1,0,1] neg_lo:[1,0,0]
    v_cvt_pk_f16_f32 v40, v80, v81
    v_cvt_pk_f16_f32 v41, v82, v83
    ds_write_b64 v2, v[40:41] offset:14256
    v_pk_mul_f32 v[96:97], v[64:65], v[28:29] op_sel:[0,0] op_sel_hi:[0,1]
    v_pk_fma_f32 v[96:97], v[64:65], v[28:29], v[96:97] op_sel:[1,1,0] op_sel_hi:[1,0,1] neg_lo:[1,0,0]
    v_pk_mul_f32 v[98:99], v[66:67], v[30:31] op_sel:[0,0] op_sel_hi:[0,1]
    v_pk_fma_f32 v[98:99], v[66:67], v[30:31], v[98:99] op_sel:[1,1,0] op_sel_hi:[1,0,1] neg_lo:[1,0,0]
    v_cvt_pk_f16_f32 v42, v96, v97
    v_cvt_pk_f16_f32 v43, v98, v99
    ds_write_b64 v2, v[42:43] offset:16368
    v_pk_mul_f32 v[116:117], v[112:113], v[24:25] op_sel:[0,0] op_sel_hi:[0,1]
    v_pk_fma_f32 v[116:117], v[112:113], v[24:25], v[116:117] op_sel:[1,1,0] op_sel_hi:[1,0,1] neg_lo:[1,0,0]
    v_pk_mul_f32 v[118:119], v[114:115], v[26:27] op_sel:[0,0] op_sel_hi:[0,1]
    v_pk_fma_f32 v[118:119], v[114:115], v[26:27], v[118:119] op_sel:[1,1,0] op_sel_hi:[1,0,1] neg_lo:[1,0,0]
    v_cvt_pk_f16_f32 v36, v116, -v117
    v_cvt_pk_f16_f32 v37, v118, -v119
    ds_write_b64 v2, v[36:37] offset:27984
    v_pk_mul_f32 v[48:49], v[80:81], v[28:29] op_sel:[0,0] op_sel_hi:[0,1]
    v_pk_fma_f32 v[48:49], v[80:81], v[28:29], v[48:49] op_sel:[1,1,0] op_sel_hi:[1,0,1] neg_lo:[1,0,0]
    v_pk_mul_f32 v[50:51], v[82:83], v[30:31] op_sel:[0,0] op_sel_hi:[0,1]
    v_pk_fma_f32 v[50:51], v[82:83], v[30:31], v[50:51] op_sel:[1,1,0] op_sel_hi:[1,0,1] neg_lo:[1,0,0]
    v_cvt_pk_f16_f32 v38, v48, v49
    v_cvt_pk_f16_f32 v39, v50, v51
    ds_write_b64 v2, v[38:39] offset:16896
    v_pk_mul_f32 v[112:113], v[116:117], v[24:25] op_sel:[0,0] op_sel_hi:[0,1]
    v_pk_fma_f32 v[112:113], v[116:117], v[24:25], v[112:113] op_sel:[1,1,0] op_sel_hi:[1,0,1] neg_lo:[1,0,0]
    v_pk_mul_f32 v[114:115], v[118:119], v[26:27] op_sel:[0,0] op_sel_hi:[0,1]
    v_pk_fma_f32 v[114:115], v[118:119], v[26:27], v[114:115] op_sel:[1,1,0] op_sel_hi:[1,0,1] neg_lo:[1,0,0]
    v_cvt_pk_f16_f32 v40, v112, -v113
    v_cvt_pk_f16_f32 v41, v114, -v115
    ds_write_b64 v2, v[40:41] offset:28512
    v_pk_mul_f32 v[80:81], v[48:49], v[28:29] op_sel:[0,0] op_sel_hi:[0,1]
    v_pk_fma_f32 v[80:81], v[48:49], v[28:29], v[80:81] op_sel:[1,1,0] op_sel_hi:[1,0,1] neg_lo:[1,0,0]
    v_pk_mul_f32 v[82:83], v[50:51], v[30:31] op_sel:[0,0] op_sel_hi:[0,1]
    v_pk_fma_f32 v[82:83], v[50:51], v[30:31], v[82:83] op_sel:[1,1,0] op_sel_hi:[1,0,1] neg_lo:[1,0,0]
    v_cvt_pk_f16_f32 v42, v80, v81
    v_cvt_pk_f16_f32 v43, v82, v83
    ds_write_b64 v2, v[42:43] offset:17424
    v_pk_mul_f32 v[116:117], v[112:113], v[24:25] op_sel:[0,0] op_sel_hi:[0,1]
    v_pk_fma_f32 v[116:117], v[112:113], v[24:25], v[116:117] op_sel:[1,1,0] op_sel_hi:[1,0,1] neg_lo:[1,0,0]
    v_pk_mul_f32 v[118:119], v[114:115], v[26:27] op_sel:[0,0] op_sel_hi:[0,1]
    v_pk_fma_f32 v[118:119], v[114:115], v[26:27], v[118:119] op_sel:[1,1,0] op_sel_hi:[1,0,1] neg_lo:[1,0,0]
    v_cvt_pk_f16_f32 v36, v116, -v117
    v_cvt_pk_f16_f32 v37, v118, -v119
    ds_write_b64 v2, v[36:37] offset:29040
    v_pk_mul_f32 v[48:49], v[80:81], v[28:29] op_sel:[0,0] op_sel_hi:[0,1]
    v_pk_fma_f32 v[48:49], v[80:81], v[28:29], v[48:49] op_sel:[1,1,0] op_sel_hi:[1,0,1] neg_lo:[1,0,0]
    v_pk_mul_f32 v[50:51], v[82:83], v[30:31] op_sel:[0,0] op_sel_hi:[0,1]
    v_pk_fma_f32 v[50:51], v[82:83], v[30:31], v[50:51] op_sel:[1,1,0] op_sel_hi:[1,0,1] neg_lo:[1,0,0]
    v_cvt_pk_f16_f32 v38, v48, v49
    v_cvt_pk_f16_f32 v39, v50, v51
    ds_write_b64 v2, v[38:39] offset:17952
    v_pk_mul_f32 v[112:113], v[116:117], v[24:25] op_sel:[0,0] op_sel_hi:[0,1]
    v_pk_fma_f32 v[112:113], v[116:117], v[24:25], v[112:113] op_sel:[1,1,0] op_sel_hi:[1,0,1] neg_lo:[1,0,0]
    v_pk_mul_f32 v[114:115], v[118:119], v[26:27] op_sel:[0,0] op_sel_hi:[0,1]
    v_pk_fma_f32 v[114:115], v[118:119], v[26:27], v[114:115] op_sel:[1,1,0] op_sel_hi:[1,0,1] neg_lo:[1,0,0]
    v_cvt_pk_f16_f32 v40, v112, -v113
    v_cvt_pk_f16_f32 v41, v114, -v115
    ds_write_b64 v2, v[40:41] offset:29568
    v_pk_mul_f32 v[80:81], v[48:49], v[28:29] op_sel:[0,0] op_sel_hi:[0,1]
    v_pk_fma_f32 v[80:81], v[48:49], v[28:29], v[80:81] op_sel:[1,1,0] op_sel_hi:[1,0,1] neg_lo:[1,0,0]
    v_pk_mul_f32 v[82:83], v[50:51], v[30:31] op_sel:[0,0] op_sel_hi:[0,1]
    v_pk_fma_f32 v[82:83], v[50:51], v[30:31], v[82:83] op_sel:[1,1,0] op_sel_hi:[1,0,1] neg_lo:[1,0,0]
    v_cvt_pk_f16_f32 v42, v80, v81
    v_cvt_pk_f16_f32 v43, v82, v83
    ds_write_b64 v2, v[42:43] offset:18480
    v_pk_mul_f32 v[116:117], v[112:113], v[24:25] op_sel:[0,0] op_sel_hi:[0,1]
    v_pk_fma_f32 v[116:117], v[112:113], v[24:25], v[116:117] op_sel:[1,1,0] op_sel_hi:[1,0,1] neg_lo:[1,0,0]
    v_pk_mul_f32 v[118:119], v[114:115], v[26:27] op_sel:[0,0] op_sel_hi:[0,1]
    v_pk_fma_f32 v[118:119], v[114:115], v[26:27], v[118:119] op_sel:[1,1,0] op_sel_hi:[1,0,1] neg_lo:[1,0,0]
    v_cvt_pk_f16_f32 v36, v116, -v117
    v_cvt_pk_f16_f32 v37, v118, -v119
    ds_write_b64 v2, v[36:37] offset:30096
    v_pk_mul_f32 v[48:49], v[80:81], v[28:29] op_sel:[0,0] op_sel_hi:[0,1]
    v_pk_fma_f32 v[48:49], v[80:81], v[28:29], v[48:49] op_sel:[1,1,0] op_sel_hi:[1,0,1] neg_lo:[1,0,0]
    v_pk_mul_f32 v[50:51], v[82:83], v[30:31] op_sel:[0,0] op_sel_hi:[0,1]
    v_pk_fma_f32 v[50:51], v[82:83], v[30:31], v[50:51] op_sel:[1,1,0] op_sel_hi:[1,0,1] neg_lo:[1,0,0]
    v_cvt_pk_f16_f32 v38, v48, v49
    v_cvt_pk_f16_f32 v39, v50, v51
    ds_write_b64 v2, v[38:39] offset:19008
    v_pk_mul_f32 v[112:113], v[116:117], v[24:25] op_sel:[0,0] op_sel_hi:[0,1]
    v_pk_fma_f32 v[112:113], v[116:117], v[24:25], v[112:113] op_sel:[1,1,0] op_sel_hi:[1,0,1] neg_lo:[1,0,0]
    v_pk_mul_f32 v[114:115], v[118:119], v[26:27] op_sel:[0,0] op_sel_hi:[0,1]
    v_pk_fma_f32 v[114:115], v[118:119], v[26:27], v[114:115] op_sel:[1,1,0] op_sel_hi:[1,0,1] neg_lo:[1,0,0]
    v_cvt_pk_f16_f32 v40, v112, -v113
    v_cvt_pk_f16_f32 v41, v114, -v115
    ds_write_b64 v2, v[40:41] offset:30624
    v_pk_mul_f32 v[80:81], v[48:49], v[28:29] op_sel:[0,0] op_sel_hi:[0,1]
    v_pk_fma_f32 v[80:81], v[48:49], v[28:29], v[80:81] op_sel:[1,1,0] op_sel_hi:[1,0,1] neg_lo:[1,0,0]
    v_pk_mul_f32 v[82:83], v[50:51], v[30:31] op_sel:[0,0] op_sel_hi:[0,1]
    v_pk_fma_f32 v[82:83], v[50:51], v[30:31], v[82:83] op_sel:[1,1,0] op_sel_hi:[1,0,1] neg_lo:[1,0,0]
    v_cvt_pk_f16_f32 v42, v80, v81
    v_cvt_pk_f16_f32 v43, v82, v83
    ds_write_b64 v2, v[42:43] offset:19536
    v_pk_mul_f32 v[116:117], v[112:113], v[24:25] op_sel:[0,0] op_sel_hi:[0,1]
    v_pk_fma_f32 v[116:117], v[112:113], v[24:25], v[116:117] op_sel:[1,1,0] op_sel_hi:[1,0,1] neg_lo:[1,0,0]
    v_pk_mul_f32 v[118:119], v[114:115], v[26:27] op_sel:[0,0] op_sel_hi:[0,1]
    v_pk_fma_f32 v[118:119], v[114:115], v[26:27], v[118:119] op_sel:[1,1,0] op_sel_hi:[1,0,1] neg_lo:[1,0,0]
    v_cvt_pk_f16_f32 v36, v116, -v117
    v_cvt_pk_f16_f32 v37, v118, -v119
    ds_write_b64 v2, v[36:37] offset:31152
    v_pk_mul_f32 v[48:49], v[80:81], v[28:29] op_sel:[0,0] op_sel_hi:[0,1]
    v_pk_fma_f32 v[48:49], v[80:81], v[28:29], v[48:49] op_sel:[1,1,0] op_sel_hi:[1,0,1] neg_lo:[1,0,0]
    v_pk_mul_f32 v[50:51], v[82:83], v[30:31] op_sel:[0,0] op_sel_hi:[0,1]
    v_pk_fma_f32 v[50:51], v[82:83], v[30:31], v[50:51] op_sel:[1,1,0] op_sel_hi:[1,0,1] neg_lo:[1,0,0]
    v_cvt_pk_f16_f32 v38, v48, v49
    v_cvt_pk_f16_f32 v39, v50, v51
    ds_write_b64 v2, v[38:39] offset:20064
    v_pk_mul_f32 v[112:113], v[116:117], v[24:25] op_sel:[0,0] op_sel_hi:[0,1]
    v_pk_fma_f32 v[112:113], v[116:117], v[24:25], v[112:113] op_sel:[1,1,0] op_sel_hi:[1,0,1] neg_lo:[1,0,0]
    v_pk_mul_f32 v[114:115], v[118:119], v[26:27] op_sel:[0,0] op_sel_hi:[0,1]
    v_pk_fma_f32 v[114:115], v[118:119], v[26:27], v[114:115] op_sel:[1,1,0] op_sel_hi:[1,0,1] neg_lo:[1,0,0]
    v_cvt_pk_f16_f32 v40, v112, -v113
    v_cvt_pk_f16_f32 v41, v114, -v115
    ds_write_b64 v2, v[40:41] offset:31680
    v_pk_mul_f32 v[80:81], v[48:49], v[28:29] op_sel:[0,0] op_sel_hi:[0,1]
    v_pk_fma_f32 v[80:81], v[48:49], v[28:29], v[80:81] op_sel:[1,1,0] op_sel_hi:[1,0,1] neg_lo:[1,0,0]
    v_pk_mul_f32 v[82:83], v[50:51], v[30:31] op_sel:[0,0] op_sel_hi:[0,1]
    v_pk_fma_f32 v[82:83], v[50:51], v[30:31], v[82:83] op_sel:[1,1,0] op_sel_hi:[1,0,1] neg_lo:[1,0,0]
    v_cvt_pk_f16_f32 v42, v80, v81
    v_cvt_pk_f16_f32 v43, v82, v83
    ds_write_b64 v2, v[42:43] offset:20592
    v_pk_mul_f32 v[116:117], v[112:113], v[24:25] op_sel:[0,0] op_sel_hi:[0,1]
    v_pk_fma_f32 v[116:117], v[112:113], v[24:25], v[116:117] op_sel:[1,1,0] op_sel_hi:[1,0,1] neg_lo:[1,0,0]
    v_pk_mul_f32 v[118:119], v[114:115], v[26:27] op_sel:[0,0] op_sel_hi:[0,1]
    v_pk_fma_f32 v[118:119], v[114:115], v[26:27], v[118:119] op_sel:[1,1,0] op_sel_hi:[1,0,1] neg_lo:[1,0,0]
    v_cvt_pk_f16_f32 v36, v116, -v117
    v_cvt_pk_f16_f32 v37, v118, -v119
    ds_write_b64 v2, v[36:37] offset:32208
    v_pk_mul_f32 v[48:49], v[80:81], v[28:29] op_sel:[0,0] op_sel_hi:[0,1]
    v_pk_fma_f32 v[48:49], v[80:81], v[28:29], v[48:49] op_sel:[1,1,0] op_sel_hi:[1,0,1] neg_lo:[1,0,0]
    v_pk_mul_f32 v[50:51], v[82:83], v[30:31] op_sel:[0,0] op_sel_hi:[0,1]
    v_pk_fma_f32 v[50:51], v[82:83], v[30:31], v[50:51] op_sel:[1,1,0] op_sel_hi:[1,0,1] neg_lo:[1,0,0]
    v_cvt_pk_f16_f32 v38, v48, v49
    v_cvt_pk_f16_f32 v39, v50, v51
    ds_write_b64 v2, v[38:39] offset:21120
    v_pk_mul_f32 v[112:113], v[116:117], v[24:25] op_sel:[0,0] op_sel_hi:[0,1]
    v_pk_fma_f32 v[112:113], v[116:117], v[24:25], v[112:113] op_sel:[1,1,0] op_sel_hi:[1,0,1] neg_lo:[1,0,0]
    v_pk_mul_f32 v[114:115], v[118:119], v[26:27] op_sel:[0,0] op_sel_hi:[0,1]
    v_pk_fma_f32 v[114:115], v[118:119], v[26:27], v[114:115] op_sel:[1,1,0] op_sel_hi:[1,0,1] neg_lo:[1,0,0]
    v_cvt_pk_f16_f32 v40, v112, -v113
    v_cvt_pk_f16_f32 v41, v114, -v115
    ds_write_b64 v2, v[40:41] offset:32736
    v_pk_mul_f32 v[116:117], v[112:113], v[24:25] op_sel:[0,0] op_sel_hi:[0,1]
    v_pk_fma_f32 v[116:117], v[112:113], v[24:25], v[116:117] op_sel:[1,1,0] op_sel_hi:[1,0,1] neg_lo:[1,0,0]
    v_pk_mul_f32 v[118:119], v[114:115], v[26:27] op_sel:[0,0] op_sel_hi:[0,1]
    v_pk_fma_f32 v[118:119], v[114:115], v[26:27], v[118:119] op_sel:[1,1,0] op_sel_hi:[1,0,1] neg_lo:[1,0,0]
    v_cvt_pk_f16_f32 v42, v116, -v117
    v_cvt_pk_f16_f32 v43, v118, -v119
    ds_write_b64 v2, v[42:43] offset:33264
    v_and_b32 v3, 15, v0
    v_lshrrev_b32 v4, 4, v0
    v_mul_u32_u24 v5, 528, v3
    v_lshl_add_u32 v5, v4, 4, v5
    v_add_u32 v5, s15, v5
    s_waitcnt lgkmcnt(0)
    ds_read_b128 v[48:51], v5 offset:0
    ds_read_b128 v[52:55], v5 offset:8448
    ds_read_b128 v[56:59], v5 offset:16896
    ds_read_b128 v[60:63], v5 offset:25344
    ds_read_b128 v[64:67], v5 offset:64
    ds_read_b128 v[68:71], v5 offset:8512
    ds_read_b128 v[72:75], v5 offset:16960
    ds_read_b128 v[76:79], v5 offset:25408
    ds_read_b128 v[80:83], v5 offset:128
    ds_read_b128 v[84:87], v5 offset:8576
    ds_read_b128 v[88:91], v5 offset:17024
    ds_read_b128 v[92:95], v5 offset:25472
    ds_read_b128 v[96:99], v5 offset:192
    ds_read_b128 v[100:103], v5 offset:8640
    ds_read_b128 v[104:107], v5 offset:17088
    ds_read_b128 v[108:111], v5 offset:25536
    ds_read_b128 v[112:115], v5 offset:256
    ds_read_b128 v[116:119], v5 offset:8704
    ds_read_b128 v[120:123], v5 offset:17152
    ds_read_b128 v[124:127], v5 offset:25600
    ds_read_b128 v[128:131], v5 offset:320
    ds_read_b128 v[132:135], v5 offset:8768
    ds_read_b128 v[136:139], v5 offset:17216
    ds_read_b128 v[140:143], v5 offset:25664
    ds_read_b128 v[144:147], v5 offset:384
    ds_read_b128 v[148:151], v5 offset:8832
    ds_read_b128 v[152:155], v5 offset:17280
    ds_read_b128 v[156:159], v5 offset:25728
    ds_read_b128 v[160:163], v5 offset:448
    ds_read_b128 v[164:167], v5 offset:8896
    ds_read_b128 v[168:171], v5 offset:17344
    ds_read_b128 v[172:175], v5 offset:25792
    s_waitcnt lgkmcnt(15)
    v_mfma_f32_16x16x32_f16 v[20:23], v[48:51], v[60:63], 0
    v_mfma_f32_16x16x32_f16 v[24:27], v[52:55], v[60:63], 0
    v_mfma_f32_16x16x32_f16 v[28:31], v[56:59], v[60:63], 0
    s_waitcnt lgkmcnt(15)
    v_mfma_f32_16x16x32_f16 v[20:23], v[64:67], v[76:79], v[20:23]
    v_mfma_f32_16x16x32_f16 v[24:27], v[68:71], v[76:79], v[24:27]
    v_mfma_f32_16x16x32_f16 v[28:31], v[72:75], v[76:79], v[28:31]
    s_waitcnt lgkmcnt(15)
    v_mfma_f32_16x16x32_f16 v[20:23], v[80:83], v[92:95], v[20:23]
    v_mfma_f32_16x16x32_f16 v[24:27], v[84:87], v[92:95], v[24:27]
    v_mfma_f32_16x16x32_f16 v[28:31], v[88:91], v[92:95], v[28:31]
    s_waitcnt lgkmcnt(15)
    v_mfma_f32_16x16x32_f16 v[20:23], v[96:99], v[108:111], v[20:23]
    v_mfma_f32_16x16x32_f16 v[24:27], v[100:103], v[108:111], v[24:27]
    v_mfma_f32_16x16x32_f16 v[28:31], v[104:107], v[108:111], v[28:31]
    s_waitcnt lgkmcnt(12)
    v_mfma_f32_16x16x32_f16 v[20:23], v[112:115], v[124:127], v[20:23]
    v_mfma_f32_16x16x32_f16 v[24:27], v[116:119], v[124:127], v[24:27]
    v_mfma_f32_16x16x32_f16 v[28:31], v[120:123], v[124:127], v[28:31]
    s_waitcnt lgkmcnt(8)
    v_mfma_f32_16x16x32_f16 v[20:23], v[128:131], v[140:143], v[20:23]
    v_mfma_f32_16x16x32_f16 v[24:27], v[132:135], v[140:143], v[24:27]
    v_mfma_f32_16x16x32_f16 v[28:31], v[136:139], v[140:143], v[28:31]
    s_waitcnt lgkmcnt(4)
    v_mfma_f32_16x16x32_f16 v[20:23], v[144:147], v[156:159], v[20:23]
    v_mfma_f32_16x16x32_f16 v[24:27], v[148:151], v[156:159], v[24:27]
    v_mfma_f32_16x16x32_f16 v[28:31], v[152:155], v[156:159], v[28:31]
    s_waitcnt lgkmcnt(0)
    v_mfma_f32_16x16x32_f16 v[20:23], v[160:163], v[172:175], v[20:23]
    v_mfma_f32_16x16x32_f16 v[24:27], v[164:167], v[172:175], v[24:27]
    v_mfma_f32_16x16x32_f16 v[28:31], v[168:171], v[172:175], v[28:31]
    v_lshrrev_b32 v32, 1, v4
    v_lshlrev_b32 v32, 7, v32
    v_and_b32 v33, 1, v4
    v_lshl_add_u32 v32, v33, 2, v32
    v_cmp_gt_u32 vcc, 2, v4
    v_lshlrev_b32 v34, 7, v4
    v_add_u32 v34, 256, v34
    v_lshlrev_b32 v35, 2, v4
    v_add_u32 v35, 504, v35
    v_cndmask_b32 v34, v35, v34, vcc
    v_mov_b32 v35, 128
    v_cndmask_b32 v35, v35, 2, vcc
    v_lshlrev_b32 v36, 9, v4
    v_add_u32 v36, 1024, v36
    v_mov_b32 v37, 128
    v_cmp_eq_u32 vcc, 3, v4
    v_mov_b32 v38, 2176
    s_nop 0
    v_cndmask_b32 v36, v36, v38, vcc
    v_cndmask_b32 v37, v37, 0, vcc
    s_add_u32 s34, s15, 33280
    v_lshl_add_u32 v32, v3, 3, v32
    v_lshl_add_u32 v32, v32, 1, s34
    v_lshl_add_u32 v34, v3, 3, v34
    v_lshl_add_u32 v34, v34, 1, s34
    v_lshl_add_u32 v36, v3, 3, v36
    v_lshl_add_u32 v36, v36, 1, s34
    v_lshlrev_b32 v35, 1, v35
    v_lshlrev_b32 v37, 1, v37
    v_mul_f32 v20, v19, v20
    v_cvt_pk_bf16_f32 v20, v20, v20
    v_mul_f32 v21, v19, v21
    v_cvt_pk_bf16_f32 v21, v21, v21
    v_mul_f32 v22, v19, v22
    v_cvt_pk_bf16_f32 v22, v22, v22
    v_mul_f32 v23, v19, v23
    v_cvt_pk_bf16_f32 v23, v23, v23
    v_mul_f32 v24, v19, v24
    v_cvt_pk_bf16_f32 v24, v24, v24
    v_mul_f32 v25, v19, v25
    v_cvt_pk_bf16_f32 v25, v25, v25
    v_mul_f32 v26, v19, v26
    v_cvt_pk_bf16_f32 v26, v26, v26
    v_mul_f32 v27, v19, v27
    v_cvt_pk_bf16_f32 v27, v27, v27
    v_mul_f32 v28, v19, v28
    v_cvt_pk_bf16_f32 v28, v28, v28
    v_mul_f32 v29, v19, v29
    v_cvt_pk_bf16_f32 v29, v29, v29
    v_mul_f32 v30, v19, v30
    v_cvt_pk_bf16_f32 v30, v30, v30
    v_mul_f32 v31, v19, v31
    v_cvt_pk_bf16_f32 v31, v31, v31
    ds_write_b16 v32, v20 offset:0
    ds_write_b16 v34, v24
    ds_write_b16 v36, v28
    v_add_u32 v34, v34, v35
    v_add_u32 v36, v36, v37
    ds_write_b16 v32, v21 offset:2
    ds_write_b16 v34, v25
    ds_write_b16 v36, v29
    v_add_u32 v34, v34, v35
    v_add_u32 v36, v36, v37
    ds_write_b16 v32, v22 offset:4
    ds_write_b16 v34, v26
    ds_write_b16 v36, v30
    v_add_u32 v34, v34, v35
    v_add_u32 v36, v36, v37
    ds_write_b16 v32, v23 offset:6
    ds_write_b16 v34, v27
    ds_write_b16 v36, v31
    v_sub_u32 v6, 255, v0
    v_lshl_add_u32 v6, v6, 4, s34
    v_add_u32 v6, 4294964224, v6
    v_cmp_gt_u32 vcc, 32, v0
    s_nop 1
    v_cndmask_b32 v7, 0, 2, vcc
    v_sub_u32 v10, v6, v7
    v_add_u32 v11, v6, v7
    s_waitcnt lgkmcnt(0)
    v_max_u32 v15, 32, v0
    v_lshl_add_u32 v15, v15, 6, s34
    v_mov_b32 v14, s34
    ds_read_u16 v80, v15 offset:16
    ds_read_u16 v81, v15 offset:32
    ds_read_u16 v82, v15 offset:48
    ds_read_u16 v83, v15 offset:64
    ds_read_u16 v47, v14 offset:2048
    ds_read_u16 v84, v6 offset:1024
    ds_read_u16 v85, v6 offset:1032
    ds_read_u16 v86, v6 offset:1040
    ds_read_u16 v72, v11 offset:14
    ds_read_u16 v76, v6 offset:12
    ds_read_u16 v73, v10 offset:10
    ds_read_u16 v77, v6 offset:8
    ds_read_u16 v74, v11 offset:6
    ds_read_u16 v78, v6 offset:4
    ds_read_u16 v75, v10 offset:2
    ds_read_u16 v79, v6 offset:0
    v_and_b32 v12, 7, v0
    v_lshlrev_b32 v13, 4, v0
    v_add_u32 v13, s15, v13
    v_lshl_add_u32 v16, v12, 4, s15
    v_lshlrev_b32 v17, 3, v0
    v_add_u32 v17, s15, v17
    s_waitcnt lgkmcnt(0)
    v_lshl_or_b32 v80, v81, 16, v80
    v_lshl_or_b32 v81, v83, 16, v82
    v_cndmask_b32 v80, v80, 0, vcc
    v_cndmask_b32 v81, v81, 0, vcc
    v_cmp_eq_u32 vcc, 7, v12
    ds_write_b64 v17, v[80:81] offset:28160
    v_lshl_or_b32 v72, v76, 16, v72
    v_lshl_or_b32 v73, v77, 16, v73
    v_lshl_or_b32 v74, v78, 16, v74
    v_lshl_or_b32 v75, v79, 16, v75
    v_cndmask_b32 v47, 0, v47, vcc
    v_lshl_or_b32 v64, v86, 16, v86
    v_lshl_or_b32 v65, v85, 16, v85
    v_lshl_or_b32 v66, v84, 16, v85
    v_lshl_or_b32 v67, v84, 16, v84
    v_mov_b32 v56, 0
    v_lshlrev_b32 v57, 16, v47
    v_lshl_or_b32 v58, v47, 16, v47
    v_mov_b32 v59, v58
    s_mov_b64 exec, 0xff
    ds_write_b128 v16, v[56:59] offset:0
    s_mov_b64 exec, -1
    ds_write_b128 v13, v[64:67] offset:128
    ds_write_b128 v13, v[72:75] offset:1152
    v_and_b32 v12, 31, v0
    v_lshrrev_b32 v14, 2, v12
    v_mul_u32_u24 v14, 2368, v14
    v_and_b32 v12, 3, v0
    v_lshl_add_u32 v14, v12, 4, v14
    v_add_u32 v14, s15, v14
    v_mov_b32 v84, 0
    v_mov_b32 v85, 0
    v_mov_b32 v86, 0
    v_mov_b32 v87, 0
    s_mov_b32 exec_hi, 0
    ds_write_b128 v14, v[84:87] offset:2176
    s_mov_b32 exec_hi, -1
    s_waitcnt lgkmcnt(0)
    ds_read_b128 v[60:63], v16 offset:16
    ds_read_b128 v[68:71], v13 offset:144
    ds_read_b128 v[76:79], v13 offset:1168
    v_min_u32 v14, 4, v0
    v_lshl_add_u32 v14, v14, 4, s34
    s_mov_b64 exec, 31
    ds_write_b128 v14, v[84:87]
    s_mov_b64 exec, -1
    s_waitcnt lgkmcnt(3)
    v_mov_b32 v88, v57
    v_alignbit_b32 v94, v57, v56, 16
    v_alignbit_b32 v100, v58, v57, 16
    v_mov_b32 v89, v58
    v_alignbit_b32 v95, v58, v57, 16
    v_alignbit_b32 v101, v59, v58, 16
    v_mov_b32 v90, v59
    v_alignbit_b32 v96, v59, v58, 16
    v_alignbit_b32 v102, v60, v59, 16
    v_mov_b32 v91, v60
    v_alignbit_b32 v97, v60, v59, 16
    v_alignbit_b32 v103, v61, v60, 16
    v_mov_b32 v92, v61
    v_alignbit_b32 v98, v61, v60, 16
    v_alignbit_b32 v104, v62, v61, 16
    v_mov_b32 v93, v62
    v_alignbit_b32 v99, v62, v61, 16
    v_alignbit_b32 v105, v63, v62, 16
    s_mov_b64 exec, 0xff
    ds_write_b128 v16, v[94:97] offset:2368
    ds_write_b128 v16, v[88:91] offset:4736
    ds_write_b128 v16, v[100:103] offset:7104
    ds_write_b128 v16, v[58:61] offset:9472
    ds_write_b128 v16, v[96:99] offset:11840
    ds_write_b128 v16, v[90:93] offset:14208
    ds_write_b128 v16, v[102:105] offset:16576
    s_mov_b64 exec, -1
    s_waitcnt lgkmcnt(9)
    v_mov_b32 v106, v65
    v_alignbit_b32 v112, v65, v64, 16
    v_alignbit_b32 v118, v66, v65, 16
    v_mov_b32 v107, v66
    v_alignbit_b32 v113, v66, v65, 16
    v_alignbit_b32 v119, v67, v66, 16
    v_mov_b32 v108, v67
    v_alignbit_b32 v114, v67, v66, 16
    v_alignbit_b32 v120, v68, v67, 16
    v_mov_b32 v109, v68
    v_alignbit_b32 v115, v68, v67, 16
    v_alignbit_b32 v121, v69, v68, 16
    v_mov_b32 v110, v69
    v_alignbit_b32 v116, v69, v68, 16
    v_alignbit_b32 v122, v70, v69, 16
    v_mov_b32 v111, v70
    v_alignbit_b32 v117, v70, v69, 16
    v_alignbit_b32 v123, v71, v70, 16
    ds_write_b128 v13, v[112:115] offset:2496
    ds_write_b128 v13, v[106:109] offset:4864
    ds_write_b128 v13, v[118:121] offset:7232
    ds_write_b128 v13, v[66:69] offset:9600
    ds_write_b128 v13, v[114:117] offset:11968
    ds_write_b128 v13, v[108:111] offset:14336
    ds_write_b128 v13, v[120:123] offset:16704
    s_waitcnt lgkmcnt(15)
    v_mov_b32 v88, v73
    v_alignbit_b32 v94, v73, v72, 16
    v_alignbit_b32 v100, v74, v73, 16
    v_mov_b32 v89, v74
    v_alignbit_b32 v95, v74, v73, 16
    v_alignbit_b32 v101, v75, v74, 16
    v_mov_b32 v90, v75
    v_alignbit_b32 v96, v75, v74, 16
    v_alignbit_b32 v102, v76, v75, 16
    v_mov_b32 v91, v76
    v_alignbit_b32 v97, v76, v75, 16
    v_alignbit_b32 v103, v77, v76, 16
    v_mov_b32 v92, v77
    v_alignbit_b32 v98, v77, v76, 16
    v_alignbit_b32 v104, v78, v77, 16
    v_mov_b32 v93, v78
    v_alignbit_b32 v99, v78, v77, 16
    v_alignbit_b32 v105, v79, v78, 16
    ds_write_b128 v13, v[94:97] offset:3520
    ds_write_b128 v13, v[88:91] offset:5888
    ds_write_b128 v13, v[100:103] offset:8256
    ds_write_b128 v13, v[74:77] offset:10624
    ds_write_b128 v13, v[96:99] offset:12992
    ds_write_b128 v13, v[90:93] offset:15360
    ds_write_b128 v13, v[102:105] offset:17728
    s_cmp_lg_u32 s14, 0
    s_cbranch_scc1 f_c_nom
    v_mov_b32 v59, 153920
    v_mov_b32 v58, 1
    s_mov_b32 s37, s34
gb_5:
    s_sleep 1
    ds_read_b32 v60, v59 offset:16
    s_waitcnt lgkmcnt(0)
    v_readfirstlane_b32 s35, v60
    s_cmp_lt_u32 s35, 1
    s_cbranch_scc1 gb_5
    ds_read_b64 v[60:61], v59 offset:8
    s_lshl_b32 s34, s12, 7
    s_add_u32 s34, s34, 53510144
    s_lshl_b32 s25, s12, 4
    s_add_u32 s25, s25, 0
    s_add_u32 s26, s25, 4608
    v_and_b32 v5, 3, v0
    v_mul_u32_u24 v5, 13824, v5
    s_waitcnt lgkmcnt(0)
    v_readfirstlane_b32 s31, v60
    v_readfirstlane_b32 s32, v61
    s_nop 3
    v_mov_b32 v60, 0
    s_mov_b32 s36, 0
    s_cmp_ge_u32 s32, 24
    s_cbranch_scc1 polled_m
poll_m:
    buffer_load_dword v61, v60, s[8:11], s34 offen sc1
    s_waitcnt vmcnt(0)
    v_readfirstlane_b32 s35, v61
    s_cmp_lg_u32 s35, s31
    s_cbranch_scc1 polled_m
    s_sleep 1
    s_add_u32 s36, s36, 1
    s_cmp_lt_u32 s36, 0x100000
    s_cbranch_scc1 poll_m
polled_m:
    buffer_load_dwordx4 v[88:91], v5, s[8:11], s25 offen sc1
    buffer_load_dwordx4 v[92:95], v5, s[8:11], s25 offen offset:2304 sc1
    buffer_load_dwordx4 v[96:99], v5, s[8:11], s26 offen sc1
    s_mov_b32 s34, s37
    s_waitcnt vmcnt(0)
    s_nop 1
    v_add_f32_dpp v88, v88, v88 quad_perm:[1,0,3,2] row_mask:0xf bank_mask:0xf
    v_add_f32_dpp v89, v89, v89 quad_perm:[1,0,3,2] row_mask:0xf bank_mask:0xf
    v_add_f32_dpp v90, v90, v90 quad_perm:[1,0,3,2] row_mask:0xf bank_mask:0xf
    v_add_f32_dpp v91, v91, v91 quad_perm:[1,0,3,2] row_mask:0xf bank_mask:0xf
    v_add_f32_dpp v92, v92, v92 quad_perm:[1,0,3,2] row_mask:0xf bank_mask:0xf
    v_add_f32_dpp v93, v93, v93 quad_perm:[1,0,3,2] row_mask:0xf bank_mask:0xf
    v_add_f32_dpp v94, v94, v94 quad_perm:[1,0,3,2] row_mask:0xf bank_mask:0xf
    v_add_f32_dpp v95, v95, v95 quad_perm:[1,0,3,2] row_mask:0xf bank_mask:0xf
    v_add_f32_dpp v96, v96, v96 quad_perm:[1,0,3,2] row_mask:0xf bank_mask:0xf
    v_add_f32_dpp v97, v97, v97 quad_perm:[1,0,3,2] row_mask:0xf bank_mask:0xf
    v_add_f32_dpp v98, v98, v98 quad_perm:[1,0,3,2] row_mask:0xf bank_mask:0xf
    v_add_f32_dpp v99, v99, v99 quad_perm:[1,0,3,2] row_mask:0xf bank_mask:0xf
    s_nop 1
    v_add_f32_dpp v88, v88, v88 quad_perm:[2,3,0,1] row_mask:0xf bank_mask:0xf
    v_add_f32_dpp v89, v89, v89 quad_perm:[2,3,0,1] row_mask:0xf bank_mask:0xf
    v_add_f32_dpp v90, v90, v90 quad_perm:[2,3,0,1] row_mask:0xf bank_mask:0xf
    v_add_f32_dpp v91, v91, v91 quad_perm:[2,3,0,1] row_mask:0xf bank_mask:0xf
    v_add_f32_dpp v92, v92, v92 quad_perm:[2,3,0,1] row_mask:0xf bank_mask:0xf
    v_add_f32_dpp v93, v93, v93 quad_perm:[2,3,0,1] row_mask:0xf bank_mask:0xf
    v_add_f32_dpp v94, v94, v94 quad_perm:[2,3,0,1] row_mask:0xf bank_mask:0xf
    v_add_f32_dpp v95, v95, v95 quad_perm:[2,3,0,1] row_mask:0xf bank_mask:0xf
    v_add_f32_dpp v96, v96, v96 quad_perm:[2,3,0,1] row_mask:0xf bank_mask:0xf
    v_add_f32_dpp v97, v97, v97 quad_perm:[2,3,0,1] row_mask:0xf bank_mask:0xf
    v_add_f32_dpp v98, v98, v98 quad_perm:[2,3,0,1] row_mask:0xf bank_mask:0xf
    v_add_f32_dpp v99, v99, v99 quad_perm:[2,3,0,1] row_mask:0xf bank_mask:0xf
    v_cvt_pk_bf16_f32 v88, v88, v88
    v_lshlrev_b32 v88, 16, v88
    v_cvt_pk_bf16_f32 v89, v89, v89
    v_lshlrev_b32 v89, 16, v89
    v_cvt_pk_bf16_f32 v90, v90, v90
    v_lshlrev_b32 v90, 16, v90
    v_cvt_pk_bf16_f32 v91, v91, v91
    v_lshlrev_b32 v91, 16, v91
    v_cvt_pk_bf16_f32 v92, v92, v92
    v_lshlrev_b32 v92, 16, v92
    v_cvt_pk_bf16_f32 v93, v93, v93
    v_lshlrev_b32 v93, 16, v93
    v_cvt_pk_bf16_f32 v94, v94, v94
    v_lshlrev_b32 v94, 16, v94
    v_cvt_pk_bf16_f32 v95, v95, v95
    v_lshlrev_b32 v95, 16, v95
    v_cvt_pk_bf16_f32 v96, v96, v96
    v_lshlrev_b32 v96, 16, v96
    v_cvt_pk_bf16_f32 v97, v97, v97
    v_lshlrev_b32 v97, 16, v97
    v_cvt_pk_bf16_f32 v98, v98, v98
    v_lshlrev_b32 v98, 16, v98
    v_cvt_pk_bf16_f32 v99, v99, v99
    v_lshlrev_b32 v99, 16, v99
    v_add_f32 v92, 1.0, v92
    v_cvt_pk_bf16_f32 v92, v92, v92
    v_lshlrev_b32 v92, 16, v92
    v_add_f32 v93, 1.0, v93
    v_cvt_pk_bf16_f32 v93, v93, v93
    v_lshlrev_b32 v93, 16, v93
    v_add_f32 v94, 1.0, v94
    v_cvt_pk_bf16_f32 v94, v94, v94
    v_lshlrev_b32 v94, 16, v94
    v_add_f32 v95, 1.0, v95
    v_cvt_pk_bf16_f32 v95, v95, v95
    v_lshlrev_b32 v95, 16, v95
    s_mov_b64 exec, 1
    ds_write_b128 v59, v[88:91] offset:32
    ds_write_b128 v59, v[92:95] offset:48
    ds_write_b128 v59, v[96:99] offset:64
    s_waitcnt lgkmcnt(0)
    ds_add_u32 v59, v58 offset:4
    s_mov_b64 exec, -1
f_c_nom:
    s_waitcnt lgkmcnt(0)
    s_barrier
    v_and_b32 v3, 31, v0
    v_lshrrev_b32 v4, 5, v0
    v_lshlrev_b32 v5, 6, v3
    v_lshl_add_u32 v5, v4, 3, v5
    v_sub_u32 v6, 31, v3
    v_and_b32 v7, 7, v6
    v_mul_u32_u24 v7, 2368, v7
    v_lshrrev_b32 v6, 3, v6
    v_add_u32 v6, v6, v4
    v_lshl_add_u32 v7, v6, 4, v7
    v_add_u32 v7, s15, v7
    v_mov_b32 v15, v7
    v_add_u32 v7, 1920, v7
    v_lshl_add_u32 v10, v4, 4, s34
    v_mul_u32_u24 v11, 80, v3
    v_add_u32 v11, v11, v10
    v_add_u32 v11, 80, v11
    v_add_u32 v12, 2320, v11
    v_and_b32 v2, 3, v0
    v_mul_u32_u24 v2, 13824, v2
    s_lshl_b32 s30, s13, 2
    s_add_u32 s30, s30, 4608
    v_mov_b32 v128, 0
    v_mov_b32 v129, 0
    v_mov_b32 v130, 0
    v_mov_b32 v131, 0
    v_mov_b32 v132, 0
    v_mov_b32 v133, 0
    v_mov_b32 v134, 0
    v_mov_b32 v135, 0
    v_mov_b32 v136, 0
    v_mov_b32 v137, 0
    v_mov_b32 v138, 0
    v_mov_b32 v139, 0
    v_mov_b32 v140, 0
    v_mov_b32 v141, 0
    v_mov_b32 v142, 0
    v_mov_b32 v143, 0
    v_mov_b32 v144, 0
    v_mov_b32 v145, 0
    v_mov_b32 v146, 0
    v_mov_b32 v147, 0
    v_mov_b32 v148, 0
    v_mov_b32 v149, 0
    v_mov_b32 v150, 0
    v_mov_b32 v151, 0
    v_mov_b32 v152, 0
    v_mov_b32 v153, 0
    v_mov_b32 v154, 0
    v_mov_b32 v155, 0
    v_mov_b32 v156, 0
    v_mov_b32 v157, 0
    v_mov_b32 v158, 0
    v_mov_b32 v159, 0
    v_add_u32 v16, -80, v11
    v_lshrrev_b32 v17, 4, v3
    v_lshl_add_u32 v17, v4, 2, v17
    v_mul_u32_u24 v17, 144, v17
    v_and_b32 v18, 15, v3
    v_lshl_add_u32 v17, v18, 3, v17
    v_add_u32 v17, s15, v17
    v_lshlrev_b32 v18, 1, v4
    v_sub_u32 v18, v3, v18
    v_lshlrev_b32 v18, 3, v18
    s_add_u32 s31, s15, 28184
    v_add_u32 v18, s31, v18
    v_max_i32 v13, v11, v10
    s_barrier
    s_setprio 3
    s_lshl_b32 s30, s14, 2
    s_add_u32 s30, s30, 153984
    v_mov_b32 v2, s30
    ds_read_b32 v20, v2
    ds_read_b128 v[48:51], v7 offset:192
    ds_read_b128 v[52:55], v13 offset:0
    ds_read_b128 v[56:59], v12 offset:240
    ds_read_b128 v[60:63], v7 offset:224
    ds_read_b128 v[64:67], v13 offset:32
    ds_read_b128 v[68:71], v12 offset:272
    s_mov_b32 s29, 0
f_cloop:
    v_add_u32 v11, 4294967216, v11
    v_max_i32 v13, v11, v10
    s_waitcnt lgkmcnt(4)
    v_mfma_f32_32x32x16_bf16 v[128:143], v[48:51], v[52:55], v[128:143]
    ds_read_b128 v[72:75], v7 offset:128
    ds_read_b128 v[76:79], v13 offset:0
    s_waitcnt lgkmcnt(5)
    v_mfma_f32_32x32x16_bf16 v[144:159], v[48:51], v[56:59], v[144:159]
    ds_read_b128 v[80:83], v12 offset:160
    s_waitcnt lgkmcnt(4)
    v_mfma_f32_32x32x16_bf16 v[128:143], v[60:63], v[64:67], v[128:143]
    ds_read_b128 v[84:87], v7 offset:160
    ds_read_b128 v[88:91], v13 offset:32
    s_waitcnt lgkmcnt(5)
    v_mfma_f32_32x32x16_bf16 v[144:159], v[60:63], v[68:71], v[144:159]
    ds_read_b128 v[92:95], v12 offset:192
    v_add_u32 v11, 4294967216, v11
    v_max_i32 v13, v11, v10
    s_waitcnt lgkmcnt(4)
    v_mfma_f32_32x32x16_bf16 v[128:143], v[72:75], v[76:79], v[128:143]
    ds_read_b128 v[48:51], v7 offset:64
    ds_read_b128 v[52:55], v13 offset:0
    s_waitcnt lgkmcnt(5)
    v_mfma_f32_32x32x16_bf16 v[144:159], v[72:75], v[80:83], v[144:159]
    ds_read_b128 v[56:59], v12 offset:80
    s_waitcnt lgkmcnt(4)
    v_mfma_f32_32x32x16_bf16 v[128:143], v[84:87], v[88:91], v[128:143]
    ds_read_b128 v[60:63], v7 offset:96
    ds_read_b128 v[64:67], v13 offset:32
    s_waitcnt lgkmcnt(5)
    v_mfma_f32_32x32x16_bf16 v[144:159], v[84:87], v[92:95], v[144:159]
    ds_read_b128 v[68:71], v12 offset:112
    v_add_u32 v11, 4294967216, v11
    v_max_i32 v13, v11, v10
    s_waitcnt lgkmcnt(4)
    v_mfma_f32_32x32x16_bf16 v[128:143], v[48:51], v[52:55], v[128:143]
    ds_read_b128 v[72:75], v7 offset:0
    ds_read_b128 v[76:79], v13 offset:0
    s_waitcnt lgkmcnt(5)
    v_mfma_f32_32x32x16_bf16 v[144:159], v[48:51], v[56:59], v[144:159]
    ds_read_b128 v[80:83], v12 offset:0
    s_waitcnt lgkmcnt(4)
    v_mfma_f32_32x32x16_bf16 v[128:143], v[60:63], v[64:67], v[128:143]
    ds_read_b128 v[84:87], v7 offset:32
    ds_read_b128 v[88:91], v13 offset:32
    s_waitcnt lgkmcnt(5)
    v_mfma_f32_32x32x16_bf16 v[144:159], v[60:63], v[68:71], v[144:159]
    ds_read_b128 v[92:95], v12 offset:32
    v_add_u32 v7, -256, v7
    v_add_u32 v12, 4294966976, v12
    v_add_u32 v11, 4294967216, v11
    v_max_i32 v13, v11, v10
    s_waitcnt lgkmcnt(4)
    v_mfma_f32_32x32x16_bf16 v[128:143], v[72:75], v[76:79], v[128:143]
    ds_read_b128 v[48:51], v7 offset:192
    ds_read_b128 v[52:55], v13 offset:0
    s_waitcnt lgkmcnt(5)
    v_mfma_f32_32x32x16_bf16 v[144:159], v[72:75], v[80:83], v[144:159]
    ds_read_b128 v[56:59], v12 offset:240
    s_waitcnt lgkmcnt(4)
    v_mfma_f32_32x32x16_bf16 v[128:143], v[84:87], v[88:91], v[128:143]
    ds_read_b128 v[60:63], v7 offset:224
    ds_read_b128 v[64:67], v13 offset:32
    s_waitcnt lgkmcnt(5)
    v_mfma_f32_32x32x16_bf16 v[144:159], v[84:87], v[92:95], v[144:159]
    ds_read_b128 v[68:71], v12 offset:272
    s_add_u32 s29, s29, 1
    s_cmp_lt_u32 s29, 8
    s_cbranch_scc1 f_cloop
    ds_read_b128 v[160:163], v15 offset:64
    ds_read_b128 v[164:167], v16 offset:80
    ds_read_b128 v[168:171], v15 offset:96
    ds_read_b128 v[172:175], v16 offset:112
    ds_read_b128 v[176:179], v15 offset:0
    ds_read_b128 v[180:183], v16 offset:0
    ds_read_b128 v[184:187], v15 offset:32
    ds_read_b128 v[188:191], v16 offset:32
    s_barrier
    ds_read_b64 v[192:193], v17 offset:18944
    ds_read_b64 v[194:195], v17 offset:19232
    ds_read2_b64 v[196:199], v18 offset0:29 offset1:28
    s_waitcnt lgkmcnt(9)
    v_mfma_f32_32x32x16_bf16 v[144:159], v[160:163], v[164:167], v[144:159]
    ds_read_b64 v[200:201], v17 offset:20096
    ds_read_b64 v[202:203], v17 offset:20384
    ds_read2_b64 v[204:207], v18 offset0:25 offset1:24
    s_waitcnt lgkmcnt(10)
    v_mfma_f32_32x32x16_bf16 v[144:159], v[168:171], v[172:175], v[144:159]
    ds_read_b64 v[208:209], v17 offset:21248
    ds_read_b64 v[210:211], v17 offset:21536
    ds_read2_b64 v[212:215], v18 offset0:21 offset1:20
    s_waitcnt lgkmcnt(11)
    v_mfma_f32_32x32x16_bf16 v[144:159], v[176:179], v[180:183], v[144:159]
    ds_read_b64 v[216:217], v17 offset:22400
    ds_read_b64 v[218:219], v17 offset:22688
    ds_read2_b64 v[220:223], v18 offset0:17 offset1:16
    s_waitcnt lgkmcnt(12)
    v_mfma_f32_32x32x16_bf16 v[144:159], v[184:187], v[188:191], v[144:159]
    ds_read_b64 v[224:225], v17 offset:23552
    ds_read_b64 v[226:227], v17 offset:23840
    ds_read2_b64 v[228:231], v18 offset0:13 offset1:12
    s_waitcnt lgkmcnt(12)
    v_mfma_f32_32x32x16_bf16 v[144:159], v[192:195], v[196:199], v[144:159]
    ds_read_b64 v[232:233], v17 offset:24704
    ds_read_b64 v[234:235], v17 offset:24992
    ds_read2_b64 v[236:239], v18 offset0:9 offset1:8
    s_waitcnt lgkmcnt(12)
    v_mfma_f32_32x32x16_bf16 v[144:159], v[200:203], v[204:207], v[144:159]
    ds_read_b64 v[240:241], v17 offset:25856
    ds_read_b64 v[242:243], v17 offset:26144
    ds_read2_b64 v[244:247], v18 offset0:5 offset1:4
    s_waitcnt lgkmcnt(12)
    v_mfma_f32_32x32x16_bf16 v[144:159], v[208:211], v[212:215], v[144:159]
    ds_read_b64 v[248:249], v17 offset:27008
    ds_read_b64 v[250:251], v17 offset:27296
    ds_read2_b64 v[252:255], v18 offset0:1 offset1:0
    s_waitcnt lgkmcnt(12)
    v_mfma_f32_32x32x16_bf16 v[144:159], v[216:219], v[220:223], v[144:159]
    s_waitcnt lgkmcnt(9)
    v_mfma_f32_32x32x16_bf16 v[144:159], v[224:227], v[228:231], v[144:159]
    s_waitcnt lgkmcnt(6)
    v_mfma_f32_32x32x16_bf16 v[144:159], v[232:235], v[236:239], v[144:159]
    s_waitcnt lgkmcnt(3)
    v_mfma_f32_32x32x16_bf16 v[144:159], v[240:243], v[244:247], v[144:159]
    s_waitcnt lgkmcnt(0)
    v_mfma_f32_32x32x16_bf16 v[144:159], v[248:251], v[252:255], v[144:159]
    v_mul_u32_u24 v6, 80, v3
    v_lshl_add_u32 v6, v4, 3, v6
    v_add_u32 v6, s34, v6
    s_waitcnt lgkmcnt(0)
    ds_read_b64 v[48:49], v6 offset:80
    ds_read_b64 v[50:51], v6 offset:96
    ds_read_b64 v[52:53], v6 offset:112
    ds_read_b64 v[54:55], v6 offset:128
    ds_read_b64 v[56:57], v6 offset:2640
    ds_read_b64 v[58:59], v6 offset:2656
    ds_read_b64 v[60:61], v6 offset:2672
    ds_read_b64 v[62:63], v6 offset:2688
    v_add_u32 v5, s15, v5
    v_mov_b32 v8, v9
    s_waitcnt lgkmcnt(0)
    v_cvt_pk_bf16_f32 v24, v128, v129
    v_lshlrev_b32 v22, 16, v48
    v_and_b32 v23, 0xffff0000, v48
    v_pk_mul_f32 v[22:23], v[22:23], v[8:9]
    v_cvt_pk_bf16_f32 v25, v22, v23
    v_lshlrev_b32 v22, 16, v24
    v_and_b32 v23, 0xffff0000, v24
    v_lshlrev_b32 v26, 16, v25
    v_and_b32 v27, 0xffff0000, v25
    v_pk_add_f32 v[22:23], v[22:23], v[26:27]
    v_cvt_pk_bf16_f32 v24, v22, v23
    v_lshlrev_b32 v22, 16, v24
    v_and_b32 v23, 0xffff0000, v24
    v_pk_mul_f32 v[22:23], v[22:23], v[20:21] op_sel_hi:[1,0]
    v_cvt_pk_bf16_f32 v80, v22, v23
    v_cvt_pk_bf16_f32 v30, v130, v131
    v_lshlrev_b32 v28, 16, v49
    v_and_b32 v29, 0xffff0000, v49
    v_pk_mul_f32 v[28:29], v[28:29], v[8:9]
    v_cvt_pk_bf16_f32 v31, v28, v29
    v_lshlrev_b32 v28, 16, v30
    v_and_b32 v29, 0xffff0000, v30
    v_lshlrev_b32 v32, 16, v31
    v_and_b32 v33, 0xffff0000, v31
    v_pk_add_f32 v[28:29], v[28:29], v[32:33]
    v_cvt_pk_bf16_f32 v30, v28, v29
    v_lshlrev_b32 v28, 16, v30
    v_and_b32 v29, 0xffff0000, v30
    v_pk_mul_f32 v[28:29], v[28:29], v[20:21] op_sel_hi:[1,0]
    v_cvt_pk_bf16_f32 v81, v28, v29
    ds_write_b64 v5, v[80:81] offset:0
    v_cvt_pk_bf16_f32 v24, v132, v133
    v_lshlrev_b32 v22, 16, v50
    v_and_b32 v23, 0xffff0000, v50
    v_pk_mul_f32 v[22:23], v[22:23], v[8:9]
    v_cvt_pk_bf16_f32 v25, v22, v23
    v_lshlrev_b32 v22, 16, v24
    v_and_b32 v23, 0xffff0000, v24
    v_lshlrev_b32 v26, 16, v25
    v_and_b32 v27, 0xffff0000, v25
    v_pk_add_f32 v[22:23], v[22:23], v[26:27]
    v_cvt_pk_bf16_f32 v24, v22, v23
    v_lshlrev_b32 v22, 16, v24
    v_and_b32 v23, 0xffff0000, v24
    v_pk_mul_f32 v[22:23], v[22:23], v[20:21] op_sel_hi:[1,0]
    v_cvt_pk_bf16_f32 v82, v22, v23
    v_cvt_pk_bf16_f32 v30, v134, v135
    v_lshlrev_b32 v28, 16, v51
    v_and_b32 v29, 0xffff0000, v51
    v_pk_mul_f32 v[28:29], v[28:29], v[8:9]
    v_cvt_pk_bf16_f32 v31, v28, v29
    v_lshlrev_b32 v28, 16, v30
    v_and_b32 v29, 0xffff0000, v30
    v_lshlrev_b32 v32, 16, v31
    v_and_b32 v33, 0xffff0000, v31
    v_pk_add_f32 v[28:29], v[28:29], v[32:33]
    v_cvt_pk_bf16_f32 v30, v28, v29
    v_lshlrev_b32 v28, 16, v30
    v_and_b32 v29, 0xffff0000, v30
    v_pk_mul_f32 v[28:29], v[28:29], v[20:21] op_sel_hi:[1,0]
    v_cvt_pk_bf16_f32 v83, v28, v29
    ds_write_b64 v5, v[82:83] offset:16
    v_cvt_pk_bf16_f32 v24, v136, v137
    v_lshlrev_b32 v22, 16, v52
    v_and_b32 v23, 0xffff0000, v52
    v_pk_mul_f32 v[22:23], v[22:23], v[8:9]
    v_cvt_pk_bf16_f32 v25, v22, v23
    v_lshlrev_b32 v22, 16, v24
    v_and_b32 v23, 0xffff0000, v24
    v_lshlrev_b32 v26, 16, v25
    v_and_b32 v27, 0xffff0000, v25
    v_pk_add_f32 v[22:23], v[22:23], v[26:27]
    v_cvt_pk_bf16_f32 v24, v22, v23
    v_lshlrev_b32 v22, 16, v24
    v_and_b32 v23, 0xffff0000, v24
    v_pk_mul_f32 v[22:23], v[22:23], v[20:21] op_sel_hi:[1,0]
    v_cvt_pk_bf16_f32 v84, v22, v23
    v_cvt_pk_bf16_f32 v30, v138, v139
    v_lshlrev_b32 v28, 16, v53
    v_and_b32 v29, 0xffff0000, v53
    v_pk_mul_f32 v[28:29], v[28:29], v[8:9]
    v_cvt_pk_bf16_f32 v31, v28, v29
    v_lshlrev_b32 v28, 16, v30
    v_and_b32 v29, 0xffff0000, v30
    v_lshlrev_b32 v32, 16, v31
    v_and_b32 v33, 0xffff0000, v31
    v_pk_add_f32 v[28:29], v[28:29], v[32:33]
    v_cvt_pk_bf16_f32 v30, v28, v29
    v_lshlrev_b32 v28, 16, v30
    v_and_b32 v29, 0xffff0000, v30
    v_pk_mul_f32 v[28:29], v[28:29], v[20:21] op_sel_hi:[1,0]
    v_cvt_pk_bf16_f32 v85, v28, v29
    ds_write_b64 v5, v[84:85] offset:32
    v_cvt_pk_bf16_f32 v24, v140, v141
    v_lshlrev_b32 v22, 16, v54
    v_and_b32 v23, 0xffff0000, v54
    v_pk_mul_f32 v[22:23], v[22:23], v[8:9]
    v_cvt_pk_bf16_f32 v25, v22, v23
    v_lshlrev_b32 v22, 16, v24
    v_and_b32 v23, 0xffff0000, v24
    v_lshlrev_b32 v26, 16, v25
    v_and_b32 v27, 0xffff0000, v25
    v_pk_add_f32 v[22:23], v[22:23], v[26:27]
    v_cvt_pk_bf16_f32 v24, v22, v23
    v_lshlrev_b32 v22, 16, v24
    v_and_b32 v23, 0xffff0000, v24
    v_pk_mul_f32 v[22:23], v[22:23], v[20:21] op_sel_hi:[1,0]
    v_cvt_pk_bf16_f32 v86, v22, v23
    v_cvt_pk_bf16_f32 v30, v142, v143
    v_lshlrev_b32 v28, 16, v55
    v_and_b32 v29, 0xffff0000, v55
    v_pk_mul_f32 v[28:29], v[28:29], v[8:9]
    v_cvt_pk_bf16_f32 v31, v28, v29
    v_lshlrev_b32 v28, 16, v30
    v_and_b32 v29, 0xffff0000, v30
    v_lshlrev_b32 v32, 16, v31
    v_and_b32 v33, 0xffff0000, v31
    v_pk_add_f32 v[28:29], v[28:29], v[32:33]
    v_cvt_pk_bf16_f32 v30, v28, v29
    v_lshlrev_b32 v28, 16, v30
    v_and_b32 v29, 0xffff0000, v30
    v_pk_mul_f32 v[28:29], v[28:29], v[20:21] op_sel_hi:[1,0]
    v_cvt_pk_bf16_f32 v87, v28, v29
    ds_write_b64 v5, v[86:87] offset:48
    v_cvt_pk_bf16_f32 v24, v144, v145
    v_lshlrev_b32 v22, 16, v56
    v_and_b32 v23, 0xffff0000, v56
    v_pk_mul_f32 v[22:23], v[22:23], v[8:9]
    v_cvt_pk_bf16_f32 v25, v22, v23
    v_lshlrev_b32 v22, 16, v24
    v_and_b32 v23, 0xffff0000, v24
    v_lshlrev_b32 v26, 16, v25
    v_and_b32 v27, 0xffff0000, v25
    v_pk_add_f32 v[22:23], v[22:23], v[26:27]
    v_cvt_pk_bf16_f32 v24, v22, v23
    v_lshlrev_b32 v22, 16, v24
    v_and_b32 v23, 0xffff0000, v24
    v_pk_mul_f32 v[22:23], v[22:23], v[20:21] op_sel_hi:[1,0]
    v_cvt_pk_bf16_f32 v88, v22, v23
    v_cvt_pk_bf16_f32 v30, v146, v147
    v_lshlrev_b32 v28, 16, v57
    v_and_b32 v29, 0xffff0000, v57
    v_pk_mul_f32 v[28:29], v[28:29], v[8:9]
    v_cvt_pk_bf16_f32 v31, v28, v29
    v_lshlrev_b32 v28, 16, v30
    v_and_b32 v29, 0xffff0000, v30
    v_lshlrev_b32 v32, 16, v31
    v_and_b32 v33, 0xffff0000, v31
    v_pk_add_f32 v[28:29], v[28:29], v[32:33]
    v_cvt_pk_bf16_f32 v30, v28, v29
    v_lshlrev_b32 v28, 16, v30
    v_and_b32 v29, 0xffff0000, v30
    v_pk_mul_f32 v[28:29], v[28:29], v[20:21] op_sel_hi:[1,0]
    v_cvt_pk_bf16_f32 v89, v28, v29
    ds_write_b64 v5, v[88:89] offset:2048
    v_cvt_pk_bf16_f32 v24, v148, v149
    v_lshlrev_b32 v22, 16, v58
    v_and_b32 v23, 0xffff0000, v58
    v_pk_mul_f32 v[22:23], v[22:23], v[8:9]
    v_cvt_pk_bf16_f32 v25, v22, v23
    v_lshlrev_b32 v22, 16, v24
    v_and_b32 v23, 0xffff0000, v24
    v_lshlrev_b32 v26, 16, v25
    v_and_b32 v27, 0xffff0000, v25
    v_pk_add_f32 v[22:23], v[22:23], v[26:27]
    v_cvt_pk_bf16_f32 v24, v22, v23
    v_lshlrev_b32 v22, 16, v24
    v_and_b32 v23, 0xffff0000, v24
    v_pk_mul_f32 v[22:23], v[22:23], v[20:21] op_sel_hi:[1,0]
    v_cvt_pk_bf16_f32 v90, v22, v23
    v_cvt_pk_bf16_f32 v30, v150, v151
    v_lshlrev_b32 v28, 16, v59
    v_and_b32 v29, 0xffff0000, v59
    v_pk_mul_f32 v[28:29], v[28:29], v[8:9]
    v_cvt_pk_bf16_f32 v31, v28, v29
    v_lshlrev_b32 v28, 16, v30
    v_and_b32 v29, 0xffff0000, v30
    v_lshlrev_b32 v32, 16, v31
    v_and_b32 v33, 0xffff0000, v31
    v_pk_add_f32 v[28:29], v[28:29], v[32:33]
    v_cvt_pk_bf16_f32 v30, v28, v29
    v_lshlrev_b32 v28, 16, v30
    v_and_b32 v29, 0xffff0000, v30
    v_pk_mul_f32 v[28:29], v[28:29], v[20:21] op_sel_hi:[1,0]
    v_cvt_pk_bf16_f32 v91, v28, v29
    ds_write_b64 v5, v[90:91] offset:2064
    v_cvt_pk_bf16_f32 v24, v152, v153
    v_lshlrev_b32 v22, 16, v60
    v_and_b32 v23, 0xffff0000, v60
    v_pk_mul_f32 v[22:23], v[22:23], v[8:9]
    v_cvt_pk_bf16_f32 v25, v22, v23
    v_lshlrev_b32 v22, 16, v24
    v_and_b32 v23, 0xffff0000, v24
    v_lshlrev_b32 v26, 16, v25
    v_and_b32 v27, 0xffff0000, v25
    v_pk_add_f32 v[22:23], v[22:23], v[26:27]
    v_cvt_pk_bf16_f32 v24, v22, v23
    v_lshlrev_b32 v22, 16, v24
    v_and_b32 v23, 0xffff0000, v24
    v_pk_mul_f32 v[22:23], v[22:23], v[20:21] op_sel_hi:[1,0]
    v_cvt_pk_bf16_f32 v92, v22, v23
    v_cvt_pk_bf16_f32 v30, v154, v155
    v_lshlrev_b32 v28, 16, v61
    v_and_b32 v29, 0xffff0000, v61
    v_pk_mul_f32 v[28:29], v[28:29], v[8:9]
    v_cvt_pk_bf16_f32 v31, v28, v29
    v_lshlrev_b32 v28, 16, v30
    v_and_b32 v29, 0xffff0000, v30
    v_lshlrev_b32 v32, 16, v31
    v_and_b32 v33, 0xffff0000, v31
    v_pk_add_f32 v[28:29], v[28:29], v[32:33]
    v_cvt_pk_bf16_f32 v30, v28, v29
    v_lshlrev_b32 v28, 16, v30
    v_and_b32 v29, 0xffff0000, v30
    v_pk_mul_f32 v[28:29], v[28:29], v[20:21] op_sel_hi:[1,0]
    v_cvt_pk_bf16_f32 v93, v28, v29
    ds_write_b64 v5, v[92:93] offset:2080
    v_cvt_pk_bf16_f32 v24, v156, v157
    v_lshlrev_b32 v22, 16, v62
    v_and_b32 v23, 0xffff0000, v62
    v_pk_mul_f32 v[22:23], v[22:23], v[8:9]
    v_cvt_pk_bf16_f32 v25, v22, v23
    v_lshlrev_b32 v22, 16, v24
    v_and_b32 v23, 0xffff0000, v24
    v_lshlrev_b32 v26, 16, v25
    v_and_b32 v27, 0xffff0000, v25
    v_pk_add_f32 v[22:23], v[22:23], v[26:27]
    v_cvt_pk_bf16_f32 v24, v22, v23
    v_lshlrev_b32 v22, 16, v24
    v_and_b32 v23, 0xffff0000, v24
    v_pk_mul_f32 v[22:23], v[22:23], v[20:21] op_sel_hi:[1,0]
    v_cvt_pk_bf16_f32 v94, v22, v23
    v_cvt_pk_bf16_f32 v30, v158, v159
    v_lshlrev_b32 v28, 16, v63
    v_and_b32 v29, 0xffff0000, v63
    v_pk_mul_f32 v[28:29], v[28:29], v[8:9]
    v_cvt_pk_bf16_f32 v31, v28, v29
    v_lshlrev_b32 v28, 16, v30
    v_and_b32 v29, 0xffff0000, v30
    v_lshlrev_b32 v32, 16, v31
    v_and_b32 v33, 0xffff0000, v31
    v_pk_add_f32 v[28:29], v[28:29], v[32:33]
    v_cvt_pk_bf16_f32 v30, v28, v29
    v_lshlrev_b32 v28, 16, v30
    v_and_b32 v29, 0xffff0000, v30
    v_pk_mul_f32 v[28:29], v[28:29], v[20:21] op_sel_hi:[1,0]
    v_cvt_pk_bf16_f32 v95, v28, v29
    ds_write_b64 v5, v[94:95] offset:2096
    s_waitcnt lgkmcnt(0)
    s_barrier
f_end:
    s_endpgm
.globl m_kernel
.p2align 8
.type m_kernel,@function
m_kernel:
    s_cmp_ge_u32 s2, 256
    s_cbranch_scc1 g2_end
    s_load_dwordx2 s[4:5], s[0:1], 112
    s_load_dwordx2 s[6:7], s[0:1], 96
    v_lshrrev_b32 v1, 6, v0
    v_and_b32 v0, 63, v0
    v_readfirstlane_b32 s14, v1
    s_and_b32 s15, s2, 7
    s_lshr_b32 s16, s2, 3
    s_and_b32 s12, s15, 1
    s_lshl_b32 s12, s12, 3
    s_and_b32 s17, s16, 7
    s_add_u32 s12, s12, s17
    s_lshr_b32 s13, s15, 1
    s_lshl_b32 s13, s13, 2
    s_lshr_b32 s17, s16, 3
    s_add_u32 s13, s13, s17
    s_lshr_b32 s40, s15, 1
    s_lshl_b32 s41, s12, 2
    s_add_u32 s41, s41, s17
    s_waitcnt lgkmcnt(0)
    s_mov_b32 s8, s4
    s_mov_b32 s9, s5
    s_mov_b32 s10, 79564800
    s_mov_b32 s11, 0x00020000
    s_mov_b32 s48, s6
    s_mov_b32 s49, s7
    s_mov_b32 s50, 2359296
    s_mov_b32 s51, 0x00020000
    s_cmp_ge_u32 s14, 4
    s_cbranch_scc1 g1_prod
    s_lshl_b32 s20, s12, 2
    s_add_u32 s18, s20, s14
    s_mul_i32 s19, s18, 36864
    s_add_u32 s19, s19, 2441216
    v_lshrrev_b32 v9, 4, v0
    v_and_b32 v8, 15, v0
    v_lshlrev_b32 v8, 4, v8
    v_lshl_add_u32 v5, v9, 9, v8
    s_add_u32 s25, s19, 0
    buffer_load_dwordx4 v[104:107], v5, s[8:11], s25 offen offset:0
    buffer_load_dwordx4 v[108:111], v5, s[8:11], s25 offen offset:256
    buffer_load_dwordx4 v[112:115], v5, s[8:11], s25 offen offset:2048
    buffer_load_dwordx4 v[116:119], v5, s[8:11], s25 offen offset:2304
    s_add_u32 s25, s19, 4096
    buffer_load_dwordx4 v[120:123], v5, s[8:11], s25 offen offset:0
    buffer_load_dwordx4 v[124:127], v5, s[8:11], s25 offen offset:256
    buffer_load_dwordx4 v[128:131], v5, s[8:11], s25 offen offset:2048
    buffer_load_dwordx4 v[132:135], v5, s[8:11], s25 offen offset:2304
    s_add_u32 s25, s19, 8192
    buffer_load_dwordx4 v[136:139], v5, s[8:11], s25 offen offset:0
    buffer_load_dwordx4 v[140:143], v5, s[8:11], s25 offen offset:256
    buffer_load_dwordx4 v[144:147], v5, s[8:11], s25 offen offset:2048
    buffer_load_dwordx4 v[148:151], v5, s[8:11], s25 offen offset:2304
    v_lshlrev_b32 v1, 4, v0
    v_mov_b32 v2, v1
    v_add_u32 v3, 73728, v1
    v_add_u32 v6, 36864, v1
    v_add_u32 v7, 110592, v1
    v_add_u32 v4, 147456, v8
    v_mov_b32 v98, 0
    v_mov_b32 v99, 0
    v_mov_b32 v100, 0
    v_mov_b32 v101, 0
    s_mov_b32 s28, 0x3f803f80
    s_mov_b32 s24, 0xbfb8aa3b
    s_lshl_b32 s20, s18, 1
    s_mul_i32 s20, s20, 144
    s_mul_i32 s22, s13, 9
    s_add_u32 s20, s20, s22
    s_lshl_b32 s20, s20, 10
    s_add_u32 s20, s20, 10256384
    s_add_u32 s21, s20, 147456
    s_barrier
    ds_read_b128 v[48:51], v2 offset:0
    ds_read_b128 v[52:55], v2 offset:1024
    ds_read_b128 v[56:59], v2 offset:2048
    ds_read_b128 v[60:63], v2 offset:3072
    s_waitcnt vmcnt(10)
    s_waitcnt lgkmcnt(2)
    v_mfma_f32_16x16x32_bf16 v[16:19], v[48:51], v[104:107], 0
    ds_read_b128 v[64:67], v2 offset:4096
    v_mfma_f32_16x16x32_bf16 v[20:23], v[48:51], v[108:111], 0
    v_mfma_f32_16x16x32_bf16 v[24:27], v[52:55], v[104:107], 0
    ds_read_b128 v[68:71], v2 offset:5120
    s_add_u32 s25, s19, 12288
    buffer_load_dwordx4 v[152:155], v5, s[8:11], s25 offen offset:0
    buffer_load_dwordx4 v[156:159], v5, s[8:11], s25 offen offset:256
    v_dot2_f32_bf16 v98, v104, s28, v98
    v_dot2_f32_bf16 v99, v104, v104, v99
    v_dot2_f32_bf16 v98, v105, s28, v98
    v_dot2_f32_bf16 v99, v105, v105, v99
    v_dot2_f32_bf16 v98, v106, s28, v98
    v_dot2_f32_bf16 v99, v106, v106, v99
    v_dot2_f32_bf16 v98, v107, s28, v98
    v_dot2_f32_bf16 v99, v107, v107, v99
    v_mfma_f32_16x16x32_bf16 v[28:31], v[52:55], v[108:111], 0
    v_dot2_f32_bf16 v100, v108, s28, v100
    v_dot2_f32_bf16 v101, v108, v108, v101
    v_dot2_f32_bf16 v100, v109, s28, v100
    v_dot2_f32_bf16 v101, v109, v109, v101
    v_dot2_f32_bf16 v100, v110, s28, v100
    v_dot2_f32_bf16 v101, v110, v110, v101
    v_dot2_f32_bf16 v100, v111, s28, v100
    v_dot2_f32_bf16 v101, v111, v111, v101
    s_waitcnt vmcnt(10)
    s_waitcnt lgkmcnt(2)
    v_mfma_f32_16x16x32_bf16 v[16:19], v[56:59], v[112:115], v[16:19]
    ds_read_b128 v[48:51], v2 offset:6144
    v_mfma_f32_16x16x32_bf16 v[20:23], v[56:59], v[116:119], v[20:23]
    v_mfma_f32_16x16x32_bf16 v[24:27], v[60:63], v[112:115], v[24:27]
    ds_read_b128 v[52:55], v2 offset:7168
    buffer_load_dwordx4 v[160:163], v5, s[8:11], s25 offen offset:2048
    buffer_load_dwordx4 v[164:167], v5, s[8:11], s25 offen offset:2304
    v_dot2_f32_bf16 v98, v112, s28, v98
    v_dot2_f32_bf16 v99, v112, v112, v99
    v_dot2_f32_bf16 v98, v113, s28, v98
    v_dot2_f32_bf16 v99, v113, v113, v99
    v_dot2_f32_bf16 v98, v114, s28, v98
    v_dot2_f32_bf16 v99, v114, v114, v99
    v_dot2_f32_bf16 v98, v115, s28, v98
    v_dot2_f32_bf16 v99, v115, v115, v99
    v_mfma_f32_16x16x32_bf16 v[28:31], v[60:63], v[116:119], v[28:31]
    v_dot2_f32_bf16 v100, v116, s28, v100
    v_dot2_f32_bf16 v101, v116, v116, v101
    v_dot2_f32_bf16 v100, v117, s28, v100
    v_dot2_f32_bf16 v101, v117, v117, v101
    v_dot2_f32_bf16 v100, v118, s28, v100
    v_dot2_f32_bf16 v101, v118, v118, v101
    v_dot2_f32_bf16 v100, v119, s28, v100
    v_dot2_f32_bf16 v101, v119, v119, v101
    s_waitcnt vmcnt(10)
    s_waitcnt lgkmcnt(2)
    v_mfma_f32_16x16x32_bf16 v[16:19], v[64:67], v[120:123], v[16:19]
    ds_read_b128 v[56:59], v2 offset:8192
    v_mfma_f32_16x16x32_bf16 v[20:23], v[64:67], v[124:127], v[20:23]
    v_mfma_f32_16x16x32_bf16 v[24:27], v[68:71], v[120:123], v[24:27]
    ds_read_b128 v[60:63], v2 offset:9216
    s_add_u32 s25, s19, 16384
    buffer_load_dwordx4 v[168:171], v5, s[8:11], s25 offen offset:0
    buffer_load_dwordx4 v[172:175], v5, s[8:11], s25 offen offset:256
    v_dot2_f32_bf16 v98, v120, s28, v98
    v_dot2_f32_bf16 v99, v120, v120, v99
    v_dot2_f32_bf16 v98, v121, s28, v98
    v_dot2_f32_bf16 v99, v121, v121, v99
    v_dot2_f32_bf16 v98, v122, s28, v98
    v_dot2_f32_bf16 v99, v122, v122, v99
    v_dot2_f32_bf16 v98, v123, s28, v98
    v_dot2_f32_bf16 v99, v123, v123, v99
    v_mfma_f32_16x16x32_bf16 v[28:31], v[68:71], v[124:127], v[28:31]
    v_dot2_f32_bf16 v100, v124, s28, v100
    v_dot2_f32_bf16 v101, v124, v124, v101
    v_dot2_f32_bf16 v100, v125, s28, v100
    v_dot2_f32_bf16 v101, v125, v125, v101
    v_dot2_f32_bf16 v100, v126, s28, v100
    v_dot2_f32_bf16 v101, v126, v126, v101
    v_dot2_f32_bf16 v100, v127, s28, v100
    v_dot2_f32_bf16 v101, v127, v127, v101
    s_waitcnt vmcnt(10)
    s_waitcnt lgkmcnt(2)
    v_mfma_f32_16x16x32_bf16 v[16:19], v[48:51], v[128:131], v[16:19]
    ds_read_b128 v[64:67], v2 offset:10240
    v_mfma_f32_16x16x32_bf16 v[20:23], v[48:51], v[132:135], v[20:23]
    v_mfma_f32_16x16x32_bf16 v[24:27], v[52:55], v[128:131], v[24:27]
    ds_read_b128 v[68:71], v2 offset:11264
    buffer_load_dwordx4 v[176:179], v5, s[8:11], s25 offen offset:2048
    buffer_load_dwordx4 v[180:183], v5, s[8:11], s25 offen offset:2304
    v_dot2_f32_bf16 v98, v128, s28, v98
    v_dot2_f32_bf16 v99, v128, v128, v99
    v_dot2_f32_bf16 v98, v129, s28, v98
    v_dot2_f32_bf16 v99, v129, v129, v99
    v_dot2_f32_bf16 v98, v130, s28, v98
    v_dot2_f32_bf16 v99, v130, v130, v99
    v_dot2_f32_bf16 v98, v131, s28, v98
    v_dot2_f32_bf16 v99, v131, v131, v99
    v_mfma_f32_16x16x32_bf16 v[28:31], v[52:55], v[132:135], v[28:31]
    v_dot2_f32_bf16 v100, v132, s28, v100
    v_dot2_f32_bf16 v101, v132, v132, v101
    v_dot2_f32_bf16 v100, v133, s28, v100
    v_dot2_f32_bf16 v101, v133, v133, v101
    v_dot2_f32_bf16 v100, v134, s28, v100
    v_dot2_f32_bf16 v101, v134, v134, v101
    v_dot2_f32_bf16 v100, v135, s28, v100
    v_dot2_f32_bf16 v101, v135, v135, v101
    s_waitcnt vmcnt(10)
    s_waitcnt lgkmcnt(2)
    v_mfma_f32_16x16x32_bf16 v[16:19], v[56:59], v[136:139], v[16:19]
    s_barrier
    ds_read_b128 v[48:51], v2 offset:12288
    v_mfma_f32_16x16x32_bf16 v[20:23], v[56:59], v[140:143], v[20:23]
    v_mfma_f32_16x16x32_bf16 v[24:27], v[60:63], v[136:139], v[24:27]
    ds_read_b128 v[52:55], v2 offset:13312
    s_add_u32 s25, s19, 20480
    buffer_load_dwordx4 v[184:187], v5, s[8:11], s25 offen offset:0
    buffer_load_dwordx4 v[188:191], v5, s[8:11], s25 offen offset:256
    v_dot2_f32_bf16 v98, v136, s28, v98
    v_dot2_f32_bf16 v99, v136, v136, v99
    v_dot2_f32_bf16 v98, v137, s28, v98
    v_dot2_f32_bf16 v99, v137, v137, v99
    v_dot2_f32_bf16 v98, v138, s28, v98
    v_dot2_f32_bf16 v99, v138, v138, v99
    v_dot2_f32_bf16 v98, v139, s28, v98
    v_dot2_f32_bf16 v99, v139, v139, v99
    v_mfma_f32_16x16x32_bf16 v[28:31], v[60:63], v[140:143], v[28:31]
    v_dot2_f32_bf16 v100, v140, s28, v100
    v_dot2_f32_bf16 v101, v140, v140, v101
    v_dot2_f32_bf16 v100, v141, s28, v100
    v_dot2_f32_bf16 v101, v141, v141, v101
    v_dot2_f32_bf16 v100, v142, s28, v100
    v_dot2_f32_bf16 v101, v142, v142, v101
    v_dot2_f32_bf16 v100, v143, s28, v100
    v_dot2_f32_bf16 v101, v143, v143, v101
    s_waitcnt vmcnt(10)
    s_waitcnt lgkmcnt(2)
    v_mfma_f32_16x16x32_bf16 v[16:19], v[64:67], v[144:147], v[16:19]
    ds_read_b128 v[56:59], v2 offset:14336
    v_mfma_f32_16x16x32_bf16 v[20:23], v[64:67], v[148:151], v[20:23]
    v_mfma_f32_16x16x32_bf16 v[24:27], v[68:71], v[144:147], v[24:27]
    ds_read_b128 v[60:63], v2 offset:15360
    buffer_load_dwordx4 v[192:195], v5, s[8:11], s25 offen offset:2048
    buffer_load_dwordx4 v[196:199], v5, s[8:11], s25 offen offset:2304
    v_dot2_f32_bf16 v98, v144, s28, v98
    v_dot2_f32_bf16 v99, v144, v144, v99
    v_dot2_f32_bf16 v98, v145, s28, v98
    v_dot2_f32_bf16 v99, v145, v145, v99
    v_dot2_f32_bf16 v98, v146, s28, v98
    v_dot2_f32_bf16 v99, v146, v146, v99
    v_dot2_f32_bf16 v98, v147, s28, v98
    v_dot2_f32_bf16 v99, v147, v147, v99
    v_mfma_f32_16x16x32_bf16 v[28:31], v[68:71], v[148:151], v[28:31]
    v_dot2_f32_bf16 v100, v148, s28, v100
    v_dot2_f32_bf16 v101, v148, v148, v101
    v_dot2_f32_bf16 v100, v149, s28, v100
    v_dot2_f32_bf16 v101, v149, v149, v101
    v_dot2_f32_bf16 v100, v150, s28, v100
    v_dot2_f32_bf16 v101, v150, v150, v101
    v_dot2_f32_bf16 v100, v151, s28, v100
    v_dot2_f32_bf16 v101, v151, v151, v101
    s_waitcnt vmcnt(10)
    s_waitcnt lgkmcnt(2)
    v_mfma_f32_16x16x32_bf16 v[16:19], v[48:51], v[152:155], v[16:19]
    ds_read_b128 v[64:67], v2 offset:16384
    v_mfma_f32_16x16x32_bf16 v[20:23], v[48:51], v[156:159], v[20:23]
    v_mfma_f32_16x16x32_bf16 v[24:27], v[52:55], v[152:155], v[24:27]
    ds_read_b128 v[68:71], v2 offset:17408
    s_add_u32 s25, s19, 24576
    buffer_load_dwordx4 v[200:203], v5, s[8:11], s25 offen offset:0
    buffer_load_dwordx4 v[204:207], v5, s[8:11], s25 offen offset:256
    v_dot2_f32_bf16 v98, v152, s28, v98
    v_dot2_f32_bf16 v99, v152, v152, v99
    v_dot2_f32_bf16 v98, v153, s28, v98
    v_dot2_f32_bf16 v99, v153, v153, v99
    v_dot2_f32_bf16 v98, v154, s28, v98
    v_dot2_f32_bf16 v99, v154, v154, v99
    v_dot2_f32_bf16 v98, v155, s28, v98
    v_dot2_f32_bf16 v99, v155, v155, v99
    v_mfma_f32_16x16x32_bf16 v[28:31], v[52:55], v[156:159], v[28:31]
    v_dot2_f32_bf16 v100, v156, s28, v100
    v_dot2_f32_bf16 v101, v156, v156, v101
    v_dot2_f32_bf16 v100, v157, s28, v100
    v_dot2_f32_bf16 v101, v157, v157, v101
    v_dot2_f32_bf16 v100, v158, s28, v100
    v_dot2_f32_bf16 v101, v158, v158, v101
    v_dot2_f32_bf16 v100, v159, s28, v100
    v_dot2_f32_bf16 v101, v159, v159, v101
    s_waitcnt vmcnt(10)
    s_waitcnt lgkmcnt(2)
    v_mfma_f32_16x16x32_bf16 v[16:19], v[56:59], v[160:163], v[16:19]
    ds_read_b128 v[48:51], v2 offset:18432
    v_mfma_f32_16x16x32_bf16 v[20:23], v[56:59], v[164:167], v[20:23]
    v_mfma_f32_16x16x32_bf16 v[24:27], v[60:63], v[160:163], v[24:27]
    ds_read_b128 v[52:55], v2 offset:19456
    buffer_load_dwordx4 v[208:211], v5, s[8:11], s25 offen offset:2048
    buffer_load_dwordx4 v[212:215], v5, s[8:11], s25 offen offset:2304
    v_dot2_f32_bf16 v98, v160, s28, v98
    v_dot2_f32_bf16 v99, v160, v160, v99
    v_dot2_f32_bf16 v98, v161, s28, v98
    v_dot2_f32_bf16 v99, v161, v161, v99
    v_dot2_f32_bf16 v98, v162, s28, v98
    v_dot2_f32_bf16 v99, v162, v162, v99
    v_dot2_f32_bf16 v98, v163, s28, v98
    v_dot2_f32_bf16 v99, v163, v163, v99
    v_mfma_f32_16x16x32_bf16 v[28:31], v[60:63], v[164:167], v[28:31]
    v_dot2_f32_bf16 v100, v164, s28, v100
    v_dot2_f32_bf16 v101, v164, v164, v101
    v_dot2_f32_bf16 v100, v165, s28, v100
    v_dot2_f32_bf16 v101, v165, v165, v101
    v_dot2_f32_bf16 v100, v166, s28, v100
    v_dot2_f32_bf16 v101, v166, v166, v101
    v_dot2_f32_bf16 v100, v167, s28, v100
    v_dot2_f32_bf16 v101, v167, v167, v101
    s_waitcnt vmcnt(10)
    s_waitcnt lgkmcnt(2)
    v_mfma_f32_16x16x32_bf16 v[16:19], v[64:67], v[168:171], v[16:19]
    ds_read_b128 v[56:59], v2 offset:20480
    v_mfma_f32_16x16x32_bf16 v[20:23], v[64:67], v[172:175], v[20:23]
    v_mfma_f32_16x16x32_bf16 v[24:27], v[68:71], v[168:171], v[24:27]
    ds_read_b128 v[60:63], v2 offset:21504
    s_add_u32 s25, s19, 28672
    buffer_load_dwordx4 v[216:219], v5, s[8:11], s25 offen offset:0
    buffer_load_dwordx4 v[220:223], v5, s[8:11], s25 offen offset:256
    v_dot2_f32_bf16 v98, v168, s28, v98
    v_dot2_f32_bf16 v99, v168, v168, v99
    v_dot2_f32_bf16 v98, v169, s28, v98
    v_dot2_f32_bf16 v99, v169, v169, v99
    v_dot2_f32_bf16 v98, v170, s28, v98
    v_dot2_f32_bf16 v99, v170, v170, v99
    v_dot2_f32_bf16 v98, v171, s28, v98
    v_dot2_f32_bf16 v99, v171, v171, v99
    v_mfma_f32_16x16x32_bf16 v[28:31], v[68:71], v[172:175], v[28:31]
    v_dot2_f32_bf16 v100, v172, s28, v100
    v_dot2_f32_bf16 v101, v172, v172, v101
    v_dot2_f32_bf16 v100, v173, s28, v100
    v_dot2_f32_bf16 v101, v173, v173, v101
    v_dot2_f32_bf16 v100, v174, s28, v100
    v_dot2_f32_bf16 v101, v174, v174, v101
    v_dot2_f32_bf16 v100, v175, s28, v100
    v_dot2_f32_bf16 v101, v175, v175, v101
    s_waitcnt vmcnt(10)
    s_waitcnt lgkmcnt(2)
    v_mfma_f32_16x16x32_bf16 v[16:19], v[48:51], v[176:179], v[16:19]
    ds_read_b128 v[64:67], v2 offset:22528
    v_mfma_f32_16x16x32_bf16 v[20:23], v[48:51], v[180:183], v[20:23]
    v_mfma_f32_16x16x32_bf16 v[24:27], v[52:55], v[176:179], v[24:27]
    ds_read_b128 v[68:71], v2 offset:23552
    buffer_load_dwordx4 v[224:227], v5, s[8:11], s25 offen offset:2048
    buffer_load_dwordx4 v[228:231], v5, s[8:11], s25 offen offset:2304
    v_dot2_f32_bf16 v98, v176, s28, v98
    v_dot2_f32_bf16 v99, v176, v176, v99
    v_dot2_f32_bf16 v98, v177, s28, v98
    v_dot2_f32_bf16 v99, v177, v177, v99
    v_dot2_f32_bf16 v98, v178, s28, v98
    v_dot2_f32_bf16 v99, v178, v178, v99
    v_dot2_f32_bf16 v98, v179, s28, v98
    v_dot2_f32_bf16 v99, v179, v179, v99
    v_mfma_f32_16x16x32_bf16 v[28:31], v[52:55], v[180:183], v[28:31]
    v_dot2_f32_bf16 v100, v180, s28, v100
    v_dot2_f32_bf16 v101, v180, v180, v101
    v_dot2_f32_bf16 v100, v181, s28, v100
    v_dot2_f32_bf16 v101, v181, v181, v101
    v_dot2_f32_bf16 v100, v182, s28, v100
    v_dot2_f32_bf16 v101, v182, v182, v101
    v_dot2_f32_bf16 v100, v183, s28, v100
    v_dot2_f32_bf16 v101, v183, v183, v101
    s_waitcnt vmcnt(10)
    s_waitcnt lgkmcnt(2)
    v_mfma_f32_16x16x32_bf16 v[16:19], v[56:59], v[184:187], v[16:19]
    s_barrier
    ds_read_b128 v[48:51], v2 offset:24576
    v_mfma_f32_16x16x32_bf16 v[20:23], v[56:59], v[188:191], v[20:23]
    v_mfma_f32_16x16x32_bf16 v[24:27], v[60:63], v[184:187], v[24:27]
    ds_read_b128 v[52:55], v2 offset:25600
    s_add_u32 s25, s19, 32768
    buffer_load_dwordx4 v[232:235], v5, s[8:11], s25 offen offset:0
    buffer_load_dwordx4 v[236:239], v5, s[8:11], s25 offen offset:256
    v_dot2_f32_bf16 v98, v184, s28, v98
    v_dot2_f32_bf16 v99, v184, v184, v99
    v_dot2_f32_bf16 v98, v185, s28, v98
    v_dot2_f32_bf16 v99, v185, v185, v99
    v_dot2_f32_bf16 v98, v186, s28, v98
    v_dot2_f32_bf16 v99, v186, v186, v99
    v_dot2_f32_bf16 v98, v187, s28, v98
    v_dot2_f32_bf16 v99, v187, v187, v99
    v_mfma_f32_16x16x32_bf16 v[28:31], v[60:63], v[188:191], v[28:31]
    v_dot2_f32_bf16 v100, v188, s28, v100
    v_dot2_f32_bf16 v101, v188, v188, v101
    v_dot2_f32_bf16 v100, v189, s28, v100
    v_dot2_f32_bf16 v101, v189, v189, v101
    v_dot2_f32_bf16 v100, v190, s28, v100
    v_dot2_f32_bf16 v101, v190, v190, v101
    v_dot2_f32_bf16 v100, v191, s28, v100
    v_dot2_f32_bf16 v101, v191, v191, v101
    s_waitcnt vmcnt(10)
    s_waitcnt lgkmcnt(2)
    v_mfma_f32_16x16x32_bf16 v[16:19], v[64:67], v[192:195], v[16:19]
    ds_read_b128 v[56:59], v2 offset:26624
    v_mfma_f32_16x16x32_bf16 v[20:23], v[64:67], v[196:199], v[20:23]
    v_mfma_f32_16x16x32_bf16 v[24:27], v[68:71], v[192:195], v[24:27]
    ds_read_b128 v[60:63], v2 offset:27648
    buffer_load_dwordx4 v[240:243], v5, s[8:11], s25 offen offset:2048
    buffer_load_dwordx4 v[244:247], v5, s[8:11], s25 offen offset:2304
    v_dot2_f32_bf16 v98, v192, s28, v98
    v_dot2_f32_bf16 v99, v192, v192, v99
    v_dot2_f32_bf16 v98, v193, s28, v98
    v_dot2_f32_bf16 v99, v193, v193, v99
    v_dot2_f32_bf16 v98, v194, s28, v98
    v_dot2_f32_bf16 v99, v194, v194, v99
    v_dot2_f32_bf16 v98, v195, s28, v98
    v_dot2_f32_bf16 v99, v195, v195, v99
    v_mfma_f32_16x16x32_bf16 v[28:31], v[68:71], v[196:199], v[28:31]
    v_dot2_f32_bf16 v100, v196, s28, v100
    v_dot2_f32_bf16 v101, v196, v196, v101
    v_dot2_f32_bf16 v100, v197, s28, v100
    v_dot2_f32_bf16 v101, v197, v197, v101
    v_dot2_f32_bf16 v100, v198, s28, v100
    v_dot2_f32_bf16 v101, v198, v198, v101
    v_dot2_f32_bf16 v100, v199, s28, v100
    v_dot2_f32_bf16 v101, v199, v199, v101
    s_waitcnt vmcnt(10)
    s_waitcnt lgkmcnt(2)
    v_mfma_f32_16x16x32_bf16 v[16:19], v[48:51], v[200:203], v[16:19]
    ds_read_b128 v[64:67], v2 offset:28672
    v_mfma_f32_16x16x32_bf16 v[20:23], v[48:51], v[204:207], v[20:23]
    v_mfma_f32_16x16x32_bf16 v[24:27], v[52:55], v[200:203], v[24:27]
    ds_read_b128 v[68:71], v2 offset:29696
    v_dot2_f32_bf16 v98, v200, s28, v98
    v_dot2_f32_bf16 v99, v200, v200, v99
    v_dot2_f32_bf16 v98, v201, s28, v98
    v_dot2_f32_bf16 v99, v201, v201, v99
    v_dot2_f32_bf16 v98, v202, s28, v98
    v_dot2_f32_bf16 v99, v202, v202, v99
    v_dot2_f32_bf16 v98, v203, s28, v98
    v_dot2_f32_bf16 v99, v203, v203, v99
    v_mfma_f32_16x16x32_bf16 v[28:31], v[52:55], v[204:207], v[28:31]
    v_dot2_f32_bf16 v100, v204, s28, v100
    v_dot2_f32_bf16 v101, v204, v204, v101
    v_dot2_f32_bf16 v100, v205, s28, v100
    v_dot2_f32_bf16 v101, v205, v205, v101
    v_dot2_f32_bf16 v100, v206, s28, v100
    v_dot2_f32_bf16 v101, v206, v206, v101
    v_dot2_f32_bf16 v100, v207, s28, v100
    v_dot2_f32_bf16 v101, v207, v207, v101
    s_waitcnt vmcnt(8)
    s_waitcnt lgkmcnt(2)
    v_mfma_f32_16x16x32_bf16 v[16:19], v[56:59], v[208:211], v[16:19]
    ds_read_b128 v[48:51], v2 offset:30720
    v_mfma_f32_16x16x32_bf16 v[20:23], v[56:59], v[212:215], v[20:23]
    v_mfma_f32_16x16x32_bf16 v[24:27], v[60:63], v[208:211], v[24:27]
    ds_read_b128 v[52:55], v2 offset:31744
    v_dot2_f32_bf16 v98, v208, s28, v98
    v_dot2_f32_bf16 v99, v208, v208, v99
    v_dot2_f32_bf16 v98, v209, s28, v98
    v_dot2_f32_bf16 v99, v209, v209, v99
    v_dot2_f32_bf16 v98, v210, s28, v98
    v_dot2_f32_bf16 v99, v210, v210, v99
    v_dot2_f32_bf16 v98, v211, s28, v98
    v_dot2_f32_bf16 v99, v211, v211, v99
    v_mfma_f32_16x16x32_bf16 v[28:31], v[60:63], v[212:215], v[28:31]
    v_dot2_f32_bf16 v100, v212, s28, v100
    v_dot2_f32_bf16 v101, v212, v212, v101
    v_dot2_f32_bf16 v100, v213, s28, v100
    v_dot2_f32_bf16 v101, v213, v213, v101
    v_dot2_f32_bf16 v100, v214, s28, v100
    v_dot2_f32_bf16 v101, v214, v214, v101
    v_dot2_f32_bf16 v100, v215, s28, v100
    v_dot2_f32_bf16 v101, v215, v215, v101
    s_waitcnt vmcnt(6)
    s_waitcnt lgkmcnt(2)
    v_mfma_f32_16x16x32_bf16 v[16:19], v[64:67], v[216:219], v[16:19]
    ds_read_b128 v[56:59], v2 offset:32768
    v_mfma_f32_16x16x32_bf16 v[20:23], v[64:67], v[220:223], v[20:23]
    v_mfma_f32_16x16x32_bf16 v[24:27], v[68:71], v[216:219], v[24:27]
    ds_read_b128 v[60:63], v2 offset:33792
    v_dot2_f32_bf16 v98, v216, s28, v98
    v_dot2_f32_bf16 v99, v216, v216, v99
    v_dot2_f32_bf16 v98, v217, s28, v98
    v_dot2_f32_bf16 v99, v217, v217, v99
    v_dot2_f32_bf16 v98, v218, s28, v98
    v_dot2_f32_bf16 v99, v218, v218, v99
    v_dot2_f32_bf16 v98, v219, s28, v98
    v_dot2_f32_bf16 v99, v219, v219, v99
    v_mfma_f32_16x16x32_bf16 v[28:31], v[68:71], v[220:223], v[28:31]
    v_dot2_f32_bf16 v100, v220, s28, v100
    v_dot2_f32_bf16 v101, v220, v220, v101
    v_dot2_f32_bf16 v100, v221, s28, v100
    v_dot2_f32_bf16 v101, v221, v221, v101
    v_dot2_f32_bf16 v100, v222, s28, v100
    v_dot2_f32_bf16 v101, v222, v222, v101
    v_dot2_f32_bf16 v100, v223, s28, v100
    v_dot2_f32_bf16 v101, v223, v223, v101
    s_waitcnt vmcnt(4)
    s_waitcnt lgkmcnt(2)
    v_mfma_f32_16x16x32_bf16 v[16:19], v[48:51], v[224:227], v[16:19]
    ds_read_b128 v[64:67], v2 offset:34816
    v_mfma_f32_16x16x32_bf16 v[20:23], v[48:51], v[228:231], v[20:23]
    v_mfma_f32_16x16x32_bf16 v[24:27], v[52:55], v[224:227], v[24:27]
    ds_read_b128 v[68:71], v2 offset:35840
    v_dot2_f32_bf16 v98, v224, s28, v98
    v_dot2_f32_bf16 v99, v224, v224, v99
    v_dot2_f32_bf16 v98, v225, s28, v98
    v_dot2_f32_bf16 v99, v225, v225, v99
    v_dot2_f32_bf16 v98, v226, s28, v98
    v_dot2_f32_bf16 v99, v226, v226, v99
    v_dot2_f32_bf16 v98, v227, s28, v98
    v_dot2_f32_bf16 v99, v227, v227, v99
    v_mfma_f32_16x16x32_bf16 v[28:31], v[52:55], v[228:231], v[28:31]
    v_dot2_f32_bf16 v100, v228, s28, v100
    v_dot2_f32_bf16 v101, v228, v228, v101
    v_dot2_f32_bf16 v100, v229, s28, v100
    v_dot2_f32_bf16 v101, v229, v229, v101
    v_dot2_f32_bf16 v100, v230, s28, v100
    v_dot2_f32_bf16 v101, v230, v230, v101
    v_dot2_f32_bf16 v100, v231, s28, v100
    v_dot2_f32_bf16 v101, v231, v231, v101
    s_waitcnt vmcnt(2)
    s_waitcnt lgkmcnt(2)
    v_mfma_f32_16x16x32_bf16 v[16:19], v[56:59], v[232:235], v[16:19]
    ds_read_b128 v[8:11], v4 offset:0
    v_mfma_f32_16x16x32_bf16 v[20:23], v[56:59], v[236:239], v[20:23]
    v_mfma_f32_16x16x32_bf16 v[24:27], v[60:63], v[232:235], v[24:27]
    ds_read_b128 v[12:15], v4 offset:256
    v_add_u32 v4, 512, v4
    v_dot2_f32_bf16 v98, v232, s28, v98
    v_dot2_f32_bf16 v99, v232, v232, v99
    v_dot2_f32_bf16 v98, v233, s28, v98
    v_dot2_f32_bf16 v99, v233, v233, v99
    v_dot2_f32_bf16 v98, v234, s28, v98
    v_dot2_f32_bf16 v99, v234, v234, v99
    v_dot2_f32_bf16 v98, v235, s28, v98
    v_dot2_f32_bf16 v99, v235, v235, v99
    v_mfma_f32_16x16x32_bf16 v[28:31], v[60:63], v[236:239], v[28:31]
    v_dot2_f32_bf16 v100, v236, s28, v100
    v_dot2_f32_bf16 v101, v236, v236, v101
    v_dot2_f32_bf16 v100, v237, s28, v100
    v_dot2_f32_bf16 v101, v237, v237, v101
    v_dot2_f32_bf16 v100, v238, s28, v100
    v_dot2_f32_bf16 v101, v238, v238, v101
    v_dot2_f32_bf16 v100, v239, s28, v100
    v_dot2_f32_bf16 v101, v239, v239, v101
    s_waitcnt vmcnt(0)
    s_waitcnt lgkmcnt(2)
    v_mfma_f32_16x16x32_bf16 v[16:19], v[64:67], v[240:243], v[16:19]
    s_waitcnt vmcnt(1)
    s_barrier
    ds_read_b128 v[48:51], v6 offset:0
    v_mfma_f32_16x16x32_bf16 v[20:23], v[64:67], v[244:247], v[20:23]
    v_mfma_f32_16x16x32_bf16 v[24:27], v[68:71], v[240:243], v[24:27]
    ds_read_b128 v[52:55], v6 offset:1024
    v_dot2_f32_bf16 v98, v240, s28, v98
    v_dot2_f32_bf16 v99, v240, v240, v99
    v_dot2_f32_bf16 v98, v241, s28, v98
    v_dot2_f32_bf16 v99, v241, v241, v99
    v_dot2_f32_bf16 v98, v242, s28, v98
    v_dot2_f32_bf16 v99, v242, v242, v99
    v_dot2_f32_bf16 v98, v243, s28, v98
    v_dot2_f32_bf16 v99, v243, v243, v99
    v_mfma_f32_16x16x32_bf16 v[28:31], v[68:71], v[244:247], v[28:31]
    v_dot2_f32_bf16 v100, v244, s28, v100
    v_dot2_f32_bf16 v101, v244, v244, v101
    v_dot2_f32_bf16 v100, v245, s28, v100
    v_dot2_f32_bf16 v101, v245, v245, v101
    v_dot2_f32_bf16 v100, v246, s28, v100
    v_dot2_f32_bf16 v101, v246, v246, v101
    v_dot2_f32_bf16 v100, v247, s28, v100
    v_dot2_f32_bf16 v101, v247, v247, v101
    s_nop 3
    v_mov_b32 v72, v98
    v_mov_b32 v73, v99
    v_mov_b32 v74, v100
    v_mov_b32 v75, v101
    s_nop 1
    v_permlane32_swap_b32 v72, v98
    v_permlane32_swap_b32 v73, v99
    v_permlane32_swap_b32 v74, v100
    v_permlane32_swap_b32 v75, v101
    v_add_f32 v98, v98, v72
    v_add_f32 v99, v99, v73
    v_add_f32 v100, v100, v74
    v_add_f32 v101, v101, v75
    v_mov_b32 v72, v98
    v_mov_b32 v73, v99
    v_mov_b32 v74, v100
    v_mov_b32 v75, v101
    s_nop 1
    v_permlane16_swap_b32 v72, v98
    v_permlane16_swap_b32 v73, v99
    v_permlane16_swap_b32 v74, v100
    v_permlane16_swap_b32 v75, v101
    v_add_f32 v98, v98, v72
    v_add_f32 v99, v99, v73
    v_add_f32 v100, v100, v74
    v_add_f32 v101, v101, v75
    s_mov_b32 s22, 0x3ae38e39
    s_mov_b32 s23, 0x3727c5ac
    v_cmp_gt_u32 vcc, 16, v0
    v_mul_f32 v98, s22, v98
    v_mul_f32 v99, s22, v99
    v_fma_f32 v99, -v98, v98, v99
    v_max_f32 v99, 0, v99
    v_cvt_pk_bf16_f32 v99, v99, v99
    v_lshlrev_b32 v99, 16, v99
    v_add_f32 v99, s23, v99
    v_cvt_pk_bf16_f32 v99, v99, v99
    v_lshlrev_b32 v99, 16, v99
    v_sqrt_f32 v99, v99
    v_cvt_pk_bf16_f32 v248, -v98, -v98
    v_cvt_pk_bf16_f32 v249, -v98, v99
    v_cvt_pk_bf16_f32 v250, v99, v99
    v_mov_b32 v251, 0
    v_lshlrev_b32 v99, 16, v250
    v_rcp_f32 v96, v99
    v_cndmask_b32 v248, 0, v248, vcc
    v_mul_f32 v96, s24, v96
    v_cndmask_b32 v249, 0, v249, vcc
    v_cndmask_b32 v250, 0, v250, vcc
    v_mul_f32 v100, s22, v100
    v_mul_f32 v101, s22, v101
    v_fma_f32 v101, -v100, v100, v101
    v_max_f32 v101, 0, v101
    v_cvt_pk_bf16_f32 v101, v101, v101
    v_lshlrev_b32 v101, 16, v101
    v_add_f32 v101, s23, v101
    v_cvt_pk_bf16_f32 v101, v101, v101
    v_lshlrev_b32 v101, 16, v101
    v_sqrt_f32 v101, v101
    v_cvt_pk_bf16_f32 v252, -v100, -v100
    v_cvt_pk_bf16_f32 v253, -v100, v101
    v_cvt_pk_bf16_f32 v254, v101, v101
    v_mov_b32 v255, 0
    v_lshlrev_b32 v101, 16, v254
    v_rcp_f32 v97, v101
    v_cndmask_b32 v252, 0, v252, vcc
    v_mul_f32 v97, s24, v97
    v_cndmask_b32 v253, 0, v253, vcc
    v_cndmask_b32 v254, 0, v254, vcc
    s_nop 1
    s_waitcnt lgkmcnt(2)
    v_mfma_f32_16x16x32_bf16 v[16:19], v[8:11], v[248:251], v[16:19]
    ds_read_b128 v[56:59], v6 offset:2048
    v_mfma_f32_16x16x32_bf16 v[20:23], v[8:11], v[252:255], v[20:23]
    v_mfma_f32_16x16x32_bf16 v[24:27], v[12:15], v[248:251], v[24:27]
    ds_read_b128 v[60:63], v6 offset:3072
    v_mfma_f32_16x16x32_bf16 v[28:31], v[12:15], v[252:255], v[28:31]
    s_mov_b32 s29, 0
g1_cloop:
    s_waitcnt lgkmcnt(2)
    v_mfma_f32_16x16x32_bf16 v[32:35], v[48:51], v[104:107], 0
    ds_read_b128 v[64:67], v6 offset:4096
    v_mfma_f32_16x16x32_bf16 v[36:39], v[48:51], v[108:111], 0
    v_mfma_f32_16x16x32_bf16 v[40:43], v[52:55], v[104:107], 0
    ds_read_b128 v[68:71], v6 offset:5120
    v_mfma_f32_16x16x32_bf16 v[44:47], v[52:55], v[108:111], 0
    s_waitcnt lgkmcnt(2)
    v_mfma_f32_16x16x32_bf16 v[32:35], v[56:59], v[112:115], v[32:35]
    ds_read_b128 v[48:51], v6 offset:6144
    v_mfma_f32_16x16x32_bf16 v[36:39], v[56:59], v[116:119], v[36:39]
    v_mfma_f32_16x16x32_bf16 v[40:43], v[60:63], v[112:115], v[40:43]
    ds_read_b128 v[52:55], v6 offset:7168
    v_mul_f32 v16, v96, v16
    v_mul_f32 v17, v96, v17
    v_mfma_f32_16x16x32_bf16 v[44:47], v[60:63], v[116:119], v[44:47]
    v_mul_f32 v18, v96, v18
    s_waitcnt lgkmcnt(2)
    v_mfma_f32_16x16x32_bf16 v[32:35], v[64:67], v[120:123], v[32:35]
    ds_read_b128 v[56:59], v6 offset:8192
    v_mul_f32 v19, v96, v19
    v_mfma_f32_16x16x32_bf16 v[36:39], v[64:67], v[124:127], v[36:39]
    v_exp_f32 v72, v16
    v_exp_f32 v73, v17
    v_mfma_f32_16x16x32_bf16 v[40:43], v[68:71], v[120:123], v[40:43]
    ds_read_b128 v[60:63], v6 offset:9216
    v_exp_f32 v74, v18
    v_mfma_f32_16x16x32_bf16 v[44:47], v[68:71], v[124:127], v[44:47]
    v_exp_f32 v75, v19
    s_waitcnt lgkmcnt(2)
    v_mfma_f32_16x16x32_bf16 v[32:35], v[48:51], v[128:131], v[32:35]
    ds_read_b128 v[64:67], v6 offset:10240
    v_fma_f32 v72, v72, s24, s24
    v_fma_f32 v73, v73, s24, s24
    v_mfma_f32_16x16x32_bf16 v[36:39], v[48:51], v[132:135], v[36:39]
    v_fma_f32 v74, v74, s24, s24
    v_mfma_f32_16x16x32_bf16 v[40:43], v[52:55], v[128:131], v[40:43]
    ds_read_b128 v[68:71], v6 offset:11264
    v_fma_f32 v75, v75, s24, s24
    v_mfma_f32_16x16x32_bf16 v[44:47], v[52:55], v[132:135], v[44:47]
    v_rcp_f32 v72, v72
    v_rcp_f32 v73, v73
    s_waitcnt lgkmcnt(2)
    v_mfma_f32_16x16x32_bf16 v[32:35], v[56:59], v[136:139], v[32:35]
    ds_read_b128 v[48:51], v6 offset:12288
    v_rcp_f32 v74, v74
    v_mfma_f32_16x16x32_bf16 v[36:39], v[56:59], v[140:143], v[36:39]
    v_rcp_f32 v75, v75
    v_mfma_f32_16x16x32_bf16 v[40:43], v[60:63], v[136:139], v[40:43]
    ds_read_b128 v[52:55], v6 offset:13312
    v_mul_f32 v72, v72, v16
    v_mul_f32 v73, v73, v17
    v_mfma_f32_16x16x32_bf16 v[44:47], v[60:63], v[140:143], v[44:47]
    v_mul_f32 v74, v74, v18
    s_waitcnt lgkmcnt(2)
    v_mfma_f32_16x16x32_bf16 v[32:35], v[64:67], v[144:147], v[32:35]
    ds_read_b128 v[56:59], v6 offset:14336
    v_mul_f32 v75, v75, v19
    v_mfma_f32_16x16x32_bf16 v[36:39], v[64:67], v[148:151], v[36:39]
    v_cvt_pk_bf16_f32 v88, v72, v73
    v_cvt_pk_bf16_f32 v89, v74, v75
    v_mfma_f32_16x16x32_bf16 v[40:43], v[68:71], v[144:147], v[40:43]
    ds_read_b128 v[60:63], v6 offset:15360
    v_mul_f32 v24, v96, v24
    v_mfma_f32_16x16x32_bf16 v[44:47], v[68:71], v[148:151], v[44:47]
    v_mul_f32 v25, v96, v25
    s_waitcnt lgkmcnt(2)
    v_mfma_f32_16x16x32_bf16 v[32:35], v[48:51], v[152:155], v[32:35]
    ds_read_b128 v[64:67], v6 offset:16384
    v_mul_f32 v26, v96, v26
    v_mfma_f32_16x16x32_bf16 v[36:39], v[48:51], v[156:159], v[36:39]
    v_mul_f32 v27, v96, v27
    v_exp_f32 v76, v24
    v_mfma_f32_16x16x32_bf16 v[40:43], v[52:55], v[152:155], v[40:43]
    ds_read_b128 v[68:71], v6 offset:17408
    v_exp_f32 v77, v25
    v_mfma_f32_16x16x32_bf16 v[44:47], v[52:55], v[156:159], v[44:47]
    v_exp_f32 v78, v26
    s_waitcnt lgkmcnt(2)
    v_mfma_f32_16x16x32_bf16 v[32:35], v[56:59], v[160:163], v[32:35]
    ds_read_b128 v[48:51], v6 offset:18432
    v_exp_f32 v79, v27
    v_fma_f32 v76, v76, s24, s24
    v_mfma_f32_16x16x32_bf16 v[36:39], v[56:59], v[164:167], v[36:39]
    v_fma_f32 v77, v77, s24, s24
    v_mfma_f32_16x16x32_bf16 v[40:43], v[60:63], v[160:163], v[40:43]
    ds_read_b128 v[52:55], v6 offset:19456
    v_fma_f32 v78, v78, s24, s24
    v_mfma_f32_16x16x32_bf16 v[44:47], v[60:63], v[164:167], v[44:47]
    v_fma_f32 v79, v79, s24, s24
    v_rcp_f32 v76, v76
    s_waitcnt lgkmcnt(2)
    v_mfma_f32_16x16x32_bf16 v[32:35], v[64:67], v[168:171], v[32:35]
    ds_read_b128 v[56:59], v6 offset:20480
    v_rcp_f32 v77, v77
    v_mfma_f32_16x16x32_bf16 v[36:39], v[64:67], v[172:175], v[36:39]
    v_rcp_f32 v78, v78
    v_mfma_f32_16x16x32_bf16 v[40:43], v[68:71], v[168:171], v[40:43]
    ds_read_b128 v[60:63], v6 offset:21504
    v_rcp_f32 v79, v79
    v_mul_f32 v76, v76, v24
    v_mfma_f32_16x16x32_bf16 v[44:47], v[68:71], v[172:175], v[44:47]
    v_mul_f32 v77, v77, v25
    s_waitcnt lgkmcnt(2)
    v_mfma_f32_16x16x32_bf16 v[32:35], v[48:51], v[176:179], v[32:35]
    ds_read_b128 v[64:67], v6 offset:22528
    v_mul_f32 v78, v78, v26
    v_mfma_f32_16x16x32_bf16 v[36:39], v[48:51], v[180:183], v[36:39]
    v_mul_f32 v79, v79, v27
    v_cvt_pk_bf16_f32 v90, v76, v77
    v_mfma_f32_16x16x32_bf16 v[40:43], v[52:55], v[176:179], v[40:43]
    ds_read_b128 v[68:71], v6 offset:23552
    v_cvt_pk_bf16_f32 v91, v78, v79
    v_mfma_f32_16x16x32_bf16 v[44:47], v[52:55], v[180:183], v[44:47]
    buffer_store_dwordx4 v[88:91], v1, s[8:11], s20 offen sc1
    s_waitcnt lgkmcnt(2)
    v_mfma_f32_16x16x32_bf16 v[32:35], v[56:59], v[184:187], v[32:35]
    ds_read_b128 v[48:51], v6 offset:24576
    v_mul_f32 v20, v97, v20
    v_mfma_f32_16x16x32_bf16 v[36:39], v[56:59], v[188:191], v[36:39]
    v_mul_f32 v21, v97, v21
    v_mul_f32 v22, v97, v22
    v_mfma_f32_16x16x32_bf16 v[40:43], v[60:63], v[184:187], v[40:43]
    ds_read_b128 v[52:55], v6 offset:25600
    v_mul_f32 v23, v97, v23
    v_mfma_f32_16x16x32_bf16 v[44:47], v[60:63], v[188:191], v[44:47]
    v_exp_f32 v80, v20
    s_waitcnt lgkmcnt(2)
    v_mfma_f32_16x16x32_bf16 v[32:35], v[64:67], v[192:195], v[32:35]
    ds_read_b128 v[56:59], v6 offset:26624
    v_exp_f32 v81, v21
    v_exp_f32 v82, v22
    v_mfma_f32_16x16x32_bf16 v[36:39], v[64:67], v[196:199], v[36:39]
    v_exp_f32 v83, v23
    v_mfma_f32_16x16x32_bf16 v[40:43], v[68:71], v[192:195], v[40:43]
    ds_read_b128 v[60:63], v6 offset:27648
    v_fma_f32 v80, v80, s24, s24
    v_mfma_f32_16x16x32_bf16 v[44:47], v[68:71], v[196:199], v[44:47]
    v_fma_f32 v81, v81, s24, s24
    v_fma_f32 v82, v82, s24, s24
    s_waitcnt lgkmcnt(2)
    v_mfma_f32_16x16x32_bf16 v[32:35], v[48:51], v[200:203], v[32:35]
    ds_read_b128 v[64:67], v6 offset:28672
    v_fma_f32 v83, v83, s24, s24
    v_mfma_f32_16x16x32_bf16 v[36:39], v[48:51], v[204:207], v[36:39]
    v_rcp_f32 v80, v80
    v_mfma_f32_16x16x32_bf16 v[40:43], v[52:55], v[200:203], v[40:43]
    ds_read_b128 v[68:71], v6 offset:29696
    v_rcp_f32 v81, v81
    v_rcp_f32 v82, v82
    v_mfma_f32_16x16x32_bf16 v[44:47], v[52:55], v[204:207], v[44:47]
    v_rcp_f32 v83, v83
    s_waitcnt lgkmcnt(2)
    v_mfma_f32_16x16x32_bf16 v[32:35], v[56:59], v[208:211], v[32:35]
    ds_read_b128 v[48:51], v6 offset:30720
    v_mul_f32 v80, v80, v20
    v_mfma_f32_16x16x32_bf16 v[36:39], v[56:59], v[212:215], v[36:39]
    v_mul_f32 v81, v81, v21
    v_mul_f32 v82, v82, v22
    v_mfma_f32_16x16x32_bf16 v[40:43], v[60:63], v[208:211], v[40:43]
    ds_read_b128 v[52:55], v6 offset:31744
    v_mul_f32 v83, v83, v23
    v_mfma_f32_16x16x32_bf16 v[44:47], v[60:63], v[212:215], v[44:47]
    v_cvt_pk_bf16_f32 v92, v80, v81
    s_waitcnt lgkmcnt(2)
    v_mfma_f32_16x16x32_bf16 v[32:35], v[64:67], v[216:219], v[32:35]
    ds_read_b128 v[56:59], v6 offset:32768
    v_cvt_pk_bf16_f32 v93, v82, v83
    v_mul_f32 v28, v97, v28
    v_mfma_f32_16x16x32_bf16 v[36:39], v[64:67], v[220:223], v[36:39]
    v_mul_f32 v29, v97, v29
    v_mfma_f32_16x16x32_bf16 v[40:43], v[68:71], v[216:219], v[40:43]
    ds_read_b128 v[60:63], v6 offset:33792
    v_mul_f32 v30, v97, v30
    v_mfma_f32_16x16x32_bf16 v[44:47], v[68:71], v[220:223], v[44:47]
    v_mul_f32 v31, v97, v31
    s_waitcnt lgkmcnt(2)
    v_mfma_f32_16x16x32_bf16 v[32:35], v[48:51], v[224:227], v[32:35]
    ds_read_b128 v[64:67], v6 offset:34816
    v_exp_f32 v84, v28
    v_exp_f32 v85, v29
    v_mfma_f32_16x16x32_bf16 v[36:39], v[48:51], v[228:231], v[36:39]
    v_exp_f32 v86, v30
    v_mfma_f32_16x16x32_bf16 v[40:43], v[52:55], v[224:227], v[40:43]
    ds_read_b128 v[68:71], v6 offset:35840
    v_exp_f32 v87, v31
    v_mfma_f32_16x16x32_bf16 v[44:47], v[52:55], v[228:231], v[44:47]
    v_fma_f32 v84, v84, s24, s24
    v_fma_f32 v85, v85, s24, s24
    s_waitcnt lgkmcnt(2)
    v_mfma_f32_16x16x32_bf16 v[32:35], v[56:59], v[232:235], v[32:35]
    ds_read_b128 v[8:11], v4 offset:0
    v_fma_f32 v86, v86, s24, s24
    v_mfma_f32_16x16x32_bf16 v[36:39], v[56:59], v[236:239], v[36:39]
    v_fma_f32 v87, v87, s24, s24
    v_mfma_f32_16x16x32_bf16 v[40:43], v[60:63], v[232:235], v[40:43]
    ds_read_b128 v[12:15], v4 offset:256
    v_add_u32 v4, 512, v4
    v_rcp_f32 v84, v84
    v_rcp_f32 v85, v85
    v_mfma_f32_16x16x32_bf16 v[44:47], v[60:63], v[236:239], v[44:47]
    v_rcp_f32 v86, v86
    s_waitcnt lgkmcnt(2)
    v_mfma_f32_16x16x32_bf16 v[32:35], v[64:67], v[240:243], v[32:35]
    s_waitcnt vmcnt(1)
    s_barrier
    ds_read_b128 v[48:51], v3 offset:0
    v_rcp_f32 v87, v87
    v_mfma_f32_16x16x32_bf16 v[36:39], v[64:67], v[244:247], v[36:39]
    v_mul_f32 v84, v84, v28
    v_mul_f32 v85, v85, v29
    v_mfma_f32_16x16x32_bf16 v[40:43], v[68:71], v[240:243], v[40:43]
    ds_read_b128 v[52:55], v3 offset:1024
    v_mul_f32 v86, v86, v30
    v_mfma_f32_16x16x32_bf16 v[44:47], v[68:71], v[244:247], v[44:47]
    v_mul_f32 v87, v87, v31
    s_waitcnt lgkmcnt(2)
    v_mfma_f32_16x16x32_bf16 v[32:35], v[8:11], v[248:251], v[32:35]
    ds_read_b128 v[56:59], v3 offset:2048
    v_cvt_pk_bf16_f32 v94, v84, v85
    v_cvt_pk_bf16_f32 v95, v86, v87
    v_mfma_f32_16x16x32_bf16 v[36:39], v[8:11], v[252:255], v[36:39]
    buffer_store_dwordx4 v[92:95], v1, s[8:11], s21 offen sc1
    v_mfma_f32_16x16x32_bf16 v[40:43], v[12:15], v[248:251], v[40:43]
    ds_read_b128 v[60:63], v3 offset:3072
    s_add_u32 s20, s20, 1024
    v_mfma_f32_16x16x32_bf16 v[44:47], v[12:15], v[252:255], v[44:47]
    s_add_u32 s21, s21, 1024
    s_waitcnt lgkmcnt(2)
    v_mfma_f32_16x16x32_bf16 v[16:19], v[48:51], v[104:107], 0
    ds_read_b128 v[64:67], v3 offset:4096
    v_mfma_f32_16x16x32_bf16 v[20:23], v[48:51], v[108:111], 0
    v_mfma_f32_16x16x32_bf16 v[24:27], v[52:55], v[104:107], 0
    ds_read_b128 v[68:71], v3 offset:5120
    v_mfma_f32_16x16x32_bf16 v[28:31], v[52:55], v[108:111], 0
    s_waitcnt lgkmcnt(2)
    v_mfma_f32_16x16x32_bf16 v[16:19], v[56:59], v[112:115], v[16:19]
    ds_read_b128 v[48:51], v3 offset:6144
    v_mfma_f32_16x16x32_bf16 v[20:23], v[56:59], v[116:119], v[20:23]
    v_mfma_f32_16x16x32_bf16 v[24:27], v[60:63], v[112:115], v[24:27]
    ds_read_b128 v[52:55], v3 offset:7168
    v_mul_f32 v32, v96, v32
    v_mul_f32 v33, v96, v33
    v_mfma_f32_16x16x32_bf16 v[28:31], v[60:63], v[116:119], v[28:31]
    v_mul_f32 v34, v96, v34
    s_waitcnt lgkmcnt(2)
    v_mfma_f32_16x16x32_bf16 v[16:19], v[64:67], v[120:123], v[16:19]
    ds_read_b128 v[56:59], v3 offset:8192
    v_mul_f32 v35, v96, v35
    v_mfma_f32_16x16x32_bf16 v[20:23], v[64:67], v[124:127], v[20:23]
    v_exp_f32 v72, v32
    v_exp_f32 v73, v33
    v_mfma_f32_16x16x32_bf16 v[24:27], v[68:71], v[120:123], v[24:27]
    ds_read_b128 v[60:63], v3 offset:9216
    v_exp_f32 v74, v34
    v_mfma_f32_16x16x32_bf16 v[28:31], v[68:71], v[124:127], v[28:31]
    v_exp_f32 v75, v35
    s_waitcnt lgkmcnt(2)
    v_mfma_f32_16x16x32_bf16 v[16:19], v[48:51], v[128:131], v[16:19]
    ds_read_b128 v[64:67], v3 offset:10240
    v_fma_f32 v72, v72, s24, s24
    v_fma_f32 v73, v73, s24, s24
    v_mfma_f32_16x16x32_bf16 v[20:23], v[48:51], v[132:135], v[20:23]
    v_fma_f32 v74, v74, s24, s24
    v_mfma_f32_16x16x32_bf16 v[24:27], v[52:55], v[128:131], v[24:27]
    ds_read_b128 v[68:71], v3 offset:11264
    v_fma_f32 v75, v75, s24, s24
    v_mfma_f32_16x16x32_bf16 v[28:31], v[52:55], v[132:135], v[28:31]
    v_rcp_f32 v72, v72
    v_rcp_f32 v73, v73
    s_waitcnt lgkmcnt(2)
    v_mfma_f32_16x16x32_bf16 v[16:19], v[56:59], v[136:139], v[16:19]
    ds_read_b128 v[48:51], v3 offset:12288
    v_rcp_f32 v74, v74
    v_mfma_f32_16x16x32_bf16 v[20:23], v[56:59], v[140:143], v[20:23]
    v_rcp_f32 v75, v75
    v_mfma_f32_16x16x32_bf16 v[24:27], v[60:63], v[136:139], v[24:27]
    ds_read_b128 v[52:55], v3 offset:13312
    v_mul_f32 v72, v72, v32
    v_mul_f32 v73, v73, v33
    v_mfma_f32_16x16x32_bf16 v[28:31], v[60:63], v[140:143], v[28:31]
    v_mul_f32 v74, v74, v34
    s_waitcnt lgkmcnt(2)
    v_mfma_f32_16x16x32_bf16 v[16:19], v[64:67], v[144:147], v[16:19]
    ds_read_b128 v[56:59], v3 offset:14336
    v_mul_f32 v75, v75, v35
    v_mfma_f32_16x16x32_bf16 v[20:23], v[64:67], v[148:151], v[20:23]
    v_cvt_pk_bf16_f32 v88, v72, v73
    v_cvt_pk_bf16_f32 v89, v74, v75
    v_mfma_f32_16x16x32_bf16 v[24:27], v[68:71], v[144:147], v[24:27]
    ds_read_b128 v[60:63], v3 offset:15360
    v_mul_f32 v40, v96, v40
    v_mfma_f32_16x16x32_bf16 v[28:31], v[68:71], v[148:151], v[28:31]
    v_mul_f32 v41, v96, v41
    s_waitcnt lgkmcnt(2)
    v_mfma_f32_16x16x32_bf16 v[16:19], v[48:51], v[152:155], v[16:19]
    ds_read_b128 v[64:67], v3 offset:16384
    v_mul_f32 v42, v96, v42
    v_mfma_f32_16x16x32_bf16 v[20:23], v[48:51], v[156:159], v[20:23]
    v_mul_f32 v43, v96, v43
    v_exp_f32 v76, v40
    v_mfma_f32_16x16x32_bf16 v[24:27], v[52:55], v[152:155], v[24:27]
    ds_read_b128 v[68:71], v3 offset:17408
    v_exp_f32 v77, v41
    v_mfma_f32_16x16x32_bf16 v[28:31], v[52:55], v[156:159], v[28:31]
    v_exp_f32 v78, v42
    s_waitcnt lgkmcnt(2)
    v_mfma_f32_16x16x32_bf16 v[16:19], v[56:59], v[160:163], v[16:19]
    ds_read_b128 v[48:51], v3 offset:18432
    v_exp_f32 v79, v43
    v_fma_f32 v76, v76, s24, s24
    v_mfma_f32_16x16x32_bf16 v[20:23], v[56:59], v[164:167], v[20:23]
    v_fma_f32 v77, v77, s24, s24
    v_mfma_f32_16x16x32_bf16 v[24:27], v[60:63], v[160:163], v[24:27]
    ds_read_b128 v[52:55], v3 offset:19456
    v_fma_f32 v78, v78, s24, s24
    v_mfma_f32_16x16x32_bf16 v[28:31], v[60:63], v[164:167], v[28:31]
    v_fma_f32 v79, v79, s24, s24
    v_rcp_f32 v76, v76
    s_waitcnt lgkmcnt(2)
    v_mfma_f32_16x16x32_bf16 v[16:19], v[64:67], v[168:171], v[16:19]
    ds_read_b128 v[56:59], v3 offset:20480
    v_rcp_f32 v77, v77
    v_mfma_f32_16x16x32_bf16 v[20:23], v[64:67], v[172:175], v[20:23]
    v_rcp_f32 v78, v78
    v_mfma_f32_16x16x32_bf16 v[24:27], v[68:71], v[168:171], v[24:27]
    ds_read_b128 v[60:63], v3 offset:21504
    v_rcp_f32 v79, v79
    v_mul_f32 v76, v76, v40
    v_mfma_f32_16x16x32_bf16 v[28:31], v[68:71], v[172:175], v[28:31]
    v_mul_f32 v77, v77, v41
    s_waitcnt lgkmcnt(2)
    v_mfma_f32_16x16x32_bf16 v[16:19], v[48:51], v[176:179], v[16:19]
    ds_read_b128 v[64:67], v3 offset:22528
    v_mul_f32 v78, v78, v42
    v_mfma_f32_16x16x32_bf16 v[20:23], v[48:51], v[180:183], v[20:23]
    v_mul_f32 v79, v79, v43
    v_cvt_pk_bf16_f32 v90, v76, v77
    v_mfma_f32_16x16x32_bf16 v[24:27], v[52:55], v[176:179], v[24:27]
    ds_read_b128 v[68:71], v3 offset:23552
    v_cvt_pk_bf16_f32 v91, v78, v79
    v_mfma_f32_16x16x32_bf16 v[28:31], v[52:55], v[180:183], v[28:31]
    buffer_store_dwordx4 v[88:91], v1, s[8:11], s20 offen sc1
    s_waitcnt lgkmcnt(2)
    v_mfma_f32_16x16x32_bf16 v[16:19], v[56:59], v[184:187], v[16:19]
    ds_read_b128 v[48:51], v3 offset:24576
    v_mul_f32 v36, v97, v36
    v_mfma_f32_16x16x32_bf16 v[20:23], v[56:59], v[188:191], v[20:23]
    v_mul_f32 v37, v97, v37
    v_mul_f32 v38, v97, v38
    v_mfma_f32_16x16x32_bf16 v[24:27], v[60:63], v[184:187], v[24:27]
    ds_read_b128 v[52:55], v3 offset:25600
    v_mul_f32 v39, v97, v39
    v_mfma_f32_16x16x32_bf16 v[28:31], v[60:63], v[188:191], v[28:31]
    v_exp_f32 v80, v36
    s_waitcnt lgkmcnt(2)
    v_mfma_f32_16x16x32_bf16 v[16:19], v[64:67], v[192:195], v[16:19]
    ds_read_b128 v[56:59], v3 offset:26624
    v_exp_f32 v81, v37
    v_exp_f32 v82, v38
    v_mfma_f32_16x16x32_bf16 v[20:23], v[64:67], v[196:199], v[20:23]
    v_exp_f32 v83, v39
    v_mfma_f32_16x16x32_bf16 v[24:27], v[68:71], v[192:195], v[24:27]
    ds_read_b128 v[60:63], v3 offset:27648
    v_fma_f32 v80, v80, s24, s24
    v_mfma_f32_16x16x32_bf16 v[28:31], v[68:71], v[196:199], v[28:31]
    v_fma_f32 v81, v81, s24, s24
    v_fma_f32 v82, v82, s24, s24
    s_waitcnt lgkmcnt(2)
    v_mfma_f32_16x16x32_bf16 v[16:19], v[48:51], v[200:203], v[16:19]
    ds_read_b128 v[64:67], v3 offset:28672
    v_fma_f32 v83, v83, s24, s24
    v_mfma_f32_16x16x32_bf16 v[20:23], v[48:51], v[204:207], v[20:23]
    v_rcp_f32 v80, v80
    v_mfma_f32_16x16x32_bf16 v[24:27], v[52:55], v[200:203], v[24:27]
    ds_read_b128 v[68:71], v3 offset:29696
    v_rcp_f32 v81, v81
    v_rcp_f32 v82, v82
    v_mfma_f32_16x16x32_bf16 v[28:31], v[52:55], v[204:207], v[28:31]
    v_rcp_f32 v83, v83
    s_waitcnt lgkmcnt(2)
    v_mfma_f32_16x16x32_bf16 v[16:19], v[56:59], v[208:211], v[16:19]
    ds_read_b128 v[48:51], v3 offset:30720
    v_mul_f32 v80, v80, v36
    v_mfma_f32_16x16x32_bf16 v[20:23], v[56:59], v[212:215], v[20:23]
    v_mul_f32 v81, v81, v37
    v_mul_f32 v82, v82, v38
    v_mfma_f32_16x16x32_bf16 v[24:27], v[60:63], v[208:211], v[24:27]
    ds_read_b128 v[52:55], v3 offset:31744
    v_mul_f32 v83, v83, v39
    v_mfma_f32_16x16x32_bf16 v[28:31], v[60:63], v[212:215], v[28:31]
    v_cvt_pk_bf16_f32 v92, v80, v81
    s_waitcnt lgkmcnt(2)
    v_mfma_f32_16x16x32_bf16 v[16:19], v[64:67], v[216:219], v[16:19]
    ds_read_b128 v[56:59], v3 offset:32768
    v_cvt_pk_bf16_f32 v93, v82, v83
    v_mul_f32 v44, v97, v44
    v_mfma_f32_16x16x32_bf16 v[20:23], v[64:67], v[220:223], v[20:23]
    v_mul_f32 v45, v97, v45
    v_mfma_f32_16x16x32_bf16 v[24:27], v[68:71], v[216:219], v[24:27]
    ds_read_b128 v[60:63], v3 offset:33792
    v_mul_f32 v46, v97, v46
    v_mfma_f32_16x16x32_bf16 v[28:31], v[68:71], v[220:223], v[28:31]
    v_mul_f32 v47, v97, v47
    s_waitcnt lgkmcnt(2)
    v_mfma_f32_16x16x32_bf16 v[16:19], v[48:51], v[224:227], v[16:19]
    ds_read_b128 v[64:67], v3 offset:34816
    v_exp_f32 v84, v44
    v_exp_f32 v85, v45
    v_mfma_f32_16x16x32_bf16 v[20:23], v[48:51], v[228:231], v[20:23]
    v_exp_f32 v86, v46
    v_mfma_f32_16x16x32_bf16 v[24:27], v[52:55], v[224:227], v[24:27]
    ds_read_b128 v[68:71], v3 offset:35840
    v_exp_f32 v87, v47
    v_mfma_f32_16x16x32_bf16 v[28:31], v[52:55], v[228:231], v[28:31]
    v_fma_f32 v84, v84, s24, s24
    v_fma_f32 v85, v85, s24, s24
    s_waitcnt lgkmcnt(2)
    v_mfma_f32_16x16x32_bf16 v[16:19], v[56:59], v[232:235], v[16:19]
    ds_read_b128 v[8:11], v4 offset:0
    v_fma_f32 v86, v86, s24, s24
    v_mfma_f32_16x16x32_bf16 v[20:23], v[56:59], v[236:239], v[20:23]
    v_fma_f32 v87, v87, s24, s24
    v_mfma_f32_16x16x32_bf16 v[24:27], v[60:63], v[232:235], v[24:27]
    ds_read_b128 v[12:15], v4 offset:256
    v_add_u32 v4, 512, v4
    v_rcp_f32 v84, v84
    v_rcp_f32 v85, v85
    v_mfma_f32_16x16x32_bf16 v[28:31], v[60:63], v[236:239], v[28:31]
    v_rcp_f32 v86, v86
    s_waitcnt lgkmcnt(2)
    v_mfma_f32_16x16x32_bf16 v[16:19], v[64:67], v[240:243], v[16:19]
    s_waitcnt vmcnt(1)
    s_barrier
    ds_read_b128 v[48:51], v7 offset:0
    v_rcp_f32 v87, v87
    v_mfma_f32_16x16x32_bf16 v[20:23], v[64:67], v[244:247], v[20:23]
    v_mul_f32 v84, v84, v44
    v_mul_f32 v85, v85, v45
    v_mfma_f32_16x16x32_bf16 v[24:27], v[68:71], v[240:243], v[24:27]
    ds_read_b128 v[52:55], v7 offset:1024
    v_mul_f32 v86, v86, v46
    v_mfma_f32_16x16x32_bf16 v[28:31], v[68:71], v[244:247], v[28:31]
    v_mul_f32 v87, v87, v47
    s_waitcnt lgkmcnt(2)
    v_mfma_f32_16x16x32_bf16 v[16:19], v[8:11], v[248:251], v[16:19]
    ds_read_b128 v[56:59], v7 offset:2048
    v_cvt_pk_bf16_f32 v94, v84, v85
    v_cvt_pk_bf16_f32 v95, v86, v87
    v_mfma_f32_16x16x32_bf16 v[20:23], v[8:11], v[252:255], v[20:23]
    buffer_store_dwordx4 v[92:95], v1, s[8:11], s21 offen sc1
    v_mfma_f32_16x16x32_bf16 v[24:27], v[12:15], v[248:251], v[24:27]
    ds_read_b128 v[60:63], v7 offset:3072
    s_add_u32 s20, s20, 1024
    v_mfma_f32_16x16x32_bf16 v[28:31], v[12:15], v[252:255], v[28:31]
    s_add_u32 s21, s21, 1024
    v_swap_b32 v2, v3
    v_swap_b32 v6, v7
    s_add_u32 s29, s29, 1
    s_cmp_lt_u32 s29, 4
    s_cbranch_scc1 g1_cloop
    s_lshl_b32 s30, s14, 11
    s_add_u32 s30, s30, 9216
    v_add_u32 v8, s30, v2
    v_add_u32 v9, s30, v6
    v_add_u32 v10, s30, v3
    v_add_u32 v11, s30, v7
    ds_read_b128 v[32:35], v9 offset:0
    ds_read_b128 v[36:39], v9 offset:1024
    ds_read_b128 v[104:107], v6 offset:0
    ds_read_b128 v[108:111], v6 offset:1024
    ds_read_b128 v[112:115], v6 offset:2048
    ds_read_b128 v[116:119], v6 offset:3072
    ds_read_b128 v[120:123], v6 offset:4096
    ds_read_b128 v[124:127], v6 offset:5120
    ds_read_b128 v[128:131], v6 offset:6144
    ds_read_b128 v[132:135], v6 offset:7168
    ds_read_b128 v[136:139], v6 offset:8192
    s_waitcnt lgkmcnt(8)
    v_mfma_f32_16x16x32_bf16 v[176:179], v[104:107], v[32:35], 0
    ds_read_b128 v[40:43], v9 offset:17408
    ds_read_b128 v[44:47], v9 offset:18432
    v_mfma_f32_16x16x32_bf16 v[180:183], v[104:107], v[36:39], 0
    ds_read_b128 v[140:143], v6 offset:17408
    s_waitcnt lgkmcnt(10)
    v_mfma_f32_16x16x32_bf16 v[184:187], v[108:111], v[32:35], 0
    v_mfma_f32_16x16x32_bf16 v[188:191], v[108:111], v[36:39], 0
    ds_read_b128 v[144:147], v6 offset:18432
    s_waitcnt lgkmcnt(10)
    v_mfma_f32_16x16x32_bf16 v[192:195], v[112:115], v[32:35], 0
    v_mfma_f32_16x16x32_bf16 v[196:199], v[112:115], v[36:39], 0
    ds_read_b128 v[148:151], v6 offset:19456
    s_waitcnt lgkmcnt(10)
    v_mfma_f32_16x16x32_bf16 v[200:203], v[116:119], v[32:35], 0
    v_mfma_f32_16x16x32_bf16 v[204:207], v[116:119], v[36:39], 0
    ds_read_b128 v[152:155], v6 offset:20480
    s_waitcnt lgkmcnt(10)
    v_mfma_f32_16x16x32_bf16 v[208:211], v[120:123], v[32:35], 0
    v_mul_f32 v16, v96, v16
    v_mul_f32 v17, v96, v17
    v_mfma_f32_16x16x32_bf16 v[212:215], v[120:123], v[36:39], 0
    ds_read_b128 v[156:159], v6 offset:21504
    v_mul_f32 v18, v96, v18
    v_mul_f32 v19, v96, v19
    s_waitcnt lgkmcnt(10)
    v_mfma_f32_16x16x32_bf16 v[216:219], v[124:127], v[32:35], 0
    v_exp_f32 v72, v16
    v_exp_f32 v73, v17
    v_mfma_f32_16x16x32_bf16 v[220:223], v[124:127], v[36:39], 0
    ds_read_b128 v[160:163], v6 offset:22528
    v_exp_f32 v74, v18
    v_exp_f32 v75, v19
    s_waitcnt lgkmcnt(10)
    v_mfma_f32_16x16x32_bf16 v[224:227], v[128:131], v[32:35], 0
    v_fma_f32 v72, v72, s24, s24
    v_fma_f32 v73, v73, s24, s24
    v_mfma_f32_16x16x32_bf16 v[228:231], v[128:131], v[36:39], 0
    ds_read_b128 v[164:167], v6 offset:23552
    v_fma_f32 v74, v74, s24, s24
    v_fma_f32 v75, v75, s24, s24
    s_waitcnt lgkmcnt(10)
    v_mfma_f32_16x16x32_bf16 v[232:235], v[132:135], v[32:35], 0
    v_rcp_f32 v72, v72
    v_rcp_f32 v73, v73
    v_mfma_f32_16x16x32_bf16 v[236:239], v[132:135], v[36:39], 0
    ds_read_b128 v[168:171], v6 offset:24576
    v_rcp_f32 v74, v74
    v_rcp_f32 v75, v75
    s_waitcnt lgkmcnt(10)
    v_mfma_f32_16x16x32_bf16 v[240:243], v[136:139], v[32:35], 0
    v_mul_f32 v72, v72, v16
    v_mul_f32 v73, v73, v17
    v_mfma_f32_16x16x32_bf16 v[244:247], v[136:139], v[36:39], 0
    ds_read_b128 v[172:175], v6 offset:25600
    v_mul_f32 v74, v74, v18
    v_mul_f32 v75, v75, v19
    s_barrier
    s_waitcnt lgkmcnt(8)
    v_mfma_f32_16x16x32_bf16 v[176:179], v[140:143], v[40:43], v[176:179]
    ds_read_b128 v[32:35], v10 offset:0
    ds_read_b128 v[36:39], v10 offset:1024
    v_cvt_pk_bf16_f32 v88, v72, v73
    v_cvt_pk_bf16_f32 v89, v74, v75
    v_mfma_f32_16x16x32_bf16 v[180:183], v[140:143], v[44:47], v[180:183]
    ds_read_b128 v[104:107], v3 offset:0
    v_mul_f32 v24, v96, v24
    v_mul_f32 v25, v96, v25
    s_waitcnt lgkmcnt(10)
    v_mfma_f32_16x16x32_bf16 v[184:187], v[144:147], v[40:43], v[184:187]
    v_mul_f32 v26, v96, v26
    v_mul_f32 v27, v96, v27
    v_mfma_f32_16x16x32_bf16 v[188:191], v[144:147], v[44:47], v[188:191]
    ds_read_b128 v[108:111], v3 offset:1024
    v_exp_f32 v76, v24
    v_exp_f32 v77, v25
    s_waitcnt lgkmcnt(10)
    v_mfma_f32_16x16x32_bf16 v[192:195], v[148:151], v[40:43], v[192:195]
    v_exp_f32 v78, v26
    v_exp_f32 v79, v27
    v_mfma_f32_16x16x32_bf16 v[196:199], v[148:151], v[44:47], v[196:199]
    ds_read_b128 v[112:115], v3 offset:2048
    v_fma_f32 v76, v76, s24, s24
    v_fma_f32 v77, v77, s24, s24
    s_waitcnt lgkmcnt(10)
    v_mfma_f32_16x16x32_bf16 v[200:203], v[152:155], v[40:43], v[200:203]
    v_fma_f32 v78, v78, s24, s24
    v_fma_f32 v79, v79, s24, s24
    v_mfma_f32_16x16x32_bf16 v[204:207], v[152:155], v[44:47], v[204:207]
    ds_read_b128 v[116:119], v3 offset:3072
    v_rcp_f32 v76, v76
    v_rcp_f32 v77, v77
    s_waitcnt lgkmcnt(10)
    v_mfma_f32_16x16x32_bf16 v[208:211], v[156:159], v[40:43], v[208:211]
    v_rcp_f32 v78, v78
    v_rcp_f32 v79, v79
    v_mfma_f32_16x16x32_bf16 v[212:215], v[156:159], v[44:47], v[212:215]
    ds_read_b128 v[120:123], v3 offset:4096
    v_mul_f32 v76, v76, v24
    v_mul_f32 v77, v77, v25
    s_waitcnt lgkmcnt(10)
    v_mfma_f32_16x16x32_bf16 v[216:219], v[160:163], v[40:43], v[216:219]
    v_mul_f32 v78, v78, v26
    v_mul_f32 v79, v79, v27
    v_mfma_f32_16x16x32_bf16 v[220:223], v[160:163], v[44:47], v[220:223]
    ds_read_b128 v[124:127], v3 offset:5120
    v_cvt_pk_bf16_f32 v90, v76, v77
    v_cvt_pk_bf16_f32 v91, v78, v79
    s_waitcnt lgkmcnt(10)
    v_mfma_f32_16x16x32_bf16 v[224:227], v[164:167], v[40:43], v[224:227]
    buffer_store_dwordx4 v[88:91], v1, s[8:11], s20 offen sc1
    v_mul_f32 v20, v97, v20
    v_mfma_f32_16x16x32_bf16 v[228:231], v[164:167], v[44:47], v[228:231]
    ds_read_b128 v[128:131], v3 offset:6144
    v_mul_f32 v21, v97, v21
    v_mul_f32 v22, v97, v22
    s_waitcnt lgkmcnt(10)
    v_mfma_f32_16x16x32_bf16 v[232:235], v[168:171], v[40:43], v[232:235]
    v_mul_f32 v23, v97, v23
    v_exp_f32 v80, v20
    v_mfma_f32_16x16x32_bf16 v[236:239], v[168:171], v[44:47], v[236:239]
    ds_read_b128 v[132:135], v3 offset:7168
    v_exp_f32 v81, v21
    v_exp_f32 v82, v22
    s_waitcnt lgkmcnt(10)
    v_mfma_f32_16x16x32_bf16 v[240:243], v[172:175], v[40:43], v[240:243]
    v_exp_f32 v83, v23
    v_fma_f32 v80, v80, s24, s24
    v_mfma_f32_16x16x32_bf16 v[244:247], v[172:175], v[44:47], v[244:247]
    ds_read_b128 v[136:139], v3 offset:8192
    v_fma_f32 v81, v81, s24, s24
    v_fma_f32 v82, v82, s24, s24
    s_waitcnt lgkmcnt(8)
    v_mfma_f32_16x16x32_bf16 v[176:179], v[104:107], v[32:35], v[176:179]
    ds_read_b128 v[40:43], v10 offset:17408
    ds_read_b128 v[44:47], v10 offset:18432
    v_fma_f32 v83, v83, s24, s24
    v_rcp_f32 v80, v80
    v_mfma_f32_16x16x32_bf16 v[180:183], v[104:107], v[36:39], v[180:183]
    ds_read_b128 v[140:143], v3 offset:17408
    v_rcp_f32 v81, v81
    v_rcp_f32 v82, v82
    s_waitcnt lgkmcnt(10)
    v_mfma_f32_16x16x32_bf16 v[184:187], v[108:111], v[32:35], v[184:187]
    v_rcp_f32 v83, v83
    v_mul_f32 v80, v80, v20
    v_mfma_f32_16x16x32_bf16 v[188:191], v[108:111], v[36:39], v[188:191]
    ds_read_b128 v[144:147], v3 offset:18432
    v_mul_f32 v81, v81, v21
    v_mul_f32 v82, v82, v22
    s_waitcnt lgkmcnt(10)
    v_mfma_f32_16x16x32_bf16 v[192:195], v[112:115], v[32:35], v[192:195]
    v_mul_f32 v83, v83, v23
    v_cvt_pk_bf16_f32 v92, v80, v81
    v_mfma_f32_16x16x32_bf16 v[196:199], v[112:115], v[36:39], v[196:199]
    ds_read_b128 v[148:151], v3 offset:19456
    v_cvt_pk_bf16_f32 v93, v82, v83
    v_mul_f32 v28, v97, v28
    s_waitcnt lgkmcnt(10)
    v_mfma_f32_16x16x32_bf16 v[200:203], v[116:119], v[32:35], v[200:203]
    v_mul_f32 v29, v97, v29
    v_mul_f32 v30, v97, v30
    v_mfma_f32_16x16x32_bf16 v[204:207], v[116:119], v[36:39], v[204:207]
    ds_read_b128 v[152:155], v3 offset:20480
    v_mul_f32 v31, v97, v31
    v_exp_f32 v84, v28
    s_waitcnt lgkmcnt(10)
    v_mfma_f32_16x16x32_bf16 v[208:211], v[120:123], v[32:35], v[208:211]
    v_exp_f32 v85, v29
    v_exp_f32 v86, v30
    v_mfma_f32_16x16x32_bf16 v[212:215], v[120:123], v[36:39], v[212:215]
    ds_read_b128 v[156:159], v3 offset:21504
    v_exp_f32 v87, v31
    v_fma_f32 v84, v84, s24, s24
    s_waitcnt lgkmcnt(10)
    v_mfma_f32_16x16x32_bf16 v[216:219], v[124:127], v[32:35], v[216:219]
    v_fma_f32 v85, v85, s24, s24
    v_fma_f32 v86, v86, s24, s24
    v_mfma_f32_16x16x32_bf16 v[220:223], v[124:127], v[36:39], v[220:223]
    ds_read_b128 v[160:163], v3 offset:22528
    v_fma_f32 v87, v87, s24, s24
    v_rcp_f32 v84, v84
    s_waitcnt lgkmcnt(10)
    v_mfma_f32_16x16x32_bf16 v[224:227], v[128:131], v[32:35], v[224:227]
    v_rcp_f32 v85, v85
    v_rcp_f32 v86, v86
    v_mfma_f32_16x16x32_bf16 v[228:231], v[128:131], v[36:39], v[228:231]
    ds_read_b128 v[164:167], v3 offset:23552
    v_rcp_f32 v87, v87
    v_mul_f32 v84, v84, v28
    s_waitcnt lgkmcnt(10)
    v_mfma_f32_16x16x32_bf16 v[232:235], v[132:135], v[32:35], v[232:235]
    v_mul_f32 v85, v85, v29
    v_mul_f32 v86, v86, v30
    v_mfma_f32_16x16x32_bf16 v[236:239], v[132:135], v[36:39], v[236:239]
    ds_read_b128 v[168:171], v3 offset:24576
    v_mul_f32 v87, v87, v31
    v_cvt_pk_bf16_f32 v94, v84, v85
    s_waitcnt lgkmcnt(10)
    v_mfma_f32_16x16x32_bf16 v[240:243], v[136:139], v[32:35], v[240:243]
    v_cvt_pk_bf16_f32 v95, v86, v87
    buffer_store_dwordx4 v[92:95], v1, s[8:11], s21 offen sc1
    v_mfma_f32_16x16x32_bf16 v[244:247], v[136:139], v[36:39], v[244:247]
    ds_read_b128 v[172:175], v3 offset:25600
    s_add_u32 s20, s20, 1024
    s_add_u32 s21, s21, 1024
    s_waitcnt vmcnt(0)
    s_barrier
    s_waitcnt lgkmcnt(8)
    v_mfma_f32_16x16x32_bf16 v[176:179], v[140:143], v[40:43], v[176:179]
    ds_read_b128 v[32:35], v11 offset:0
    ds_read_b128 v[36:39], v11 offset:1024
    v_mfma_f32_16x16x32_bf16 v[180:183], v[140:143], v[44:47], v[180:183]
    ds_read_b128 v[104:107], v7 offset:0
    s_waitcnt lgkmcnt(10)
    v_mfma_f32_16x16x32_bf16 v[184:187], v[144:147], v[40:43], v[184:187]
    v_mfma_f32_16x16x32_bf16 v[188:191], v[144:147], v[44:47], v[188:191]
    ds_read_b128 v[108:111], v7 offset:1024
    s_waitcnt lgkmcnt(10)
    v_mfma_f32_16x16x32_bf16 v[192:195], v[148:151], v[40:43], v[192:195]
    v_mfma_f32_16x16x32_bf16 v[196:199], v[148:151], v[44:47], v[196:199]
    ds_read_b128 v[112:115], v7 offset:2048
    s_waitcnt lgkmcnt(10)
    v_mfma_f32_16x16x32_bf16 v[200:203], v[152:155], v[40:43], v[200:203]
    v_mfma_f32_16x16x32_bf16 v[204:207], v[152:155], v[44:47], v[204:207]
    ds_read_b128 v[116:119], v7 offset:3072
    s_waitcnt lgkmcnt(10)
    v_mfma_f32_16x16x32_bf16 v[208:211], v[156:159], v[40:43], v[208:211]
    v_mfma_f32_16x16x32_bf16 v[212:215], v[156:159], v[44:47], v[212:215]
    ds_read_b128 v[120:123], v7 offset:4096
    s_waitcnt lgkmcnt(10)
    v_mfma_f32_16x16x32_bf16 v[216:219], v[160:163], v[40:43], v[216:219]
    v_mfma_f32_16x16x32_bf16 v[220:223], v[160:163], v[44:47], v[220:223]
    ds_read_b128 v[124:127], v7 offset:5120
    s_waitcnt lgkmcnt(10)
    v_mfma_f32_16x16x32_bf16 v[224:227], v[164:167], v[40:43], v[224:227]
    v_mfma_f32_16x16x32_bf16 v[228:231], v[164:167], v[44:47], v[228:231]
    ds_read_b128 v[128:131], v7 offset:6144
    s_waitcnt lgkmcnt(10)
    v_mfma_f32_16x16x32_bf16 v[232:235], v[168:171], v[40:43], v[232:235]
    v_mfma_f32_16x16x32_bf16 v[236:239], v[168:171], v[44:47], v[236:239]
    ds_read_b128 v[132:135], v7 offset:7168
    s_waitcnt lgkmcnt(10)
    v_mfma_f32_16x16x32_bf16 v[240:243], v[172:175], v[40:43], v[240:243]
    v_mfma_f32_16x16x32_bf16 v[244:247], v[172:175], v[44:47], v[244:247]
    ds_read_b128 v[136:139], v7 offset:8192
    s_mov_b32 s29, 0
m_loop2:
    s_waitcnt lgkmcnt(8)
    v_mfma_f32_16x16x32_bf16 v[176:179], v[104:107], v[32:35], v[176:179]
    ds_read_b128 v[40:43], v11 offset:17408
    ds_read_b128 v[44:47], v11 offset:18432
    v_mfma_f32_16x16x32_bf16 v[180:183], v[104:107], v[36:39], v[180:183]
    ds_read_b128 v[140:143], v7 offset:17408
    s_waitcnt lgkmcnt(10)
    v_mfma_f32_16x16x32_bf16 v[184:187], v[108:111], v[32:35], v[184:187]
    v_mfma_f32_16x16x32_bf16 v[188:191], v[108:111], v[36:39], v[188:191]
    ds_read_b128 v[144:147], v7 offset:18432
    s_waitcnt lgkmcnt(10)
    v_mfma_f32_16x16x32_bf16 v[192:195], v[112:115], v[32:35], v[192:195]
    v_mfma_f32_16x16x32_bf16 v[196:199], v[112:115], v[36:39], v[196:199]
    ds_read_b128 v[148:151], v7 offset:19456
    s_waitcnt lgkmcnt(10)
    v_mfma_f32_16x16x32_bf16 v[200:203], v[116:119], v[32:35], v[200:203]
    v_mfma_f32_16x16x32_bf16 v[204:207], v[116:119], v[36:39], v[204:207]
    ds_read_b128 v[152:155], v7 offset:20480
    s_waitcnt lgkmcnt(10)
    v_mfma_f32_16x16x32_bf16 v[208:211], v[120:123], v[32:35], v[208:211]
    v_mfma_f32_16x16x32_bf16 v[212:215], v[120:123], v[36:39], v[212:215]
    ds_read_b128 v[156:159], v7 offset:21504
    s_waitcnt lgkmcnt(10)
    v_mfma_f32_16x16x32_bf16 v[216:219], v[124:127], v[32:35], v[216:219]
    v_mfma_f32_16x16x32_bf16 v[220:223], v[124:127], v[36:39], v[220:223]
    ds_read_b128 v[160:163], v7 offset:22528
    s_waitcnt lgkmcnt(10)
    v_mfma_f32_16x16x32_bf16 v[224:227], v[128:131], v[32:35], v[224:227]
    v_mfma_f32_16x16x32_bf16 v[228:231], v[128:131], v[36:39], v[228:231]
    ds_read_b128 v[164:167], v7 offset:23552
    s_waitcnt lgkmcnt(10)
    v_mfma_f32_16x16x32_bf16 v[232:235], v[132:135], v[32:35], v[232:235]
    v_mfma_f32_16x16x32_bf16 v[236:239], v[132:135], v[36:39], v[236:239]
    ds_read_b128 v[168:171], v7 offset:24576
    s_waitcnt lgkmcnt(10)
    v_mfma_f32_16x16x32_bf16 v[240:243], v[136:139], v[32:35], v[240:243]
    v_mfma_f32_16x16x32_bf16 v[244:247], v[136:139], v[36:39], v[244:247]
    ds_read_b128 v[172:175], v7 offset:25600
    s_barrier
    s_waitcnt lgkmcnt(8)
    v_mfma_f32_16x16x32_bf16 v[176:179], v[140:143], v[40:43], v[176:179]
    ds_read_b128 v[32:35], v8 offset:0
    ds_read_b128 v[36:39], v8 offset:1024
    v_mfma_f32_16x16x32_bf16 v[180:183], v[140:143], v[44:47], v[180:183]
    ds_read_b128 v[104:107], v2 offset:0
    s_waitcnt lgkmcnt(10)
    v_mfma_f32_16x16x32_bf16 v[184:187], v[144:147], v[40:43], v[184:187]
    v_mfma_f32_16x16x32_bf16 v[188:191], v[144:147], v[44:47], v[188:191]
    ds_read_b128 v[108:111], v2 offset:1024
    s_waitcnt lgkmcnt(10)
    v_mfma_f32_16x16x32_bf16 v[192:195], v[148:151], v[40:43], v[192:195]
    v_mfma_f32_16x16x32_bf16 v[196:199], v[148:151], v[44:47], v[196:199]
    ds_read_b128 v[112:115], v2 offset:2048
    s_waitcnt lgkmcnt(10)
    v_mfma_f32_16x16x32_bf16 v[200:203], v[152:155], v[40:43], v[200:203]
    v_mfma_f32_16x16x32_bf16 v[204:207], v[152:155], v[44:47], v[204:207]
    ds_read_b128 v[116:119], v2 offset:3072
    s_waitcnt lgkmcnt(10)
    v_mfma_f32_16x16x32_bf16 v[208:211], v[156:159], v[40:43], v[208:211]
    v_mfma_f32_16x16x32_bf16 v[212:215], v[156:159], v[44:47], v[212:215]
    ds_read_b128 v[120:123], v2 offset:4096
    s_waitcnt lgkmcnt(10)
    v_mfma_f32_16x16x32_bf16 v[216:219], v[160:163], v[40:43], v[216:219]
    v_mfma_f32_16x16x32_bf16 v[220:223], v[160:163], v[44:47], v[220:223]
    ds_read_b128 v[124:127], v2 offset:5120
    s_waitcnt lgkmcnt(10)
    v_mfma_f32_16x16x32_bf16 v[224:227], v[164:167], v[40:43], v[224:227]
    v_mfma_f32_16x16x32_bf16 v[228:231], v[164:167], v[44:47], v[228:231]
    ds_read_b128 v[128:131], v2 offset:6144
    s_waitcnt lgkmcnt(10)
    v_mfma_f32_16x16x32_bf16 v[232:235], v[168:171], v[40:43], v[232:235]
    v_mfma_f32_16x16x32_bf16 v[236:239], v[168:171], v[44:47], v[236:239]
    ds_read_b128 v[132:135], v2 offset:7168
    s_waitcnt lgkmcnt(10)
    v_mfma_f32_16x16x32_bf16 v[240:243], v[172:175], v[40:43], v[240:243]
    v_mfma_f32_16x16x32_bf16 v[244:247], v[172:175], v[44:47], v[244:247]
    ds_read_b128 v[136:139], v2 offset:8192
    s_waitcnt lgkmcnt(8)
    v_mfma_f32_16x16x32_bf16 v[176:179], v[104:107], v[32:35], v[176:179]
    ds_read_b128 v[40:43], v8 offset:17408
    ds_read_b128 v[44:47], v8 offset:18432
    v_mfma_f32_16x16x32_bf16 v[180:183], v[104:107], v[36:39], v[180:183]
    ds_read_b128 v[140:143], v2 offset:17408
    s_waitcnt lgkmcnt(10)
    v_mfma_f32_16x16x32_bf16 v[184:187], v[108:111], v[32:35], v[184:187]
    v_mfma_f32_16x16x32_bf16 v[188:191], v[108:111], v[36:39], v[188:191]
    ds_read_b128 v[144:147], v2 offset:18432
    s_waitcnt lgkmcnt(10)
    v_mfma_f32_16x16x32_bf16 v[192:195], v[112:115], v[32:35], v[192:195]
    v_mfma_f32_16x16x32_bf16 v[196:199], v[112:115], v[36:39], v[196:199]
    ds_read_b128 v[148:151], v2 offset:19456
    s_waitcnt lgkmcnt(10)
    v_mfma_f32_16x16x32_bf16 v[200:203], v[116:119], v[32:35], v[200:203]
    v_mfma_f32_16x16x32_bf16 v[204:207], v[116:119], v[36:39], v[204:207]
    ds_read_b128 v[152:155], v2 offset:20480
    s_waitcnt lgkmcnt(10)
    v_mfma_f32_16x16x32_bf16 v[208:211], v[120:123], v[32:35], v[208:211]
    v_mfma_f32_16x16x32_bf16 v[212:215], v[120:123], v[36:39], v[212:215]
    ds_read_b128 v[156:159], v2 offset:21504
    s_waitcnt lgkmcnt(10)
    v_mfma_f32_16x16x32_bf16 v[216:219], v[124:127], v[32:35], v[216:219]
    v_mfma_f32_16x16x32_bf16 v[220:223], v[124:127], v[36:39], v[220:223]
    ds_read_b128 v[160:163], v2 offset:22528
    s_waitcnt lgkmcnt(10)
    v_mfma_f32_16x16x32_bf16 v[224:227], v[128:131], v[32:35], v[224:227]
    v_mfma_f32_16x16x32_bf16 v[228:231], v[128:131], v[36:39], v[228:231]
    ds_read_b128 v[164:167], v2 offset:23552
    s_waitcnt lgkmcnt(10)
    v_mfma_f32_16x16x32_bf16 v[232:235], v[132:135], v[32:35], v[232:235]
    v_mfma_f32_16x16x32_bf16 v[236:239], v[132:135], v[36:39], v[236:239]
    ds_read_b128 v[168:171], v2 offset:24576
    s_waitcnt lgkmcnt(10)
    v_mfma_f32_16x16x32_bf16 v[240:243], v[136:139], v[32:35], v[240:243]
    v_mfma_f32_16x16x32_bf16 v[244:247], v[136:139], v[36:39], v[244:247]
    ds_read_b128 v[172:175], v2 offset:25600
    s_barrier
    s_waitcnt lgkmcnt(8)
    v_mfma_f32_16x16x32_bf16 v[176:179], v[140:143], v[40:43], v[176:179]
    ds_read_b128 v[32:35], v9 offset:0
    ds_read_b128 v[36:39], v9 offset:1024
    v_mfma_f32_16x16x32_bf16 v[180:183], v[140:143], v[44:47], v[180:183]
    ds_read_b128 v[104:107], v6 offset:0
    s_waitcnt lgkmcnt(10)
    v_mfma_f32_16x16x32_bf16 v[184:187], v[144:147], v[40:43], v[184:187]
    v_mfma_f32_16x16x32_bf16 v[188:191], v[144:147], v[44:47], v[188:191]
    ds_read_b128 v[108:111], v6 offset:1024
    s_waitcnt lgkmcnt(10)
    v_mfma_f32_16x16x32_bf16 v[192:195], v[148:151], v[40:43], v[192:195]
    v_mfma_f32_16x16x32_bf16 v[196:199], v[148:151], v[44:47], v[196:199]
    ds_read_b128 v[112:115], v6 offset:2048
    s_waitcnt lgkmcnt(10)
    v_mfma_f32_16x16x32_bf16 v[200:203], v[152:155], v[40:43], v[200:203]
    v_mfma_f32_16x16x32_bf16 v[204:207], v[152:155], v[44:47], v[204:207]
    ds_read_b128 v[116:119], v6 offset:3072
    s_waitcnt lgkmcnt(10)
    v_mfma_f32_16x16x32_bf16 v[208:211], v[156:159], v[40:43], v[208:211]
    v_mfma_f32_16x16x32_bf16 v[212:215], v[156:159], v[44:47], v[212:215]
    ds_read_b128 v[120:123], v6 offset:4096
    s_waitcnt lgkmcnt(10)
    v_mfma_f32_16x16x32_bf16 v[216:219], v[160:163], v[40:43], v[216:219]
    v_mfma_f32_16x16x32_bf16 v[220:223], v[160:163], v[44:47], v[220:223]
    ds_read_b128 v[124:127], v6 offset:5120
    s_waitcnt lgkmcnt(10)
    v_mfma_f32_16x16x32_bf16 v[224:227], v[164:167], v[40:43], v[224:227]
    v_mfma_f32_16x16x32_bf16 v[228:231], v[164:167], v[44:47], v[228:231]
    ds_read_b128 v[128:131], v6 offset:6144
    s_waitcnt lgkmcnt(10)
    v_mfma_f32_16x16x32_bf16 v[232:235], v[168:171], v[40:43], v[232:235]
    v_mfma_f32_16x16x32_bf16 v[236:239], v[168:171], v[44:47], v[236:239]
    ds_read_b128 v[132:135], v6 offset:7168
    s_waitcnt lgkmcnt(10)
    v_mfma_f32_16x16x32_bf16 v[240:243], v[172:175], v[40:43], v[240:243]
    v_mfma_f32_16x16x32_bf16 v[244:247], v[172:175], v[44:47], v[244:247]
    ds_read_b128 v[136:139], v6 offset:8192
    s_waitcnt lgkmcnt(8)
    v_mfma_f32_16x16x32_bf16 v[176:179], v[104:107], v[32:35], v[176:179]
    ds_read_b128 v[40:43], v9 offset:17408
    ds_read_b128 v[44:47], v9 offset:18432
    v_mfma_f32_16x16x32_bf16 v[180:183], v[104:107], v[36:39], v[180:183]
    ds_read_b128 v[140:143], v6 offset:17408
    s_waitcnt lgkmcnt(10)
    v_mfma_f32_16x16x32_bf16 v[184:187], v[108:111], v[32:35], v[184:187]
    v_mfma_f32_16x16x32_bf16 v[188:191], v[108:111], v[36:39], v[188:191]
    ds_read_b128 v[144:147], v6 offset:18432
    s_waitcnt lgkmcnt(10)
    v_mfma_f32_16x16x32_bf16 v[192:195], v[112:115], v[32:35], v[192:195]
    v_mfma_f32_16x16x32_bf16 v[196:199], v[112:115], v[36:39], v[196:199]
    ds_read_b128 v[148:151], v6 offset:19456
    s_waitcnt lgkmcnt(10)
    v_mfma_f32_16x16x32_bf16 v[200:203], v[116:119], v[32:35], v[200:203]
    v_mfma_f32_16x16x32_bf16 v[204:207], v[116:119], v[36:39], v[204:207]
    ds_read_b128 v[152:155], v6 offset:20480
    s_waitcnt lgkmcnt(10)
    v_mfma_f32_16x16x32_bf16 v[208:211], v[120:123], v[32:35], v[208:211]
    v_mfma_f32_16x16x32_bf16 v[212:215], v[120:123], v[36:39], v[212:215]
    ds_read_b128 v[156:159], v6 offset:21504
    s_waitcnt lgkmcnt(10)
    v_mfma_f32_16x16x32_bf16 v[216:219], v[124:127], v[32:35], v[216:219]
    v_mfma_f32_16x16x32_bf16 v[220:223], v[124:127], v[36:39], v[220:223]
    ds_read_b128 v[160:163], v6 offset:22528
    s_waitcnt lgkmcnt(10)
    v_mfma_f32_16x16x32_bf16 v[224:227], v[128:131], v[32:35], v[224:227]
    v_mfma_f32_16x16x32_bf16 v[228:231], v[128:131], v[36:39], v[228:231]
    ds_read_b128 v[164:167], v6 offset:23552
    s_waitcnt lgkmcnt(10)
    v_mfma_f32_16x16x32_bf16 v[232:235], v[132:135], v[32:35], v[232:235]
    v_mfma_f32_16x16x32_bf16 v[236:239], v[132:135], v[36:39], v[236:239]
    ds_read_b128 v[168:171], v6 offset:24576
    s_waitcnt lgkmcnt(10)
    v_mfma_f32_16x16x32_bf16 v[240:243], v[136:139], v[32:35], v[240:243]
    v_mfma_f32_16x16x32_bf16 v[244:247], v[136:139], v[36:39], v[244:247]
    ds_read_b128 v[172:175], v6 offset:25600
    s_barrier
    s_waitcnt lgkmcnt(8)
    v_mfma_f32_16x16x32_bf16 v[176:179], v[140:143], v[40:43], v[176:179]
    ds_read_b128 v[32:35], v10 offset:0
    ds_read_b128 v[36:39], v10 offset:1024
    v_mfma_f32_16x16x32_bf16 v[180:183], v[140:143], v[44:47], v[180:183]
    ds_read_b128 v[104:107], v3 offset:0
    s_waitcnt lgkmcnt(10)
    v_mfma_f32_16x16x32_bf16 v[184:187], v[144:147], v[40:43], v[184:187]
    v_mfma_f32_16x16x32_bf16 v[188:191], v[144:147], v[44:47], v[188:191]
    ds_read_b128 v[108:111], v3 offset:1024
    s_waitcnt lgkmcnt(10)
    v_mfma_f32_16x16x32_bf16 v[192:195], v[148:151], v[40:43], v[192:195]
    v_mfma_f32_16x16x32_bf16 v[196:199], v[148:151], v[44:47], v[196:199]
    ds_read_b128 v[112:115], v3 offset:2048
    s_waitcnt lgkmcnt(10)
    v_mfma_f32_16x16x32_bf16 v[200:203], v[152:155], v[40:43], v[200:203]
    v_mfma_f32_16x16x32_bf16 v[204:207], v[152:155], v[44:47], v[204:207]
    ds_read_b128 v[116:119], v3 offset:3072
    s_waitcnt lgkmcnt(10)
    v_mfma_f32_16x16x32_bf16 v[208:211], v[156:159], v[40:43], v[208:211]
    v_mfma_f32_16x16x32_bf16 v[212:215], v[156:159], v[44:47], v[212:215]
    ds_read_b128 v[120:123], v3 offset:4096
    s_waitcnt lgkmcnt(10)
    v_mfma_f32_16x16x32_bf16 v[216:219], v[160:163], v[40:43], v[216:219]
    v_mfma_f32_16x16x32_bf16 v[220:223], v[160:163], v[44:47], v[220:223]
    ds_read_b128 v[124:127], v3 offset:5120
    s_waitcnt lgkmcnt(10)
    v_mfma_f32_16x16x32_bf16 v[224:227], v[164:167], v[40:43], v[224:227]
    v_mfma_f32_16x16x32_bf16 v[228:231], v[164:167], v[44:47], v[228:231]
    ds_read_b128 v[128:131], v3 offset:6144
    s_waitcnt lgkmcnt(10)
    v_mfma_f32_16x16x32_bf16 v[232:235], v[168:171], v[40:43], v[232:235]
    v_mfma_f32_16x16x32_bf16 v[236:239], v[168:171], v[44:47], v[236:239]
    ds_read_b128 v[132:135], v3 offset:7168
    s_waitcnt lgkmcnt(10)
    v_mfma_f32_16x16x32_bf16 v[240:243], v[172:175], v[40:43], v[240:243]
    v_mfma_f32_16x16x32_bf16 v[244:247], v[172:175], v[44:47], v[244:247]
    ds_read_b128 v[136:139], v3 offset:8192
    s_waitcnt lgkmcnt(8)
    v_mfma_f32_16x16x32_bf16 v[176:179], v[104:107], v[32:35], v[176:179]
    ds_read_b128 v[40:43], v10 offset:17408
    ds_read_b128 v[44:47], v10 offset:18432
    v_mfma_f32_16x16x32_bf16 v[180:183], v[104:107], v[36:39], v[180:183]
    ds_read_b128 v[140:143], v3 offset:17408
    s_waitcnt lgkmcnt(10)
    v_mfma_f32_16x16x32_bf16 v[184:187], v[108:111], v[32:35], v[184:187]
    v_mfma_f32_16x16x32_bf16 v[188:191], v[108:111], v[36:39], v[188:191]
    ds_read_b128 v[144:147], v3 offset:18432
    s_waitcnt lgkmcnt(10)
    v_mfma_f32_16x16x32_bf16 v[192:195], v[112:115], v[32:35], v[192:195]
    v_mfma_f32_16x16x32_bf16 v[196:199], v[112:115], v[36:39], v[196:199]
    ds_read_b128 v[148:151], v3 offset:19456
    s_waitcnt lgkmcnt(10)
    v_mfma_f32_16x16x32_bf16 v[200:203], v[116:119], v[32:35], v[200:203]
    v_mfma_f32_16x16x32_bf16 v[204:207], v[116:119], v[36:39], v[204:207]
    ds_read_b128 v[152:155], v3 offset:20480
    s_waitcnt lgkmcnt(10)
    v_mfma_f32_16x16x32_bf16 v[208:211], v[120:123], v[32:35], v[208:211]
    v_mfma_f32_16x16x32_bf16 v[212:215], v[120:123], v[36:39], v[212:215]
    ds_read_b128 v[156:159], v3 offset:21504
    s_waitcnt lgkmcnt(10)
    v_mfma_f32_16x16x32_bf16 v[216:219], v[124:127], v[32:35], v[216:219]
    v_mfma_f32_16x16x32_bf16 v[220:223], v[124:127], v[36:39], v[220:223]
    ds_read_b128 v[160:163], v3 offset:22528
    s_waitcnt lgkmcnt(10)
    v_mfma_f32_16x16x32_bf16 v[224:227], v[128:131], v[32:35], v[224:227]
    v_mfma_f32_16x16x32_bf16 v[228:231], v[128:131], v[36:39], v[228:231]
    ds_read_b128 v[164:167], v3 offset:23552
    s_waitcnt lgkmcnt(10)
    v_mfma_f32_16x16x32_bf16 v[232:235], v[132:135], v[32:35], v[232:235]
    v_mfma_f32_16x16x32_bf16 v[236:239], v[132:135], v[36:39], v[236:239]
    ds_read_b128 v[168:171], v3 offset:24576
    s_waitcnt lgkmcnt(10)
    v_mfma_f32_16x16x32_bf16 v[240:243], v[136:139], v[32:35], v[240:243]
    v_mfma_f32_16x16x32_bf16 v[244:247], v[136:139], v[36:39], v[244:247]
    ds_read_b128 v[172:175], v3 offset:25600
    s_barrier
    s_waitcnt lgkmcnt(8)
    v_mfma_f32_16x16x32_bf16 v[176:179], v[140:143], v[40:43], v[176:179]
    ds_read_b128 v[32:35], v11 offset:0
    ds_read_b128 v[36:39], v11 offset:1024
    v_mfma_f32_16x16x32_bf16 v[180:183], v[140:143], v[44:47], v[180:183]
    ds_read_b128 v[104:107], v7 offset:0
    s_waitcnt lgkmcnt(10)
    v_mfma_f32_16x16x32_bf16 v[184:187], v[144:147], v[40:43], v[184:187]
    v_mfma_f32_16x16x32_bf16 v[188:191], v[144:147], v[44:47], v[188:191]
    ds_read_b128 v[108:111], v7 offset:1024
    s_waitcnt lgkmcnt(10)
    v_mfma_f32_16x16x32_bf16 v[192:195], v[148:151], v[40:43], v[192:195]
    v_mfma_f32_16x16x32_bf16 v[196:199], v[148:151], v[44:47], v[196:199]
    ds_read_b128 v[112:115], v7 offset:2048
    s_waitcnt lgkmcnt(10)
    v_mfma_f32_16x16x32_bf16 v[200:203], v[152:155], v[40:43], v[200:203]
    v_mfma_f32_16x16x32_bf16 v[204:207], v[152:155], v[44:47], v[204:207]
    ds_read_b128 v[116:119], v7 offset:3072
    s_waitcnt lgkmcnt(10)
    v_mfma_f32_16x16x32_bf16 v[208:211], v[156:159], v[40:43], v[208:211]
    v_mfma_f32_16x16x32_bf16 v[212:215], v[156:159], v[44:47], v[212:215]
    ds_read_b128 v[120:123], v7 offset:4096
    s_waitcnt lgkmcnt(10)
    v_mfma_f32_16x16x32_bf16 v[216:219], v[160:163], v[40:43], v[216:219]
    v_mfma_f32_16x16x32_bf16 v[220:223], v[160:163], v[44:47], v[220:223]
    ds_read_b128 v[124:127], v7 offset:5120
    s_waitcnt lgkmcnt(10)
    v_mfma_f32_16x16x32_bf16 v[224:227], v[164:167], v[40:43], v[224:227]
    v_mfma_f32_16x16x32_bf16 v[228:231], v[164:167], v[44:47], v[228:231]
    ds_read_b128 v[128:131], v7 offset:6144
    s_waitcnt lgkmcnt(10)
    v_mfma_f32_16x16x32_bf16 v[232:235], v[168:171], v[40:43], v[232:235]
    v_mfma_f32_16x16x32_bf16 v[236:239], v[168:171], v[44:47], v[236:239]
    ds_read_b128 v[132:135], v7 offset:7168
    s_waitcnt lgkmcnt(10)
    v_mfma_f32_16x16x32_bf16 v[240:243], v[172:175], v[40:43], v[240:243]
    v_mfma_f32_16x16x32_bf16 v[244:247], v[172:175], v[44:47], v[244:247]
    ds_read_b128 v[136:139], v7 offset:8192
    s_add_u32 s29, s29, 1
    s_cmp_lt_u32 s29, 3
    s_cbranch_scc1 m_loop2
    s_waitcnt lgkmcnt(8)
    v_mfma_f32_16x16x32_bf16 v[176:179], v[104:107], v[32:35], v[176:179]
    ds_read_b128 v[40:43], v11 offset:17408
    ds_read_b128 v[44:47], v11 offset:18432
    v_mfma_f32_16x16x32_bf16 v[180:183], v[104:107], v[36:39], v[180:183]
    ds_read_b128 v[140:143], v7 offset:17408
    s_waitcnt lgkmcnt(10)
    v_mfma_f32_16x16x32_bf16 v[184:187], v[108:111], v[32:35], v[184:187]
    v_mfma_f32_16x16x32_bf16 v[188:191], v[108:111], v[36:39], v[188:191]
    ds_read_b128 v[144:147], v7 offset:18432
    s_waitcnt lgkmcnt(10)
    v_mfma_f32_16x16x32_bf16 v[192:195], v[112:115], v[32:35], v[192:195]
    v_mfma_f32_16x16x32_bf16 v[196:199], v[112:115], v[36:39], v[196:199]
    ds_read_b128 v[148:151], v7 offset:19456
    s_waitcnt lgkmcnt(10)
    v_mfma_f32_16x16x32_bf16 v[200:203], v[116:119], v[32:35], v[200:203]
    v_mfma_f32_16x16x32_bf16 v[204:207], v[116:119], v[36:39], v[204:207]
    ds_read_b128 v[152:155], v7 offset:20480
    s_waitcnt lgkmcnt(10)
    v_mfma_f32_16x16x32_bf16 v[208:211], v[120:123], v[32:35], v[208:211]
    v_mfma_f32_16x16x32_bf16 v[212:215], v[120:123], v[36:39], v[212:215]
    ds_read_b128 v[156:159], v7 offset:21504
    s_waitcnt lgkmcnt(10)
    v_mfma_f32_16x16x32_bf16 v[216:219], v[124:127], v[32:35], v[216:219]
    v_mfma_f32_16x16x32_bf16 v[220:223], v[124:127], v[36:39], v[220:223]
    ds_read_b128 v[160:163], v7 offset:22528
    s_waitcnt lgkmcnt(10)
    v_mfma_f32_16x16x32_bf16 v[224:227], v[128:131], v[32:35], v[224:227]
    v_mfma_f32_16x16x32_bf16 v[228:231], v[128:131], v[36:39], v[228:231]
    ds_read_b128 v[164:167], v7 offset:23552
    s_waitcnt lgkmcnt(10)
    v_mfma_f32_16x16x32_bf16 v[232:235], v[132:135], v[32:35], v[232:235]
    v_mfma_f32_16x16x32_bf16 v[236:239], v[132:135], v[36:39], v[236:239]
    ds_read_b128 v[168:171], v7 offset:24576
    s_waitcnt lgkmcnt(10)
    v_mfma_f32_16x16x32_bf16 v[240:243], v[136:139], v[32:35], v[240:243]
    v_mfma_f32_16x16x32_bf16 v[244:247], v[136:139], v[36:39], v[244:247]
    ds_read_b128 v[172:175], v7 offset:25600
    s_barrier
    s_waitcnt lgkmcnt(8)
    v_mfma_f32_16x16x32_bf16 v[176:179], v[140:143], v[40:43], v[176:179]
    ds_read_b128 v[32:35], v8 offset:0
    ds_read_b128 v[36:39], v8 offset:1024
    v_mfma_f32_16x16x32_bf16 v[180:183], v[140:143], v[44:47], v[180:183]
    ds_read_b128 v[104:107], v2 offset:0
    s_waitcnt lgkmcnt(10)
    v_mfma_f32_16x16x32_bf16 v[184:187], v[144:147], v[40:43], v[184:187]
    v_mfma_f32_16x16x32_bf16 v[188:191], v[144:147], v[44:47], v[188:191]
    ds_read_b128 v[108:111], v2 offset:1024
    s_waitcnt lgkmcnt(10)
    v_mfma_f32_16x16x32_bf16 v[192:195], v[148:151], v[40:43], v[192:195]
    v_mfma_f32_16x16x32_bf16 v[196:199], v[148:151], v[44:47], v[196:199]
    ds_read_b128 v[112:115], v2 offset:2048
    s_waitcnt lgkmcnt(10)
    v_mfma_f32_16x16x32_bf16 v[200:203], v[152:155], v[40:43], v[200:203]
    v_mfma_f32_16x16x32_bf16 v[204:207], v[152:155], v[44:47], v[204:207]
    ds_read_b128 v[116:119], v2 offset:3072
    s_waitcnt lgkmcnt(10)
    v_mfma_f32_16x16x32_bf16 v[208:211], v[156:159], v[40:43], v[208:211]
    v_mfma_f32_16x16x32_bf16 v[212:215], v[156:159], v[44:47], v[212:215]
    ds_read_b128 v[120:123], v2 offset:4096
    s_waitcnt lgkmcnt(10)
    v_mfma_f32_16x16x32_bf16 v[216:219], v[160:163], v[40:43], v[216:219]
    v_mfma_f32_16x16x32_bf16 v[220:223], v[160:163], v[44:47], v[220:223]
    ds_read_b128 v[124:127], v2 offset:5120
    s_waitcnt lgkmcnt(10)
    v_mfma_f32_16x16x32_bf16 v[224:227], v[164:167], v[40:43], v[224:227]
    v_mfma_f32_16x16x32_bf16 v[228:231], v[164:167], v[44:47], v[228:231]
    ds_read_b128 v[128:131], v2 offset:6144
    s_waitcnt lgkmcnt(10)
    v_mfma_f32_16x16x32_bf16 v[232:235], v[168:171], v[40:43], v[232:235]
    v_mfma_f32_16x16x32_bf16 v[236:239], v[168:171], v[44:47], v[236:239]
    ds_read_b128 v[132:135], v2 offset:7168
    s_waitcnt lgkmcnt(10)
    v_mfma_f32_16x16x32_bf16 v[240:243], v[172:175], v[40:43], v[240:243]
    v_mfma_f32_16x16x32_bf16 v[244:247], v[172:175], v[44:47], v[244:247]
    ds_read_b128 v[136:139], v2 offset:8192
    s_waitcnt lgkmcnt(8)
    v_mfma_f32_16x16x32_bf16 v[176:179], v[104:107], v[32:35], v[176:179]
    ds_read_b128 v[40:43], v8 offset:17408
    ds_read_b128 v[44:47], v8 offset:18432
    v_mfma_f32_16x16x32_bf16 v[180:183], v[104:107], v[36:39], v[180:183]
    ds_read_b128 v[140:143], v2 offset:17408
    s_waitcnt lgkmcnt(10)
    v_mfma_f32_16x16x32_bf16 v[184:187], v[108:111], v[32:35], v[184:187]
    v_mfma_f32_16x16x32_bf16 v[188:191], v[108:111], v[36:39], v[188:191]
    ds_read_b128 v[144:147], v2 offset:18432
    s_waitcnt lgkmcnt(10)
    v_mfma_f32_16x16x32_bf16 v[192:195], v[112:115], v[32:35], v[192:195]
    v_mfma_f32_16x16x32_bf16 v[196:199], v[112:115], v[36:39], v[196:199]
    ds_read_b128 v[148:151], v2 offset:19456
    s_waitcnt lgkmcnt(10)
    v_mfma_f32_16x16x32_bf16 v[200:203], v[116:119], v[32:35], v[200:203]
    v_mfma_f32_16x16x32_bf16 v[204:207], v[116:119], v[36:39], v[204:207]
    ds_read_b128 v[152:155], v2 offset:20480
    s_waitcnt lgkmcnt(10)
    v_mfma_f32_16x16x32_bf16 v[208:211], v[120:123], v[32:35], v[208:211]
    v_mfma_f32_16x16x32_bf16 v[212:215], v[120:123], v[36:39], v[212:215]
    ds_read_b128 v[156:159], v2 offset:21504
    s_waitcnt lgkmcnt(10)
    v_mfma_f32_16x16x32_bf16 v[216:219], v[124:127], v[32:35], v[216:219]
    v_mfma_f32_16x16x32_bf16 v[220:223], v[124:127], v[36:39], v[220:223]
    ds_read_b128 v[160:163], v2 offset:22528
    s_waitcnt lgkmcnt(10)
    v_mfma_f32_16x16x32_bf16 v[224:227], v[128:131], v[32:35], v[224:227]
    v_mfma_f32_16x16x32_bf16 v[228:231], v[128:131], v[36:39], v[228:231]
    ds_read_b128 v[164:167], v2 offset:23552
    s_waitcnt lgkmcnt(10)
    v_mfma_f32_16x16x32_bf16 v[232:235], v[132:135], v[32:35], v[232:235]
    v_mfma_f32_16x16x32_bf16 v[236:239], v[132:135], v[36:39], v[236:239]
    ds_read_b128 v[168:171], v2 offset:24576
    s_waitcnt lgkmcnt(10)
    v_mfma_f32_16x16x32_bf16 v[240:243], v[136:139], v[32:35], v[240:243]
    v_mfma_f32_16x16x32_bf16 v[244:247], v[136:139], v[36:39], v[244:247]
    ds_read_b128 v[172:175], v2 offset:25600
    s_barrier
    s_waitcnt lgkmcnt(8)
    v_mfma_f32_16x16x32_bf16 v[176:179], v[140:143], v[40:43], v[176:179]
    ds_read_b128 v[32:35], v9 offset:0
    ds_read_b128 v[36:39], v9 offset:1024
    v_mfma_f32_16x16x32_bf16 v[180:183], v[140:143], v[44:47], v[180:183]
    ds_read_b128 v[104:107], v6 offset:0
    s_waitcnt lgkmcnt(10)
    v_mfma_f32_16x16x32_bf16 v[184:187], v[144:147], v[40:43], v[184:187]
    v_mfma_f32_16x16x32_bf16 v[188:191], v[144:147], v[44:47], v[188:191]
    ds_read_b128 v[108:111], v6 offset:1024
    s_waitcnt lgkmcnt(10)
    v_mfma_f32_16x16x32_bf16 v[192:195], v[148:151], v[40:43], v[192:195]
    v_mfma_f32_16x16x32_bf16 v[196:199], v[148:151], v[44:47], v[196:199]
    ds_read_b128 v[112:115], v6 offset:2048
    s_waitcnt lgkmcnt(10)
    v_mfma_f32_16x16x32_bf16 v[200:203], v[152:155], v[40:43], v[200:203]
    v_mfma_f32_16x16x32_bf16 v[204:207], v[152:155], v[44:47], v[204:207]
    ds_read_b128 v[116:119], v6 offset:3072
    s_waitcnt lgkmcnt(10)
    v_mfma_f32_16x16x32_bf16 v[208:211], v[156:159], v[40:43], v[208:211]
    v_mfma_f32_16x16x32_bf16 v[212:215], v[156:159], v[44:47], v[212:215]
    ds_read_b128 v[120:123], v6 offset:4096
    s_waitcnt lgkmcnt(10)
    v_mfma_f32_16x16x32_bf16 v[216:219], v[160:163], v[40:43], v[216:219]
    v_mfma_f32_16x16x32_bf16 v[220:223], v[160:163], v[44:47], v[220:223]
    ds_read_b128 v[124:127], v6 offset:5120
    s_waitcnt lgkmcnt(10)
    v_mfma_f32_16x16x32_bf16 v[224:227], v[164:167], v[40:43], v[224:227]
    v_mfma_f32_16x16x32_bf16 v[228:231], v[164:167], v[44:47], v[228:231]
    ds_read_b128 v[128:131], v6 offset:6144
    s_waitcnt lgkmcnt(10)
    v_mfma_f32_16x16x32_bf16 v[232:235], v[168:171], v[40:43], v[232:235]
    v_mfma_f32_16x16x32_bf16 v[236:239], v[168:171], v[44:47], v[236:239]
    ds_read_b128 v[132:135], v6 offset:7168
    s_waitcnt lgkmcnt(10)
    v_mfma_f32_16x16x32_bf16 v[240:243], v[172:175], v[40:43], v[240:243]
    v_mfma_f32_16x16x32_bf16 v[244:247], v[172:175], v[44:47], v[244:247]
    ds_read_b128 v[136:139], v6 offset:8192
    s_waitcnt lgkmcnt(8)
    v_mfma_f32_16x16x32_bf16 v[176:179], v[104:107], v[32:35], v[176:179]
    ds_read_b128 v[40:43], v9 offset:17408
    ds_read_b128 v[44:47], v9 offset:18432
    v_mfma_f32_16x16x32_bf16 v[180:183], v[104:107], v[36:39], v[180:183]
    ds_read_b128 v[140:143], v6 offset:17408
    s_waitcnt lgkmcnt(10)
    v_mfma_f32_16x16x32_bf16 v[184:187], v[108:111], v[32:35], v[184:187]
    v_mfma_f32_16x16x32_bf16 v[188:191], v[108:111], v[36:39], v[188:191]
    ds_read_b128 v[144:147], v6 offset:18432
    s_waitcnt lgkmcnt(10)
    v_mfma_f32_16x16x32_bf16 v[192:195], v[112:115], v[32:35], v[192:195]
    v_mfma_f32_16x16x32_bf16 v[196:199], v[112:115], v[36:39], v[196:199]
    ds_read_b128 v[148:151], v6 offset:19456
    s_waitcnt lgkmcnt(10)
    v_mfma_f32_16x16x32_bf16 v[200:203], v[116:119], v[32:35], v[200:203]
    v_mfma_f32_16x16x32_bf16 v[204:207], v[116:119], v[36:39], v[204:207]
    ds_read_b128 v[152:155], v6 offset:20480
    s_waitcnt lgkmcnt(10)
    v_mfma_f32_16x16x32_bf16 v[208:211], v[120:123], v[32:35], v[208:211]
    v_mfma_f32_16x16x32_bf16 v[212:215], v[120:123], v[36:39], v[212:215]
    ds_read_b128 v[156:159], v6 offset:21504
    s_waitcnt lgkmcnt(10)
    v_mfma_f32_16x16x32_bf16 v[216:219], v[124:127], v[32:35], v[216:219]
    v_mfma_f32_16x16x32_bf16 v[220:223], v[124:127], v[36:39], v[220:223]
    ds_read_b128 v[160:163], v6 offset:22528
    s_waitcnt lgkmcnt(10)
    v_mfma_f32_16x16x32_bf16 v[224:227], v[128:131], v[32:35], v[224:227]
    v_mfma_f32_16x16x32_bf16 v[228:231], v[128:131], v[36:39], v[228:231]
    ds_read_b128 v[164:167], v6 offset:23552
    s_waitcnt lgkmcnt(10)
    v_mfma_f32_16x16x32_bf16 v[232:235], v[132:135], v[32:35], v[232:235]
    v_mfma_f32_16x16x32_bf16 v[236:239], v[132:135], v[36:39], v[236:239]
    ds_read_b128 v[168:171], v6 offset:24576
    s_waitcnt lgkmcnt(10)
    v_mfma_f32_16x16x32_bf16 v[240:243], v[136:139], v[32:35], v[240:243]
    v_mfma_f32_16x16x32_bf16 v[244:247], v[136:139], v[36:39], v[244:247]
    ds_read_b128 v[172:175], v6 offset:25600
    s_barrier
    s_waitcnt lgkmcnt(8)
    v_mfma_f32_16x16x32_bf16 v[176:179], v[140:143], v[40:43], v[176:179]
    ds_read_b128 v[32:35], v10 offset:0
    ds_read_b128 v[36:39], v10 offset:1024
    v_mfma_f32_16x16x32_bf16 v[180:183], v[140:143], v[44:47], v[180:183]
    ds_read_b128 v[104:107], v3 offset:0
    s_waitcnt lgkmcnt(10)
    v_mfma_f32_16x16x32_bf16 v[184:187], v[144:147], v[40:43], v[184:187]
    v_mfma_f32_16x16x32_bf16 v[188:191], v[144:147], v[44:47], v[188:191]
    ds_read_b128 v[108:111], v3 offset:1024
    s_waitcnt lgkmcnt(10)
    v_mfma_f32_16x16x32_bf16 v[192:195], v[148:151], v[40:43], v[192:195]
    v_mfma_f32_16x16x32_bf16 v[196:199], v[148:151], v[44:47], v[196:199]
    ds_read_b128 v[112:115], v3 offset:2048
    s_waitcnt lgkmcnt(10)
    v_mfma_f32_16x16x32_bf16 v[200:203], v[152:155], v[40:43], v[200:203]
    v_mfma_f32_16x16x32_bf16 v[204:207], v[152:155], v[44:47], v[204:207]
    ds_read_b128 v[116:119], v3 offset:3072
    s_waitcnt lgkmcnt(10)
    v_mfma_f32_16x16x32_bf16 v[208:211], v[156:159], v[40:43], v[208:211]
    v_mfma_f32_16x16x32_bf16 v[212:215], v[156:159], v[44:47], v[212:215]
    ds_read_b128 v[120:123], v3 offset:4096
    s_waitcnt lgkmcnt(10)
    v_mfma_f32_16x16x32_bf16 v[216:219], v[160:163], v[40:43], v[216:219]
    v_mfma_f32_16x16x32_bf16 v[220:223], v[160:163], v[44:47], v[220:223]
    ds_read_b128 v[124:127], v3 offset:5120
    s_waitcnt lgkmcnt(10)
    v_mfma_f32_16x16x32_bf16 v[224:227], v[164:167], v[40:43], v[224:227]
    v_mfma_f32_16x16x32_bf16 v[228:231], v[164:167], v[44:47], v[228:231]
    ds_read_b128 v[128:131], v3 offset:6144
    s_waitcnt lgkmcnt(10)
    v_mfma_f32_16x16x32_bf16 v[232:235], v[168:171], v[40:43], v[232:235]
    v_mfma_f32_16x16x32_bf16 v[236:239], v[168:171], v[44:47], v[236:239]
    ds_read_b128 v[132:135], v3 offset:7168
    s_waitcnt lgkmcnt(10)
    v_mfma_f32_16x16x32_bf16 v[240:243], v[172:175], v[40:43], v[240:243]
    v_mfma_f32_16x16x32_bf16 v[244:247], v[172:175], v[44:47], v[244:247]
    ds_read_b128 v[136:139], v3 offset:8192
    s_waitcnt lgkmcnt(8)
    v_mfma_f32_16x16x32_bf16 v[176:179], v[104:107], v[32:35], v[176:179]
    ds_read_b128 v[40:43], v10 offset:17408
    ds_read_b128 v[44:47], v10 offset:18432
    v_mfma_f32_16x16x32_bf16 v[180:183], v[104:107], v[36:39], v[180:183]
    ds_read_b128 v[140:143], v3 offset:17408
    s_waitcnt lgkmcnt(10)
    v_mfma_f32_16x16x32_bf16 v[184:187], v[108:111], v[32:35], v[184:187]
    v_mfma_f32_16x16x32_bf16 v[188:191], v[108:111], v[36:39], v[188:191]
    ds_read_b128 v[144:147], v3 offset:18432
    s_waitcnt lgkmcnt(10)
    v_mfma_f32_16x16x32_bf16 v[192:195], v[112:115], v[32:35], v[192:195]
    v_mfma_f32_16x16x32_bf16 v[196:199], v[112:115], v[36:39], v[196:199]
    ds_read_b128 v[148:151], v3 offset:19456
    s_waitcnt lgkmcnt(10)
    v_mfma_f32_16x16x32_bf16 v[200:203], v[116:119], v[32:35], v[200:203]
    v_mfma_f32_16x16x32_bf16 v[204:207], v[116:119], v[36:39], v[204:207]
    ds_read_b128 v[152:155], v3 offset:20480
    s_waitcnt lgkmcnt(10)
    v_mfma_f32_16x16x32_bf16 v[208:211], v[120:123], v[32:35], v[208:211]
    v_mfma_f32_16x16x32_bf16 v[212:215], v[120:123], v[36:39], v[212:215]
    ds_read_b128 v[156:159], v3 offset:21504
    s_waitcnt lgkmcnt(10)
    v_mfma_f32_16x16x32_bf16 v[216:219], v[124:127], v[32:35], v[216:219]
    v_mfma_f32_16x16x32_bf16 v[220:223], v[124:127], v[36:39], v[220:223]
    ds_read_b128 v[160:163], v3 offset:22528
    s_waitcnt lgkmcnt(10)
    v_mfma_f32_16x16x32_bf16 v[224:227], v[128:131], v[32:35], v[224:227]
    v_mfma_f32_16x16x32_bf16 v[228:231], v[128:131], v[36:39], v[228:231]
    ds_read_b128 v[164:167], v3 offset:23552
    s_waitcnt lgkmcnt(10)
    v_mfma_f32_16x16x32_bf16 v[232:235], v[132:135], v[32:35], v[232:235]
    v_mfma_f32_16x16x32_bf16 v[236:239], v[132:135], v[36:39], v[236:239]
    ds_read_b128 v[168:171], v3 offset:24576
    s_waitcnt lgkmcnt(10)
    v_mfma_f32_16x16x32_bf16 v[240:243], v[136:139], v[32:35], v[240:243]
    v_mfma_f32_16x16x32_bf16 v[244:247], v[136:139], v[36:39], v[244:247]
    ds_read_b128 v[172:175], v3 offset:25600
    s_waitcnt lgkmcnt(8)
    v_mfma_f32_16x16x32_bf16 v[176:179], v[140:143], v[40:43], v[176:179]
    v_mfma_f32_16x16x32_bf16 v[180:183], v[140:143], v[44:47], v[180:183]
    s_waitcnt lgkmcnt(7)
    v_mfma_f32_16x16x32_bf16 v[184:187], v[144:147], v[40:43], v[184:187]
    v_mfma_f32_16x16x32_bf16 v[188:191], v[144:147], v[44:47], v[188:191]
    s_waitcnt lgkmcnt(6)
    v_mfma_f32_16x16x32_bf16 v[192:195], v[148:151], v[40:43], v[192:195]
    v_mfma_f32_16x16x32_bf16 v[196:199], v[148:151], v[44:47], v[196:199]
    s_waitcnt lgkmcnt(5)
    v_mfma_f32_16x16x32_bf16 v[200:203], v[152:155], v[40:43], v[200:203]
    v_mfma_f32_16x16x32_bf16 v[204:207], v[152:155], v[44:47], v[204:207]
    s_waitcnt lgkmcnt(4)
    v_mfma_f32_16x16x32_bf16 v[208:211], v[156:159], v[40:43], v[208:211]
    v_mfma_f32_16x16x32_bf16 v[212:215], v[156:159], v[44:47], v[212:215]
    s_waitcnt lgkmcnt(3)
    v_mfma_f32_16x16x32_bf16 v[216:219], v[160:163], v[40:43], v[216:219]
    v_mfma_f32_16x16x32_bf16 v[220:223], v[160:163], v[44:47], v[220:223]
    s_waitcnt lgkmcnt(2)
    v_mfma_f32_16x16x32_bf16 v[224:227], v[164:167], v[40:43], v[224:227]
    v_mfma_f32_16x16x32_bf16 v[228:231], v[164:167], v[44:47], v[228:231]
    s_waitcnt lgkmcnt(1)
    v_mfma_f32_16x16x32_bf16 v[232:235], v[168:171], v[40:43], v[232:235]
    v_mfma_f32_16x16x32_bf16 v[236:239], v[168:171], v[44:47], v[236:239]
    s_waitcnt lgkmcnt(0)
    v_mfma_f32_16x16x32_bf16 v[240:243], v[172:175], v[40:43], v[240:243]
    v_mfma_f32_16x16x32_bf16 v[244:247], v[172:175], v[44:47], v[244:247]
    s_mov_b32 s13, s40
    s_mov_b32 s23, s41
    s_lshl_b32 s24, s23, 2
    s_add_u32 s24, s24, s14
    s_lshl_b32 s25, s24, 2
    s_add_u32 s25, s25, s13
    s_mul_i32 s26, s25, 9216
    s_add_u32 s26, s26, 34439168
    s_lshl_b32 s27, s24, 7
    s_lshl_b32 s28, s13, 2
    s_add_u32 s27, s27, s28
    s_add_u32 s27, s27, 53313536
    s_cmp_eq_u32 s14, s13
    s_cbranch_scc1 g2_own
    v_cvt_pk_bf16_f32 v12, v176, v177
    v_cvt_pk_bf16_f32 v13, v178, v179
    v_cvt_pk_bf16_f32 v14, v180, v181
    v_cvt_pk_bf16_f32 v15, v182, v183
    buffer_store_dwordx4 v[12:15], v1, s[8:11], s26 offen offset:0 sc1
    v_cvt_pk_bf16_f32 v16, v184, v185
    v_cvt_pk_bf16_f32 v17, v186, v187
    v_cvt_pk_bf16_f32 v18, v188, v189
    v_cvt_pk_bf16_f32 v19, v190, v191
    buffer_store_dwordx4 v[16:19], v1, s[8:11], s26 offen offset:1024 sc1
    v_cvt_pk_bf16_f32 v20, v192, v193
    v_cvt_pk_bf16_f32 v21, v194, v195
    v_cvt_pk_bf16_f32 v22, v196, v197
    v_cvt_pk_bf16_f32 v23, v198, v199
    buffer_store_dwordx4 v[20:23], v1, s[8:11], s26 offen offset:2048 sc1
    v_cvt_pk_bf16_f32 v24, v200, v201
    v_cvt_pk_bf16_f32 v25, v202, v203
    v_cvt_pk_bf16_f32 v26, v204, v205
    v_cvt_pk_bf16_f32 v27, v206, v207
    buffer_store_dwordx4 v[24:27], v1, s[8:11], s26 offen offset:3072 sc1
    v_cvt_pk_bf16_f32 v28, v208, v209
    v_cvt_pk_bf16_f32 v29, v210, v211
    v_cvt_pk_bf16_f32 v30, v212, v213
    v_cvt_pk_bf16_f32 v31, v214, v215
    s_add_u32 s26, s26, 4096
    buffer_store_dwordx4 v[28:31], v1, s[8:11], s26 offen offset:0 sc1
    v_cvt_pk_bf16_f32 v32, v216, v217
    v_cvt_pk_bf16_f32 v33, v218, v219
    v_cvt_pk_bf16_f32 v34, v220, v221
    v_cvt_pk_bf16_f32 v35, v222, v223
    buffer_store_dwordx4 v[32:35], v1, s[8:11], s26 offen offset:1024 sc1
    v_cvt_pk_bf16_f32 v36, v224, v225
    v_cvt_pk_bf16_f32 v37, v226, v227
    v_cvt_pk_bf16_f32 v38, v228, v229
    v_cvt_pk_bf16_f32 v39, v230, v231
    buffer_store_dwordx4 v[36:39], v1, s[8:11], s26 offen offset:2048 sc1
    v_cvt_pk_bf16_f32 v40, v232, v233
    v_cvt_pk_bf16_f32 v41, v234, v235
    v_cvt_pk_bf16_f32 v42, v236, v237
    v_cvt_pk_bf16_f32 v43, v238, v239
    buffer_store_dwordx4 v[40:43], v1, s[8:11], s26 offen offset:3072 sc1
    v_cvt_pk_bf16_f32 v44, v240, v241
    v_cvt_pk_bf16_f32 v45, v242, v243
    v_cvt_pk_bf16_f32 v46, v244, v245
    v_cvt_pk_bf16_f32 v47, v246, v247
    s_add_u32 s26, s26, 4096
    buffer_store_dwordx4 v[44:47], v1, s[8:11], s26 offen offset:0 sc1
    s_barrier
    v_mov_b32 v5, 1
    v_mov_b32 v6, 0
    s_waitcnt vmcnt(0)
    s_mov_b64 exec, 1
    buffer_store_dword v5, v6, s[8:11], s27 offen sc1
    s_mov_b64 exec, -1
    s_branch g2_phc
g2_own:
    s_barrier
    ds_write_b128 v1, v[176:179] offset:0
    ds_write_b128 v1, v[180:183] offset:1024
    ds_write_b128 v1, v[184:187] offset:2048
    ds_write_b128 v1, v[188:191] offset:3072
    ds_write_b128 v1, v[192:195] offset:4096
    ds_write_b128 v1, v[196:199] offset:5120
    ds_write_b128 v1, v[200:203] offset:6144
    ds_write_b128 v1, v[204:207] offset:7168
    ds_write_b128 v1, v[208:211] offset:8192
    ds_write_b128 v1, v[212:215] offset:9216
    ds_write_b128 v1, v[216:219] offset:10240
    ds_write_b128 v1, v[220:223] offset:11264
    ds_write_b128 v1, v[224:227] offset:12288
    ds_write_b128 v1, v[228:231] offset:13312
    ds_write_b128 v1, v[232:235] offset:14336
    ds_write_b128 v1, v[236:239] offset:15360
    ds_write_b128 v1, v[240:243] offset:16384
    ds_write_b128 v1, v[244:247] offset:17408
    s_branch g2_phc
g1_prod:
    s_sub_u32 s18, s14, 4
    s_mul_i32 s30, s13, 331776
    s_add_u32 s30, s30, 4800512
    s_lshl_b32 s31, s18, 10
    s_add_u32 s30, s30, s31
    v_lshlrev_b32 v1, 4, v0
    s_mul_i32 s22, s13, 4608
    s_add_u32 s22, s22, 10108928
    s_add_u32 s33, s22, 4096
    s_add_u32 s22, s22, s31
    s_add_u32 m0, s31, 0
    s_add_u32 s32, s30, 0
    buffer_load_dwordx4 v1, s[8:11], s32 offen lds
    s_add_u32 m0, s31, 4096
    s_add_u32 s32, s30, 4096
    buffer_load_dwordx4 v1, s[8:11], s32 offen lds
    s_add_u32 m0, s31, 8192
    s_add_u32 s32, s30, 8192
    buffer_load_dwordx4 v1, s[8:11], s32 offen lds
    s_add_u32 m0, s31, 147456
    s_nop 0
    buffer_load_dwordx4 v1, s[8:11], s22 offen lds
    s_mov_b32 m0, 151552
    s_nop 0
    buffer_load_dwordx4 v1, s[8:11], s33 offen lds
    s_add_u32 m0, s31, 12288
    s_add_u32 s32, s30, 12288
    buffer_load_dwordx4 v1, s[8:11], s32 offen lds
    s_add_u32 m0, s31, 16384
    s_add_u32 s32, s30, 16384
    buffer_load_dwordx4 v1, s[8:11], s32 offen lds
    s_add_u32 m0, s31, 20480
    s_add_u32 s32, s30, 20480
    buffer_load_dwordx4 v1, s[8:11], s32 offen lds
    s_waitcnt vmcnt(5)
    s_barrier
    s_add_u32 m0, s31, 24576
    s_add_u32 s32, s30, 24576
    buffer_load_dwordx4 v1, s[8:11], s32 offen lds
    s_add_u32 m0, s31, 28672
    s_add_u32 s32, s30, 28672
    buffer_load_dwordx4 v1, s[8:11], s32 offen lds
    s_add_u32 m0, s31, 32768
    s_add_u32 s32, s30, 32768
    buffer_load_dwordx4 v1, s[8:11], s32 offen lds
    s_add_u32 s30, s30, 36864
    s_waitcnt vmcnt(3)
    s_barrier
    s_add_u32 m0, s31, 36864
    s_add_u32 s32, s30, 0
    buffer_load_dwordx4 v1, s[8:11], s32 offen lds
    s_add_u32 m0, s31, 40960
    s_add_u32 s32, s30, 4096
    buffer_load_dwordx4 v1, s[8:11], s32 offen lds
    s_add_u32 m0, s31, 45056
    s_add_u32 s32, s30, 8192
    buffer_load_dwordx4 v1, s[8:11], s32 offen lds
    s_add_u32 m0, s31, 49152
    s_add_u32 s32, s30, 12288
    buffer_load_dwordx4 v1, s[8:11], s32 offen lds
    s_add_u32 m0, s31, 53248
    s_add_u32 s32, s30, 16384
    buffer_load_dwordx4 v1, s[8:11], s32 offen lds
    s_add_u32 m0, s31, 57344
    s_add_u32 s32, s30, 20480
    buffer_load_dwordx4 v1, s[8:11], s32 offen lds
    s_add_u32 m0, s31, 61440
    s_add_u32 s32, s30, 24576
    buffer_load_dwordx4 v1, s[8:11], s32 offen lds
    s_add_u32 m0, s31, 65536
    s_add_u32 s32, s30, 28672
    buffer_load_dwordx4 v1, s[8:11], s32 offen lds
    s_add_u32 m0, s31, 69632
    s_add_u32 s32, s30, 32768
    buffer_load_dwordx4 v1, s[8:11], s32 offen lds
    s_add_u32 s30, s30, 36864
    s_waitcnt vmcnt(9)
    s_barrier
    s_add_u32 m0, s31, 73728
    s_add_u32 s32, s30, 0
    buffer_load_dwordx4 v1, s[8:11], s32 offen lds
    s_add_u32 m0, s31, 77824
    s_add_u32 s32, s30, 4096
    buffer_load_dwordx4 v1, s[8:11], s32 offen lds
    s_add_u32 m0, s31, 81920
    s_add_u32 s32, s30, 8192
    buffer_load_dwordx4 v1, s[8:11], s32 offen lds
    s_add_u32 m0, s31, 86016
    s_add_u32 s32, s30, 12288
    buffer_load_dwordx4 v1, s[8:11], s32 offen lds
    s_add_u32 m0, s31, 90112
    s_add_u32 s32, s30, 16384
    buffer_load_dwordx4 v1, s[8:11], s32 offen lds
    s_add_u32 m0, s31, 94208
    s_add_u32 s32, s30, 20480
    buffer_load_dwordx4 v1, s[8:11], s32 offen lds
    s_add_u32 m0, s31, 98304
    s_add_u32 s32, s30, 24576
    buffer_load_dwordx4 v1, s[8:11], s32 offen lds
    s_add_u32 m0, s31, 102400
    s_add_u32 s32, s30, 28672
    buffer_load_dwordx4 v1, s[8:11], s32 offen lds
    s_add_u32 m0, s31, 106496
    s_add_u32 s32, s30, 32768
    buffer_load_dwordx4 v1, s[8:11], s32 offen lds
    s_add_u32 s30, s30, 36864
    s_lshr_b32 s42, s18, 1
    s_mul_i32 s38, s42, 17408
    s_mul_i32 s36, s17, 144
    s_mul_i32 s37, s40, 36
    s_add_u32 s36, s36, s37
    s_mul_i32 s36, s36, 9216
    s_add_u32 s36, s36, 29130752
    s_mul_i32 s43, s12, 1152
    s_add_u32 s43, s43, s37
    s_lshl_b32 s43, s43, 10
    s_add_u32 s43, s43, 10256384
    s_lshl_b32 s33, s12, 2
    s_add_u32 s33, s33, s40
    s_lshl_b32 s33, s33, 7
    s_add_u32 s33, s33, 53379072
    s_lshl_b32 s34, s17, 2
    s_add_u32 s34, s34, s33
    v_mov_b32 v8, 0
    v_mov_b32 v9, 1
    s_and_b32 s44, s16, 7
    s_mul_i32 s44, s44, 41472
    s_mul_i32 s45, s18, 10368
    s_add_u32 s44, s44, s45
    s_add_u32 s44, s44, s36
    s_waitcnt vmcnt(9)
    s_barrier
    s_add_u32 m0, s31, 110592
    s_add_u32 s32, s30, 0
    buffer_load_dwordx4 v1, s[8:11], s32 offen lds
    s_add_u32 m0, s31, 114688
    s_add_u32 s32, s30, 4096
    buffer_load_dwordx4 v1, s[8:11], s32 offen lds
    s_add_u32 m0, s31, 118784
    s_add_u32 s32, s30, 8192
    buffer_load_dwordx4 v1, s[8:11], s32 offen lds
    s_add_u32 m0, s31, 122880
    s_add_u32 s32, s30, 12288
    buffer_load_dwordx4 v1, s[8:11], s32 offen lds
    s_add_u32 m0, s31, 126976
    s_add_u32 s32, s30, 16384
    buffer_load_dwordx4 v1, s[8:11], s32 offen lds
    s_add_u32 m0, s31, 131072
    s_add_u32 s32, s30, 20480
    buffer_load_dwordx4 v1, s[8:11], s32 offen lds
    s_add_u32 m0, s31, 135168
    s_add_u32 s32, s30, 24576
    buffer_load_dwordx4 v1, s[8:11], s32 offen lds
    s_add_u32 m0, s31, 139264
    s_add_u32 s32, s30, 28672
    buffer_load_dwordx4 v1, s[8:11], s32 offen lds
    s_add_u32 m0, s31, 143360
    s_add_u32 s32, s30, 32768
    buffer_load_dwordx4 v1, s[8:11], s32 offen lds
    s_add_u32 s30, s30, 36864
    s_waitcnt vmcnt(9)
    s_barrier
    s_add_u32 m0, s31, 0
    s_add_u32 s32, s30, 0
    buffer_load_dwordx4 v1, s[8:11], s32 offen lds
    s_add_u32 m0, s31, 4096
    s_add_u32 s32, s30, 4096
    buffer_load_dwordx4 v1, s[8:11], s32 offen lds
    s_add_u32 m0, s31, 8192
    s_add_u32 s32, s30, 8192
    buffer_load_dwordx4 v1, s[8:11], s32 offen lds
    s_add_u32 m0, s31, 12288
    s_add_u32 s32, s30, 12288
    buffer_load_dwordx4 v1, s[8:11], s32 offen lds
    s_add_u32 m0, s31, 16384
    s_add_u32 s32, s30, 16384
    buffer_load_dwordx4 v1, s[8:11], s32 offen lds
    s_add_u32 m0, s31, 20480
    s_add_u32 s32, s30, 20480
    buffer_load_dwordx4 v1, s[8:11], s32 offen lds
    s_add_u32 m0, s31, 24576
    s_add_u32 s32, s30, 24576
    buffer_load_dwordx4 v1, s[8:11], s32 offen lds
    s_add_u32 m0, s31, 28672
    s_add_u32 s32, s30, 28672
    buffer_load_dwordx4 v1, s[8:11], s32 offen lds
    s_add_u32 m0, s31, 32768
    s_add_u32 s32, s30, 32768
    buffer_load_dwordx4 v1, s[8:11], s32 offen lds
    s_add_u32 s30, s30, 36864
    s_waitcnt vmcnt(9)
    s_barrier
    s_add_u32 m0, s31, 36864
    s_add_u32 s32, s30, 0
    buffer_load_dwordx4 v1, s[8:11], s32 offen lds
    s_add_u32 m0, s31, 40960
    s_add_u32 s32, s30, 4096
    buffer_load_dwordx4 v1, s[8:11], s32 offen lds
    s_add_u32 m0, s31, 45056
    s_add_u32 s32, s30, 8192
    buffer_load_dwordx4 v1, s[8:11], s32 offen lds
    s_add_u32 m0, s31, 49152
    s_add_u32 s32, s30, 12288
    buffer_load_dwordx4 v1, s[8:11], s32 offen lds
    s_add_u32 m0, s31, 53248
    s_add_u32 s32, s30, 16384
    buffer_load_dwordx4 v1, s[8:11], s32 offen lds
    s_add_u32 m0, s31, 57344
    s_add_u32 s32, s30, 20480
    buffer_load_dwordx4 v1, s[8:11], s32 offen lds
    s_add_u32 m0, s31, 61440
    s_add_u32 s32, s30, 24576
    buffer_load_dwordx4 v1, s[8:11], s32 offen lds
    s_add_u32 m0, s31, 65536
    s_add_u32 s32, s30, 28672
    buffer_load_dwordx4 v1, s[8:11], s32 offen lds
    s_add_u32 m0, s31, 69632
    s_add_u32 s32, s30, 32768
    buffer_load_dwordx4 v1, s[8:11], s32 offen lds
    s_add_u32 s30, s30, 36864
    s_waitcnt vmcnt(9)
    s_barrier
    s_add_u32 m0, s31, 73728
    s_add_u32 s32, s30, 0
    buffer_load_dwordx4 v1, s[8:11], s32 offen lds
    s_add_u32 m0, s31, 77824
    s_add_u32 s32, s30, 4096
    buffer_load_dwordx4 v1, s[8:11], s32 offen lds
    s_add_u32 m0, s31, 81920
    s_add_u32 s32, s30, 8192
    buffer_load_dwordx4 v1, s[8:11], s32 offen lds
    s_add_u32 m0, s31, 86016
    s_add_u32 s32, s30, 12288
    buffer_load_dwordx4 v1, s[8:11], s32 offen lds
    s_add_u32 m0, s31, 90112
    s_add_u32 s32, s30, 16384
    buffer_load_dwordx4 v1, s[8:11], s32 offen lds
    s_add_u32 m0, s31, 94208
    s_add_u32 s32, s30, 20480
    buffer_load_dwordx4 v1, s[8:11], s32 offen lds
    s_add_u32 m0, s31, 98304
    s_add_u32 s32, s30, 24576
    buffer_load_dwordx4 v1, s[8:11], s32 offen lds
    s_add_u32 m0, s31, 102400
    s_add_u32 s32, s30, 28672
    buffer_load_dwordx4 v1, s[8:11], s32 offen lds
    s_add_u32 m0, s31, 106496
    s_add_u32 s32, s30, 32768
    buffer_load_dwordx4 v1, s[8:11], s32 offen lds
    s_add_u32 s30, s30, 36864
    s_waitcnt vmcnt(9)
    s_barrier
    s_add_u32 m0, s31, 110592
    s_add_u32 s32, s30, 0
    buffer_load_dwordx4 v1, s[8:11], s32 offen lds
    s_add_u32 m0, s31, 114688
    s_add_u32 s32, s30, 4096
    buffer_load_dwordx4 v1, s[8:11], s32 offen lds
    s_add_u32 m0, s31, 118784
    s_add_u32 s32, s30, 8192
    buffer_load_dwordx4 v1, s[8:11], s32 offen lds
    s_add_u32 m0, s31, 122880
    s_add_u32 s32, s30, 12288
    buffer_load_dwordx4 v1, s[8:11], s32 offen lds
    s_add_u32 m0, s31, 126976
    s_add_u32 s32, s30, 16384
    buffer_load_dwordx4 v1, s[8:11], s32 offen lds
    s_add_u32 m0, s31, 131072
    s_add_u32 s32, s30, 20480
    buffer_load_dwordx4 v1, s[8:11], s32 offen lds
    s_add_u32 m0, s31, 135168
    s_add_u32 s32, s30, 24576
    buffer_load_dwordx4 v1, s[8:11], s32 offen lds
    s_add_u32 m0, s31, 139264
    s_add_u32 s32, s30, 28672
    buffer_load_dwordx4 v1, s[8:11], s32 offen lds
    s_add_u32 m0, s31, 143360
    s_add_u32 s32, s30, 32768
    buffer_load_dwordx4 v1, s[8:11], s32 offen lds
    s_add_u32 s30, s30, 36864
    s_waitcnt vmcnt(9)
    s_barrier
    s_add_u32 m0, s31, 0
    s_add_u32 s32, s30, 0
    buffer_load_dwordx4 v1, s[8:11], s32 offen lds
    s_add_u32 m0, s31, 4096
    s_add_u32 s32, s30, 4096
    buffer_load_dwordx4 v1, s[8:11], s32 offen lds
    s_add_u32 m0, s31, 8192
    s_add_u32 s32, s30, 8192
    buffer_load_dwordx4 v1, s[8:11], s32 offen lds
    s_add_u32 m0, s31, 12288
    s_add_u32 s32, s30, 12288
    buffer_load_dwordx4 v1, s[8:11], s32 offen lds
    s_add_u32 m0, s31, 16384
    s_add_u32 s32, s30, 16384
    buffer_load_dwordx4 v1, s[8:11], s32 offen lds
    s_add_u32 m0, s31, 20480
    s_add_u32 s32, s30, 20480
    buffer_load_dwordx4 v1, s[8:11], s32 offen lds
    s_add_u32 m0, s31, 24576
    s_add_u32 s32, s30, 24576
    buffer_load_dwordx4 v1, s[8:11], s32 offen lds
    s_add_u32 m0, s31, 28672
    s_add_u32 s32, s30, 28672
    buffer_load_dwordx4 v1, s[8:11], s32 offen lds
    s_add_u32 m0, s31, 32768
    s_add_u32 s32, s30, 32768
    buffer_load_dwordx4 v1, s[8:11], s32 offen lds
    s_add_u32 s30, s30, 36864
    s_and_b32 s39, s18, 1
    s_cmp_eq_u32 s39, 1
    s_cbranch_scc1 m_prodT
    s_waitcnt vmcnt(9)
    s_barrier
    s_add_u32 s39, s17, 0
    s_and_b32 s39, s39, 3
    s_mul_i32 s39, s39, 9
    s_add_u32 s39, s39, s42
    s_add_u32 s39, s39, 0
    s_mul_i32 s39, s39, 9216
    s_add_u32 s39, s39, s36
    s_add_u32 m0, s38, 36864
    s_add_u32 s32, s39, 0
    buffer_load_dwordx4 v1, s[8:11], s32 offen offset:0 lds
    buffer_load_dwordx4 v1, s[8:11], s32 offen offset:1024 lds
    buffer_load_dwordx4 v1, s[8:11], s32 offen offset:2048 lds
    buffer_load_dwordx4 v1, s[8:11], s32 offen offset:3072 lds
    s_add_u32 m0, s38, 40960
    s_add_u32 s32, s39, 4096
    buffer_load_dwordx4 v1, s[8:11], s32 offen offset:0 lds
    buffer_load_dwordx4 v1, s[8:11], s32 offen offset:1024 lds
    buffer_load_dwordx4 v1, s[8:11], s32 offen offset:2048 lds
    buffer_load_dwordx4 v1, s[8:11], s32 offen offset:3072 lds
    s_add_u32 m0, s38, 45056
    s_add_u32 s32, s39, 8192
    buffer_load_dwordx4 v1, s[8:11], s32 offen offset:0 lds
    s_waitcnt vmcnt(9)
    s_barrier
    s_mov_b64 exec, 1
    buffer_store_dword v9, v8, s[8:11], s34 offen offset:0 sc1
    s_mov_b64 exec, -1
    s_add_u32 s39, s17, 0
    s_and_b32 s39, s39, 3
    s_mul_i32 s39, s39, 9
    s_add_u32 s39, s39, s42
    s_add_u32 s39, s39, 2
    s_mul_i32 s39, s39, 9216
    s_add_u32 s39, s39, s36
    s_add_u32 m0, s38, 73728
    s_add_u32 s32, s39, 0
    buffer_load_dwordx4 v1, s[8:11], s32 offen offset:0 lds
    buffer_load_dwordx4 v1, s[8:11], s32 offen offset:1024 lds
    buffer_load_dwordx4 v1, s[8:11], s32 offen offset:2048 lds
    buffer_load_dwordx4 v1, s[8:11], s32 offen offset:3072 lds
    s_add_u32 m0, s38, 77824
    s_add_u32 s32, s39, 4096
    buffer_load_dwordx4 v1, s[8:11], s32 offen offset:0 lds
    buffer_load_dwordx4 v1, s[8:11], s32 offen offset:1024 lds
    buffer_load_dwordx4 v1, s[8:11], s32 offen offset:2048 lds
    buffer_load_dwordx4 v1, s[8:11], s32 offen offset:3072 lds
    s_add_u32 m0, s38, 81920
    s_add_u32 s32, s39, 8192
    buffer_load_dwordx4 v1, s[8:11], s32 offen offset:0 lds
    s_waitcnt vmcnt(10)
    s_barrier
    s_add_u32 s39, s17, 0
    s_and_b32 s39, s39, 3
    s_mul_i32 s39, s39, 9
    s_add_u32 s39, s39, s42
    s_add_u32 s39, s39, 4
    s_mul_i32 s39, s39, 9216
    s_add_u32 s39, s39, s36
    s_add_u32 m0, s38, 110592
    s_add_u32 s32, s39, 0
    buffer_load_dwordx4 v1, s[8:11], s32 offen offset:0 lds
    buffer_load_dwordx4 v1, s[8:11], s32 offen offset:1024 lds
    buffer_load_dwordx4 v1, s[8:11], s32 offen offset:2048 lds
    buffer_load_dwordx4 v1, s[8:11], s32 offen offset:3072 lds
    s_add_u32 m0, s38, 114688
    s_add_u32 s32, s39, 4096
    buffer_load_dwordx4 v1, s[8:11], s32 offen offset:0 lds
    buffer_load_dwordx4 v1, s[8:11], s32 offen offset:1024 lds
    buffer_load_dwordx4 v1, s[8:11], s32 offen offset:2048 lds
    buffer_load_dwordx4 v1, s[8:11], s32 offen offset:3072 lds
    s_add_u32 m0, s38, 118784
    s_add_u32 s32, s39, 8192
    buffer_load_dwordx4 v1, s[8:11], s32 offen offset:0 lds
    s_waitcnt vmcnt(9)
    s_barrier
    s_add_u32 s39, s17, 1
    s_and_b32 s39, s39, 3
    s_mul_i32 s39, s39, 9
    s_add_u32 s39, s39, s42
    s_add_u32 s39, s39, 0
    s_mul_i32 s39, s39, 9216
    s_add_u32 s39, s39, s36
    s_add_u32 m0, s38, 0
    s_add_u32 s32, s39, 0
    buffer_load_dwordx4 v1, s[8:11], s32 offen offset:0 lds
    buffer_load_dwordx4 v1, s[8:11], s32 offen offset:1024 lds
    buffer_load_dwordx4 v1, s[8:11], s32 offen offset:2048 lds
    buffer_load_dwordx4 v1, s[8:11], s32 offen offset:3072 lds
    s_add_u32 m0, s38, 4096
    s_add_u32 s32, s39, 4096
    buffer_load_dwordx4 v1, s[8:11], s32 offen offset:0 lds
    buffer_load_dwordx4 v1, s[8:11], s32 offen offset:1024 lds
    buffer_load_dwordx4 v1, s[8:11], s32 offen offset:2048 lds
    buffer_load_dwordx4 v1, s[8:11], s32 offen offset:3072 lds
    s_add_u32 m0, s38, 8192
    s_add_u32 s32, s39, 8192
    buffer_load_dwordx4 v1, s[8:11], s32 offen offset:0 lds
    s_waitcnt vmcnt(9)
    s_barrier
    s_mov_b64 exec, 1
    buffer_store_dword v9, v8, s[8:11], s34 offen offset:16 sc1
    s_mov_b64 exec, -1
    s_add_u32 s39, s17, 1
    s_and_b32 s39, s39, 3
    s_mul_i32 s39, s39, 9
    s_add_u32 s39, s39, s42
    s_add_u32 s39, s39, 2
    s_mul_i32 s39, s39, 9216
    s_add_u32 s39, s39, s36
    s_add_u32 m0, s38, 36864
    s_add_u32 s32, s39, 0
    buffer_load_dwordx4 v1, s[8:11], s32 offen offset:0 lds
    buffer_load_dwordx4 v1, s[8:11], s32 offen offset:1024 lds
    buffer_load_dwordx4 v1, s[8:11], s32 offen offset:2048 lds
    buffer_load_dwordx4 v1, s[8:11], s32 offen offset:3072 lds
    s_add_u32 m0, s38, 40960
    s_add_u32 s32, s39, 4096
    buffer_load_dwordx4 v1, s[8:11], s32 offen offset:0 lds
    buffer_load_dwordx4 v1, s[8:11], s32 offen offset:1024 lds
    buffer_load_dwordx4 v1, s[8:11], s32 offen offset:2048 lds
    buffer_load_dwordx4 v1, s[8:11], s32 offen offset:3072 lds
    s_add_u32 m0, s38, 45056
    s_add_u32 s32, s39, 8192
    buffer_load_dwordx4 v1, s[8:11], s32 offen offset:0 lds
    s_waitcnt vmcnt(10)
    s_barrier
    s_add_u32 s39, s17, 1
    s_and_b32 s39, s39, 3
    s_mul_i32 s39, s39, 9
    s_add_u32 s39, s39, s42
    s_add_u32 s39, s39, 4
    s_mul_i32 s39, s39, 9216
    s_add_u32 s39, s39, s36
    s_add_u32 m0, s38, 73728
    s_add_u32 s32, s39, 0
    buffer_load_dwordx4 v1, s[8:11], s32 offen offset:0 lds
    buffer_load_dwordx4 v1, s[8:11], s32 offen offset:1024 lds
    buffer_load_dwordx4 v1, s[8:11], s32 offen offset:2048 lds
    buffer_load_dwordx4 v1, s[8:11], s32 offen offset:3072 lds
    s_add_u32 m0, s38, 77824
    s_add_u32 s32, s39, 4096
    buffer_load_dwordx4 v1, s[8:11], s32 offen offset:0 lds
    buffer_load_dwordx4 v1, s[8:11], s32 offen offset:1024 lds
    buffer_load_dwordx4 v1, s[8:11], s32 offen offset:2048 lds
    buffer_load_dwordx4 v1, s[8:11], s32 offen offset:3072 lds
    s_add_u32 m0, s38, 81920
    s_add_u32 s32, s39, 8192
    buffer_load_dwordx4 v1, s[8:11], s32 offen offset:0 lds
    s_waitcnt vmcnt(9)
    s_barrier
    s_add_u32 s39, s17, 2
    s_and_b32 s39, s39, 3
    s_mul_i32 s39, s39, 9
    s_add_u32 s39, s39, s42
    s_add_u32 s39, s39, 0
    s_mul_i32 s39, s39, 9216
    s_add_u32 s39, s39, s36
    s_add_u32 m0, s38, 110592
    s_add_u32 s32, s39, 0
    buffer_load_dwordx4 v1, s[8:11], s32 offen offset:0 lds
    buffer_load_dwordx4 v1, s[8:11], s32 offen offset:1024 lds
    buffer_load_dwordx4 v1, s[8:11], s32 offen offset:2048 lds
    buffer_load_dwordx4 v1, s[8:11], s32 offen offset:3072 lds
    s_add_u32 m0, s38, 114688
    s_add_u32 s32, s39, 4096
    buffer_load_dwordx4 v1, s[8:11], s32 offen offset:0 lds
    buffer_load_dwordx4 v1, s[8:11], s32 offen offset:1024 lds
    buffer_load_dwordx4 v1, s[8:11], s32 offen offset:2048 lds
    buffer_load_dwordx4 v1, s[8:11], s32 offen offset:3072 lds
    s_add_u32 m0, s38, 118784
    s_add_u32 s32, s39, 8192
    buffer_load_dwordx4 v1, s[8:11], s32 offen offset:0 lds
    s_waitcnt vmcnt(9)
    s_barrier
    s_add_u32 s39, s17, 2
    s_and_b32 s39, s39, 3
    s_mul_i32 s39, s39, 9
    s_add_u32 s39, s39, s42
    s_add_u32 s39, s39, 2
    s_mul_i32 s39, s39, 9216
    s_add_u32 s39, s39, s36
    s_add_u32 m0, s38, 0
    s_add_u32 s32, s39, 0
    buffer_load_dwordx4 v1, s[8:11], s32 offen offset:0 lds
    buffer_load_dwordx4 v1, s[8:11], s32 offen offset:1024 lds
    buffer_load_dwordx4 v1, s[8:11], s32 offen offset:2048 lds
    buffer_load_dwordx4 v1, s[8:11], s32 offen offset:3072 lds
    s_add_u32 m0, s38, 4096
    s_add_u32 s32, s39, 4096
    buffer_load_dwordx4 v1, s[8:11], s32 offen offset:0 lds
    buffer_load_dwordx4 v1, s[8:11], s32 offen offset:1024 lds
    buffer_load_dwordx4 v1, s[8:11], s32 offen offset:2048 lds
    buffer_load_dwordx4 v1, s[8:11], s32 offen offset:3072 lds
    s_add_u32 m0, s38, 8192
    s_add_u32 s32, s39, 8192
    buffer_load_dwordx4 v1, s[8:11], s32 offen offset:0 lds
    s_waitcnt vmcnt(9)
    s_barrier
    s_add_u32 s39, s17, 2
    s_and_b32 s39, s39, 3
    s_mul_i32 s39, s39, 9
    s_add_u32 s39, s39, s42
    s_add_u32 s39, s39, 4
    s_mul_i32 s39, s39, 9216
    s_add_u32 s39, s39, s36
    s_add_u32 m0, s38, 36864
    s_add_u32 s32, s39, 0
    buffer_load_dwordx4 v1, s[8:11], s32 offen offset:0 lds
    buffer_load_dwordx4 v1, s[8:11], s32 offen offset:1024 lds
    buffer_load_dwordx4 v1, s[8:11], s32 offen offset:2048 lds
    buffer_load_dwordx4 v1, s[8:11], s32 offen offset:3072 lds
    s_add_u32 m0, s38, 40960
    s_add_u32 s32, s39, 4096
    buffer_load_dwordx4 v1, s[8:11], s32 offen offset:0 lds
    buffer_load_dwordx4 v1, s[8:11], s32 offen offset:1024 lds
    buffer_load_dwordx4 v1, s[8:11], s32 offen offset:2048 lds
    buffer_load_dwordx4 v1, s[8:11], s32 offen offset:3072 lds
    s_add_u32 m0, s38, 45056
    s_add_u32 s32, s39, 8192
    buffer_load_dwordx4 v1, s[8:11], s32 offen offset:0 lds
    s_waitcnt vmcnt(9)
    s_barrier
    s_add_u32 s39, s17, 3
    s_and_b32 s39, s39, 3
    s_mul_i32 s39, s39, 9
    s_add_u32 s39, s39, s42
    s_add_u32 s39, s39, 0
    s_mul_i32 s39, s39, 9216
    s_add_u32 s39, s39, s36
    s_add_u32 m0, s38, 73728
    s_add_u32 s32, s39, 0
    buffer_load_dwordx4 v1, s[8:11], s32 offen offset:0 lds
    buffer_load_dwordx4 v1, s[8:11], s32 offen offset:1024 lds
    buffer_load_dwordx4 v1, s[8:11], s32 offen offset:2048 lds
    buffer_load_dwordx4 v1, s[8:11], s32 offen offset:3072 lds
    s_add_u32 m0, s38, 77824
    s_add_u32 s32, s39, 4096
    buffer_load_dwordx4 v1, s[8:11], s32 offen offset:0 lds
    buffer_load_dwordx4 v1, s[8:11], s32 offen offset:1024 lds
    buffer_load_dwordx4 v1, s[8:11], s32 offen offset:2048 lds
    buffer_load_dwordx4 v1, s[8:11], s32 offen offset:3072 lds
    s_add_u32 m0, s38, 81920
    s_add_u32 s32, s39, 8192
    buffer_load_dwordx4 v1, s[8:11], s32 offen offset:0 lds
    s_waitcnt vmcnt(9)
    s_barrier
    s_add_u32 s39, s17, 3
    s_and_b32 s39, s39, 3
    s_mul_i32 s39, s39, 9
    s_add_u32 s39, s39, s42
    s_add_u32 s39, s39, 2
    s_mul_i32 s39, s39, 9216
    s_add_u32 s39, s39, s36
    s_add_u32 m0, s38, 110592
    s_add_u32 s32, s39, 0
    buffer_load_dwordx4 v1, s[8:11], s32 offen offset:0 lds
    buffer_load_dwordx4 v1, s[8:11], s32 offen offset:1024 lds
    buffer_load_dwordx4 v1, s[8:11], s32 offen offset:2048 lds
    buffer_load_dwordx4 v1, s[8:11], s32 offen offset:3072 lds
    s_add_u32 m0, s38, 114688
    s_add_u32 s32, s39, 4096
    buffer_load_dwordx4 v1, s[8:11], s32 offen offset:0 lds
    buffer_load_dwordx4 v1, s[8:11], s32 offen offset:1024 lds
    buffer_load_dwordx4 v1, s[8:11], s32 offen offset:2048 lds
    buffer_load_dwordx4 v1, s[8:11], s32 offen offset:3072 lds
    s_add_u32 m0, s38, 118784
    s_add_u32 s32, s39, 8192
    buffer_load_dwordx4 v1, s[8:11], s32 offen offset:0 lds
    s_waitcnt vmcnt(9)
    s_barrier
    s_add_u32 s39, s17, 3
    s_and_b32 s39, s39, 3
    s_mul_i32 s39, s39, 9
    s_add_u32 s39, s39, s42
    s_add_u32 s39, s39, 4
    s_mul_i32 s39, s39, 9216
    s_add_u32 s39, s39, s36
    s_add_u32 m0, s38, 0
    s_add_u32 s32, s39, 0
    buffer_load_dwordx4 v1, s[8:11], s32 offen offset:0 lds
    buffer_load_dwordx4 v1, s[8:11], s32 offen offset:1024 lds
    buffer_load_dwordx4 v1, s[8:11], s32 offen offset:2048 lds
    buffer_load_dwordx4 v1, s[8:11], s32 offen offset:3072 lds
    s_add_u32 m0, s38, 4096
    s_add_u32 s32, s39, 4096
    buffer_load_dwordx4 v1, s[8:11], s32 offen offset:0 lds
    buffer_load_dwordx4 v1, s[8:11], s32 offen offset:1024 lds
    buffer_load_dwordx4 v1, s[8:11], s32 offen offset:2048 lds
    buffer_load_dwordx4 v1, s[8:11], s32 offen offset:3072 lds
    s_add_u32 m0, s38, 8192
    s_add_u32 s32, s39, 8192
    buffer_load_dwordx4 v1, s[8:11], s32 offen offset:0 lds
    s_waitcnt vmcnt(9)
    s_barrier
    s_add_u32 s39, s17, 0
    s_and_b32 s39, s39, 3
    s_mul_i32 s39, s39, 9
    s_add_u32 s39, s39, s42
    s_add_u32 s39, s39, 6
    s_mul_i32 s39, s39, 9216
    s_add_u32 s39, s39, s36
    s_add_u32 m0, s38, 36864
    s_add_u32 s32, s39, 0
    buffer_load_dwordx4 v1, s[8:11], s32 offen offset:0 lds
    buffer_load_dwordx4 v1, s[8:11], s32 offen offset:1024 lds
    buffer_load_dwordx4 v1, s[8:11], s32 offen offset:2048 lds
    buffer_load_dwordx4 v1, s[8:11], s32 offen offset:3072 lds
    s_add_u32 m0, s38, 40960
    s_add_u32 s32, s39, 4096
    buffer_load_dwordx4 v1, s[8:11], s32 offen offset:0 lds
    buffer_load_dwordx4 v1, s[8:11], s32 offen offset:1024 lds
    buffer_load_dwordx4 v1, s[8:11], s32 offen offset:2048 lds
    buffer_load_dwordx4 v1, s[8:11], s32 offen offset:3072 lds
    s_add_u32 m0, s38, 45056
    s_add_u32 s32, s39, 8192
    buffer_load_dwordx4 v1, s[8:11], s32 offen offset:0 lds
    s_waitcnt vmcnt(9)
    s_barrier
    s_add_u32 s39, s17, 1
    s_and_b32 s39, s39, 3
    s_mul_i32 s39, s39, 9
    s_add_u32 s39, s39, s42
    s_add_u32 s39, s39, 6
    s_mul_i32 s39, s39, 9216
    s_add_u32 s39, s39, s36
    s_add_u32 m0, s38, 73728
    s_add_u32 s32, s39, 0
    buffer_load_dwordx4 v1, s[8:11], s32 offen offset:0 lds
    buffer_load_dwordx4 v1, s[8:11], s32 offen offset:1024 lds
    buffer_load_dwordx4 v1, s[8:11], s32 offen offset:2048 lds
    buffer_load_dwordx4 v1, s[8:11], s32 offen offset:3072 lds
    s_add_u32 m0, s38, 77824
    s_add_u32 s32, s39, 4096
    buffer_load_dwordx4 v1, s[8:11], s32 offen offset:0 lds
    buffer_load_dwordx4 v1, s[8:11], s32 offen offset:1024 lds
    buffer_load_dwordx4 v1, s[8:11], s32 offen offset:2048 lds
    buffer_load_dwordx4 v1, s[8:11], s32 offen offset:3072 lds
    s_add_u32 m0, s38, 81920
    s_add_u32 s32, s39, 8192
    buffer_load_dwordx4 v1, s[8:11], s32 offen offset:0 lds
    s_waitcnt vmcnt(9)
    s_barrier
    s_add_u32 s39, s17, 2
    s_and_b32 s39, s39, 3
    s_mul_i32 s39, s39, 9
    s_add_u32 s39, s39, s42
    s_add_u32 s39, s39, 6
    s_mul_i32 s39, s39, 9216
    s_add_u32 s39, s39, s36
    s_add_u32 m0, s38, 110592
    s_add_u32 s32, s39, 0
    buffer_load_dwordx4 v1, s[8:11], s32 offen offset:0 lds
    buffer_load_dwordx4 v1, s[8:11], s32 offen offset:1024 lds
    buffer_load_dwordx4 v1, s[8:11], s32 offen offset:2048 lds
    buffer_load_dwordx4 v1, s[8:11], s32 offen offset:3072 lds
    s_add_u32 m0, s38, 114688
    s_add_u32 s32, s39, 4096
    buffer_load_dwordx4 v1, s[8:11], s32 offen offset:0 lds
    buffer_load_dwordx4 v1, s[8:11], s32 offen offset:1024 lds
    buffer_load_dwordx4 v1, s[8:11], s32 offen offset:2048 lds
    buffer_load_dwordx4 v1, s[8:11], s32 offen offset:3072 lds
    s_add_u32 m0, s38, 118784
    s_add_u32 s32, s39, 8192
    buffer_load_dwordx4 v1, s[8:11], s32 offen offset:0 lds
    s_waitcnt vmcnt(9)
    s_barrier
    s_add_u32 s39, s17, 3
    s_and_b32 s39, s39, 3
    s_mul_i32 s39, s39, 9
    s_add_u32 s39, s39, s42
    s_add_u32 s39, s39, 6
    s_mul_i32 s39, s39, 9216
    s_add_u32 s39, s39, s36
    s_add_u32 m0, s38, 0
    s_add_u32 s32, s39, 0
    buffer_load_dwordx4 v1, s[8:11], s32 offen offset:0 lds
    buffer_load_dwordx4 v1, s[8:11], s32 offen offset:1024 lds
    buffer_load_dwordx4 v1, s[8:11], s32 offen offset:2048 lds
    buffer_load_dwordx4 v1, s[8:11], s32 offen offset:3072 lds
    s_add_u32 m0, s38, 4096
    s_add_u32 s32, s39, 4096
    buffer_load_dwordx4 v1, s[8:11], s32 offen offset:0 lds
    buffer_load_dwordx4 v1, s[8:11], s32 offen offset:1024 lds
    buffer_load_dwordx4 v1, s[8:11], s32 offen offset:2048 lds
    buffer_load_dwordx4 v1, s[8:11], s32 offen offset:3072 lds
    s_add_u32 m0, s38, 8192
    s_add_u32 s32, s39, 8192
    buffer_load_dwordx4 v1, s[8:11], s32 offen offset:0 lds
    s_waitcnt vmcnt(9)
    s_barrier
    s_add_u32 s39, s17, s42
    s_add_u32 s39, s39, 0
    s_and_b32 s39, s39, 3
    s_mul_i32 s39, s39, 9
    s_add_u32 s39, s39, 8
    s_mul_i32 s39, s39, 9216
    s_add_u32 s39, s39, s36
    s_add_u32 m0, s38, 36864
    s_add_u32 s32, s39, 0
    buffer_load_dwordx4 v1, s[8:11], s32 offen offset:0 lds
    buffer_load_dwordx4 v1, s[8:11], s32 offen offset:1024 lds
    buffer_load_dwordx4 v1, s[8:11], s32 offen offset:2048 lds
    buffer_load_dwordx4 v1, s[8:11], s32 offen offset:3072 lds
    s_add_u32 m0, s38, 40960
    s_add_u32 s32, s39, 4096
    buffer_load_dwordx4 v1, s[8:11], s32 offen offset:0 lds
    buffer_load_dwordx4 v1, s[8:11], s32 offen offset:1024 lds
    buffer_load_dwordx4 v1, s[8:11], s32 offen offset:2048 lds
    buffer_load_dwordx4 v1, s[8:11], s32 offen offset:3072 lds
    s_add_u32 m0, s38, 45056
    s_add_u32 s32, s39, 8192
    buffer_load_dwordx4 v1, s[8:11], s32 offen offset:0 lds
    s_waitcnt vmcnt(9)
    s_barrier
    s_add_u32 s39, s17, s42
    s_add_u32 s39, s39, 2
    s_and_b32 s39, s39, 3
    s_mul_i32 s39, s39, 9
    s_add_u32 s39, s39, 8
    s_mul_i32 s39, s39, 9216
    s_add_u32 s39, s39, s36
    s_add_u32 m0, s38, 73728
    s_add_u32 s32, s39, 0
    buffer_load_dwordx4 v1, s[8:11], s32 offen offset:0 lds
    buffer_load_dwordx4 v1, s[8:11], s32 offen offset:1024 lds
    buffer_load_dwordx4 v1, s[8:11], s32 offen offset:2048 lds
    buffer_load_dwordx4 v1, s[8:11], s32 offen offset:3072 lds
    s_add_u32 m0, s38, 77824
    s_add_u32 s32, s39, 4096
    buffer_load_dwordx4 v1, s[8:11], s32 offen offset:0 lds
    buffer_load_dwordx4 v1, s[8:11], s32 offen offset:1024 lds
    buffer_load_dwordx4 v1, s[8:11], s32 offen offset:2048 lds
    buffer_load_dwordx4 v1, s[8:11], s32 offen offset:3072 lds
    s_add_u32 m0, s38, 81920
    s_add_u32 s32, s39, 8192
    buffer_load_dwordx4 v1, s[8:11], s32 offen offset:0 lds
    s_waitcnt vmcnt(9)
    s_barrier
    s_waitcnt vmcnt(0)
    s_barrier
    s_mov_b32 s13, s40
    s_mov_b32 s23, s41
    s_barrier
    s_branch g2_phc
m_prodT:
    s_waitcnt vmcnt(9)
    s_barrier
    s_add_u32 s39, s17, 0
    s_and_b32 s39, s39, 3
    s_mul_i32 s39, s39, 9
    s_add_u32 s39, s39, s42
    s_add_u32 s39, s39, 0
    s_lshl_b32 s39, s39, 10
    s_add_u32 s39, s39, s43
    s_add_u32 m0, s38, 46080
    s_add_u32 s32, s39, 0
    buffer_load_dwordx4 v1, s[8:11], s32 offen sc1 lds
    s_add_u32 m0, s38, 47104
    s_add_u32 s32, s39, 147456
    buffer_load_dwordx4 v1, s[8:11], s32 offen sc1 lds
    s_add_u32 m0, s38, 48128
    s_add_u32 s32, s39, 294912
    buffer_load_dwordx4 v1, s[8:11], s32 offen sc1 lds
    s_add_u32 m0, s38, 49152
    s_add_u32 s32, s39, 442368
    buffer_load_dwordx4 v1, s[8:11], s32 offen sc1 lds
    s_add_u32 m0, s38, 50176
    s_add_u32 s32, s39, 589824
    buffer_load_dwordx4 v1, s[8:11], s32 offen sc1 lds
    s_add_u32 m0, s38, 51200
    s_add_u32 s32, s39, 737280
    buffer_load_dwordx4 v1, s[8:11], s32 offen sc1 lds
    s_add_u32 m0, s38, 52224
    s_add_u32 s32, s39, 884736
    buffer_load_dwordx4 v1, s[8:11], s32 offen sc1 lds
    s_add_u32 m0, s38, 53248
    s_add_u32 s32, s39, 1032192
    buffer_load_dwordx4 v1, s[8:11], s32 offen sc1 lds
    s_waitcnt vmcnt(8)
    s_barrier
    s_add_u32 s39, s17, 0
    s_and_b32 s39, s39, 3
    s_mul_i32 s39, s39, 9
    s_add_u32 s39, s39, s42
    s_add_u32 s39, s39, 2
    s_lshl_b32 s39, s39, 10
    s_add_u32 s39, s39, s43
    s_add_u32 m0, s38, 82944
    s_add_u32 s32, s39, 0
    buffer_load_dwordx4 v1, s[8:11], s32 offen sc1 lds
    s_add_u32 m0, s38, 83968
    s_add_u32 s32, s39, 147456
    buffer_load_dwordx4 v1, s[8:11], s32 offen sc1 lds
    s_add_u32 m0, s38, 84992
    s_add_u32 s32, s39, 294912
    buffer_load_dwordx4 v1, s[8:11], s32 offen sc1 lds
    s_add_u32 m0, s38, 86016
    s_add_u32 s32, s39, 442368
    buffer_load_dwordx4 v1, s[8:11], s32 offen sc1 lds
    s_add_u32 m0, s38, 87040
    s_add_u32 s32, s39, 589824
    buffer_load_dwordx4 v1, s[8:11], s32 offen sc1 lds
    s_add_u32 m0, s38, 88064
    s_add_u32 s32, s39, 737280
    buffer_load_dwordx4 v1, s[8:11], s32 offen sc1 lds
    s_add_u32 m0, s38, 89088
    s_add_u32 s32, s39, 884736
    buffer_load_dwordx4 v1, s[8:11], s32 offen sc1 lds
    s_add_u32 m0, s38, 90112
    s_add_u32 s32, s39, 1032192
    buffer_load_dwordx4 v1, s[8:11], s32 offen sc1 lds
    s_waitcnt vmcnt(8)
    s_barrier
    s_add_u32 s39, s17, 0
    s_and_b32 s39, s39, 3
    s_mul_i32 s39, s39, 9
    s_add_u32 s39, s39, s42
    s_add_u32 s39, s39, 4
    s_lshl_b32 s39, s39, 10
    s_add_u32 s39, s39, s43
    s_add_u32 m0, s38, 119808
    s_add_u32 s32, s39, 0
    buffer_load_dwordx4 v1, s[8:11], s32 offen sc1 lds
    s_add_u32 m0, s38, 120832
    s_add_u32 s32, s39, 147456
    buffer_load_dwordx4 v1, s[8:11], s32 offen sc1 lds
    s_add_u32 m0, s38, 121856
    s_add_u32 s32, s39, 294912
    buffer_load_dwordx4 v1, s[8:11], s32 offen sc1 lds
    s_add_u32 m0, s38, 122880
    s_add_u32 s32, s39, 442368
    buffer_load_dwordx4 v1, s[8:11], s32 offen sc1 lds
    s_add_u32 m0, s38, 123904
    s_add_u32 s32, s39, 589824
    buffer_load_dwordx4 v1, s[8:11], s32 offen sc1 lds
    s_add_u32 m0, s38, 124928
    s_add_u32 s32, s39, 737280
    buffer_load_dwordx4 v1, s[8:11], s32 offen sc1 lds
    s_add_u32 m0, s38, 125952
    s_add_u32 s32, s39, 884736
    buffer_load_dwordx4 v1, s[8:11], s32 offen sc1 lds
    s_add_u32 m0, s38, 126976
    s_add_u32 s32, s39, 1032192
    buffer_load_dwordx4 v1, s[8:11], s32 offen sc1 lds
    s_waitcnt vmcnt(8)
    s_barrier
    s_mov_b32 s35, 0
m_hpa:
    buffer_load_dwordx4 v[12:15], v8, s[8:11], s33 offen offset:0 sc1
    s_waitcnt vmcnt(0)
    v_add3_u32 v12, v12, v13, v14
    v_add_u32 v12, v12, v15
    s_nop 0
    v_readfirstlane_b32 s37, v12
    s_cmp_ge_u32 s37, 4
    s_cbranch_scc1 m_hpda
    s_add_u32 s35, s35, 1
    s_cmp_lt_u32 s35, 0x100000
    s_cbranch_scc1 m_hpa
m_hpda:
    s_add_u32 s39, s17, 1
    s_and_b32 s39, s39, 3
    s_mul_i32 s39, s39, 9
    s_add_u32 s39, s39, s42
    s_add_u32 s39, s39, 0
    s_lshl_b32 s39, s39, 10
    s_add_u32 s39, s39, s43
    s_add_u32 m0, s38, 9216
    s_add_u32 s32, s39, 0
    buffer_load_dwordx4 v1, s[8:11], s32 offen sc1 lds
    s_add_u32 m0, s38, 10240
    s_add_u32 s32, s39, 147456
    buffer_load_dwordx4 v1, s[8:11], s32 offen sc1 lds
    s_add_u32 m0, s38, 11264
    s_add_u32 s32, s39, 294912
    buffer_load_dwordx4 v1, s[8:11], s32 offen sc1 lds
    s_add_u32 m0, s38, 12288
    s_add_u32 s32, s39, 442368
    buffer_load_dwordx4 v1, s[8:11], s32 offen sc1 lds
    s_add_u32 m0, s38, 13312
    s_add_u32 s32, s39, 589824
    buffer_load_dwordx4 v1, s[8:11], s32 offen sc1 lds
    s_add_u32 m0, s38, 14336
    s_add_u32 s32, s39, 737280
    buffer_load_dwordx4 v1, s[8:11], s32 offen sc1 lds
    s_add_u32 m0, s38, 15360
    s_add_u32 s32, s39, 884736
    buffer_load_dwordx4 v1, s[8:11], s32 offen sc1 lds
    s_add_u32 m0, s38, 16384
    s_add_u32 s32, s39, 1032192
    buffer_load_dwordx4 v1, s[8:11], s32 offen sc1 lds
    s_barrier
    s_add_u32 s39, s17, 1
    s_and_b32 s39, s39, 3
    s_mul_i32 s39, s39, 9
    s_add_u32 s39, s39, s42
    s_add_u32 s39, s39, 2
    s_lshl_b32 s39, s39, 10
    s_add_u32 s39, s39, s43
    s_add_u32 m0, s38, 46080
    s_add_u32 s32, s39, 0
    buffer_load_dwordx4 v1, s[8:11], s32 offen sc1 lds
    s_add_u32 m0, s38, 47104
    s_add_u32 s32, s39, 147456
    buffer_load_dwordx4 v1, s[8:11], s32 offen sc1 lds
    s_add_u32 m0, s38, 48128
    s_add_u32 s32, s39, 294912
    buffer_load_dwordx4 v1, s[8:11], s32 offen sc1 lds
    s_add_u32 m0, s38, 49152
    s_add_u32 s32, s39, 442368
    buffer_load_dwordx4 v1, s[8:11], s32 offen sc1 lds
    s_add_u32 m0, s38, 50176
    s_add_u32 s32, s39, 589824
    buffer_load_dwordx4 v1, s[8:11], s32 offen sc1 lds
    s_add_u32 m0, s38, 51200
    s_add_u32 s32, s39, 737280
    buffer_load_dwordx4 v1, s[8:11], s32 offen sc1 lds
    s_add_u32 m0, s38, 52224
    s_add_u32 s32, s39, 884736
    buffer_load_dwordx4 v1, s[8:11], s32 offen sc1 lds
    s_add_u32 m0, s38, 53248
    s_add_u32 s32, s39, 1032192
    buffer_load_dwordx4 v1, s[8:11], s32 offen sc1 lds
    s_waitcnt vmcnt(8)
    s_barrier
    s_add_u32 s39, s17, 1
    s_and_b32 s39, s39, 3
    s_mul_i32 s39, s39, 9
    s_add_u32 s39, s39, s42
    s_add_u32 s39, s39, 4
    s_lshl_b32 s39, s39, 10
    s_add_u32 s39, s39, s43
    s_add_u32 m0, s38, 82944
    s_add_u32 s32, s39, 0
    buffer_load_dwordx4 v1, s[8:11], s32 offen sc1 lds
    s_add_u32 m0, s38, 83968
    s_add_u32 s32, s39, 147456
    buffer_load_dwordx4 v1, s[8:11], s32 offen sc1 lds
    s_add_u32 m0, s38, 84992
    s_add_u32 s32, s39, 294912
    buffer_load_dwordx4 v1, s[8:11], s32 offen sc1 lds
    s_add_u32 m0, s38, 86016
    s_add_u32 s32, s39, 442368
    buffer_load_dwordx4 v1, s[8:11], s32 offen sc1 lds
    s_add_u32 m0, s38, 87040
    s_add_u32 s32, s39, 589824
    buffer_load_dwordx4 v1, s[8:11], s32 offen sc1 lds
    s_add_u32 m0, s38, 88064
    s_add_u32 s32, s39, 737280
    buffer_load_dwordx4 v1, s[8:11], s32 offen sc1 lds
    s_add_u32 m0, s38, 89088
    s_add_u32 s32, s39, 884736
    buffer_load_dwordx4 v1, s[8:11], s32 offen sc1 lds
    s_add_u32 m0, s38, 90112
    s_add_u32 s32, s39, 1032192
    buffer_load_dwordx4 v1, s[8:11], s32 offen sc1 lds
    s_waitcnt vmcnt(8)
    s_barrier
    s_add_u32 s39, s17, 2
    s_and_b32 s39, s39, 3
    s_mul_i32 s39, s39, 9
    s_add_u32 s39, s39, s42
    s_add_u32 s39, s39, 0
    s_lshl_b32 s39, s39, 10
    s_add_u32 s39, s39, s43
    s_add_u32 m0, s38, 119808
    s_add_u32 s32, s39, 0
    buffer_load_dwordx4 v1, s[8:11], s32 offen sc1 lds
    s_add_u32 m0, s38, 120832
    s_add_u32 s32, s39, 147456
    buffer_load_dwordx4 v1, s[8:11], s32 offen sc1 lds
    s_add_u32 m0, s38, 121856
    s_add_u32 s32, s39, 294912
    buffer_load_dwordx4 v1, s[8:11], s32 offen sc1 lds
    s_add_u32 m0, s38, 122880
    s_add_u32 s32, s39, 442368
    buffer_load_dwordx4 v1, s[8:11], s32 offen sc1 lds
    s_add_u32 m0, s38, 123904
    s_add_u32 s32, s39, 589824
    buffer_load_dwordx4 v1, s[8:11], s32 offen sc1 lds
    s_add_u32 m0, s38, 124928
    s_add_u32 s32, s39, 737280
    buffer_load_dwordx4 v1, s[8:11], s32 offen sc1 lds
    s_add_u32 m0, s38, 125952
    s_add_u32 s32, s39, 884736
    buffer_load_dwordx4 v1, s[8:11], s32 offen sc1 lds
    s_add_u32 m0, s38, 126976
    s_add_u32 s32, s39, 1032192
    buffer_load_dwordx4 v1, s[8:11], s32 offen sc1 lds
    s_waitcnt vmcnt(8)
    s_barrier
    s_add_u32 s39, s17, 2
    s_and_b32 s39, s39, 3
    s_mul_i32 s39, s39, 9
    s_add_u32 s39, s39, s42
    s_add_u32 s39, s39, 2
    s_lshl_b32 s39, s39, 10
    s_add_u32 s39, s39, s43
    s_add_u32 m0, s38, 9216
    s_add_u32 s32, s39, 0
    buffer_load_dwordx4 v1, s[8:11], s32 offen sc1 lds
    s_add_u32 m0, s38, 10240
    s_add_u32 s32, s39, 147456
    buffer_load_dwordx4 v1, s[8:11], s32 offen sc1 lds
    s_add_u32 m0, s38, 11264
    s_add_u32 s32, s39, 294912
    buffer_load_dwordx4 v1, s[8:11], s32 offen sc1 lds
    s_add_u32 m0, s38, 12288
    s_add_u32 s32, s39, 442368
    buffer_load_dwordx4 v1, s[8:11], s32 offen sc1 lds
    s_add_u32 m0, s38, 13312
    s_add_u32 s32, s39, 589824
    buffer_load_dwordx4 v1, s[8:11], s32 offen sc1 lds
    s_add_u32 m0, s38, 14336
    s_add_u32 s32, s39, 737280
    buffer_load_dwordx4 v1, s[8:11], s32 offen sc1 lds
    s_add_u32 m0, s38, 15360
    s_add_u32 s32, s39, 884736
    buffer_load_dwordx4 v1, s[8:11], s32 offen sc1 lds
    s_add_u32 m0, s38, 16384
    s_add_u32 s32, s39, 1032192
    buffer_load_dwordx4 v1, s[8:11], s32 offen sc1 lds
    s_waitcnt vmcnt(8)
    s_barrier
    s_add_u32 s39, s17, 2
    s_and_b32 s39, s39, 3
    s_mul_i32 s39, s39, 9
    s_add_u32 s39, s39, s42
    s_add_u32 s39, s39, 4
    s_lshl_b32 s39, s39, 10
    s_add_u32 s39, s39, s43
    s_add_u32 m0, s38, 46080
    s_add_u32 s32, s39, 0
    buffer_load_dwordx4 v1, s[8:11], s32 offen sc1 lds
    s_add_u32 m0, s38, 47104
    s_add_u32 s32, s39, 147456
    buffer_load_dwordx4 v1, s[8:11], s32 offen sc1 lds
    s_add_u32 m0, s38, 48128
    s_add_u32 s32, s39, 294912
    buffer_load_dwordx4 v1, s[8:11], s32 offen sc1 lds
    s_add_u32 m0, s38, 49152
    s_add_u32 s32, s39, 442368
    buffer_load_dwordx4 v1, s[8:11], s32 offen sc1 lds
    s_add_u32 m0, s38, 50176
    s_add_u32 s32, s39, 589824
    buffer_load_dwordx4 v1, s[8:11], s32 offen sc1 lds
    s_add_u32 m0, s38, 51200
    s_add_u32 s32, s39, 737280
    buffer_load_dwordx4 v1, s[8:11], s32 offen sc1 lds
    s_add_u32 m0, s38, 52224
    s_add_u32 s32, s39, 884736
    buffer_load_dwordx4 v1, s[8:11], s32 offen sc1 lds
    s_add_u32 m0, s38, 53248
    s_add_u32 s32, s39, 1032192
    buffer_load_dwordx4 v1, s[8:11], s32 offen sc1 lds
    s_waitcnt vmcnt(8)
    s_barrier
    s_add_u32 s39, s17, 3
    s_and_b32 s39, s39, 3
    s_mul_i32 s39, s39, 9
    s_add_u32 s39, s39, s42
    s_add_u32 s39, s39, 0
    s_lshl_b32 s39, s39, 10
    s_add_u32 s39, s39, s43
    s_add_u32 m0, s38, 82944
    s_add_u32 s32, s39, 0
    buffer_load_dwordx4 v1, s[8:11], s32 offen sc1 lds
    s_add_u32 m0, s38, 83968
    s_add_u32 s32, s39, 147456
    buffer_load_dwordx4 v1, s[8:11], s32 offen sc1 lds
    s_add_u32 m0, s38, 84992
    s_add_u32 s32, s39, 294912
    buffer_load_dwordx4 v1, s[8:11], s32 offen sc1 lds
    s_add_u32 m0, s38, 86016
    s_add_u32 s32, s39, 442368
    buffer_load_dwordx4 v1, s[8:11], s32 offen sc1 lds
    s_add_u32 m0, s38, 87040
    s_add_u32 s32, s39, 589824
    buffer_load_dwordx4 v1, s[8:11], s32 offen sc1 lds
    s_add_u32 m0, s38, 88064
    s_add_u32 s32, s39, 737280
    buffer_load_dwordx4 v1, s[8:11], s32 offen sc1 lds
    s_add_u32 m0, s38, 89088
    s_add_u32 s32, s39, 884736
    buffer_load_dwordx4 v1, s[8:11], s32 offen sc1 lds
    s_add_u32 m0, s38, 90112
    s_add_u32 s32, s39, 1032192
    buffer_load_dwordx4 v1, s[8:11], s32 offen sc1 lds
    s_waitcnt vmcnt(8)
    s_barrier
    s_add_u32 s39, s17, 3
    s_and_b32 s39, s39, 3
    s_mul_i32 s39, s39, 9
    s_add_u32 s39, s39, s42
    s_add_u32 s39, s39, 2
    s_lshl_b32 s39, s39, 10
    s_add_u32 s39, s39, s43
    s_add_u32 m0, s38, 119808
    s_add_u32 s32, s39, 0
    buffer_load_dwordx4 v1, s[8:11], s32 offen sc1 lds
    s_add_u32 m0, s38, 120832
    s_add_u32 s32, s39, 147456
    buffer_load_dwordx4 v1, s[8:11], s32 offen sc1 lds
    s_add_u32 m0, s38, 121856
    s_add_u32 s32, s39, 294912
    buffer_load_dwordx4 v1, s[8:11], s32 offen sc1 lds
    s_add_u32 m0, s38, 122880
    s_add_u32 s32, s39, 442368
    buffer_load_dwordx4 v1, s[8:11], s32 offen sc1 lds
    s_add_u32 m0, s38, 123904
    s_add_u32 s32, s39, 589824
    buffer_load_dwordx4 v1, s[8:11], s32 offen sc1 lds
    s_add_u32 m0, s38, 124928
    s_add_u32 s32, s39, 737280
    buffer_load_dwordx4 v1, s[8:11], s32 offen sc1 lds
    s_add_u32 m0, s38, 125952
    s_add_u32 s32, s39, 884736
    buffer_load_dwordx4 v1, s[8:11], s32 offen sc1 lds
    s_add_u32 m0, s38, 126976
    s_add_u32 s32, s39, 1032192
    buffer_load_dwordx4 v1, s[8:11], s32 offen sc1 lds
    s_waitcnt vmcnt(8)
    s_barrier
    s_add_u32 s39, s17, 3
    s_and_b32 s39, s39, 3
    s_mul_i32 s39, s39, 9
    s_add_u32 s39, s39, s42
    s_add_u32 s39, s39, 4
    s_lshl_b32 s39, s39, 10
    s_add_u32 s39, s39, s43
    s_add_u32 m0, s38, 9216
    s_add_u32 s32, s39, 0
    buffer_load_dwordx4 v1, s[8:11], s32 offen sc1 lds
    s_add_u32 m0, s38, 10240
    s_add_u32 s32, s39, 147456
    buffer_load_dwordx4 v1, s[8:11], s32 offen sc1 lds
    s_add_u32 m0, s38, 11264
    s_add_u32 s32, s39, 294912
    buffer_load_dwordx4 v1, s[8:11], s32 offen sc1 lds
    s_add_u32 m0, s38, 12288
    s_add_u32 s32, s39, 442368
    buffer_load_dwordx4 v1, s[8:11], s32 offen sc1 lds
    s_add_u32 m0, s38, 13312
    s_add_u32 s32, s39, 589824
    buffer_load_dwordx4 v1, s[8:11], s32 offen sc1 lds
    s_add_u32 m0, s38, 14336
    s_add_u32 s32, s39, 737280
    buffer_load_dwordx4 v1, s[8:11], s32 offen sc1 lds
    s_add_u32 m0, s38, 15360
    s_add_u32 s32, s39, 884736
    buffer_load_dwordx4 v1, s[8:11], s32 offen sc1 lds
    s_add_u32 m0, s38, 16384
    s_add_u32 s32, s39, 1032192
    buffer_load_dwordx4 v1, s[8:11], s32 offen sc1 lds
    s_waitcnt vmcnt(8)
    s_barrier
    s_mov_b32 s35, 0
m_hpb:
    buffer_load_dwordx4 v[12:15], v8, s[8:11], s33 offen offset:16 sc1
    s_waitcnt vmcnt(0)
    v_add3_u32 v12, v12, v13, v14
    v_add_u32 v12, v12, v15
    s_nop 0
    v_readfirstlane_b32 s37, v12
    s_cmp_ge_u32 s37, 4
    s_cbranch_scc1 m_hpdb
    s_add_u32 s35, s35, 1
    s_cmp_lt_u32 s35, 0x100000
    s_cbranch_scc1 m_hpb
m_hpdb:
    s_add_u32 s39, s17, 0
    s_and_b32 s39, s39, 3
    s_mul_i32 s39, s39, 9
    s_add_u32 s39, s39, s42
    s_add_u32 s39, s39, 6
    s_lshl_b32 s39, s39, 10
    s_add_u32 s39, s39, s43
    s_add_u32 m0, s38, 46080
    s_add_u32 s32, s39, 0
    buffer_load_dwordx4 v1, s[8:11], s32 offen sc1 lds
    s_add_u32 m0, s38, 47104
    s_add_u32 s32, s39, 147456
    buffer_load_dwordx4 v1, s[8:11], s32 offen sc1 lds
    s_add_u32 m0, s38, 48128
    s_add_u32 s32, s39, 294912
    buffer_load_dwordx4 v1, s[8:11], s32 offen sc1 lds
    s_add_u32 m0, s38, 49152
    s_add_u32 s32, s39, 442368
    buffer_load_dwordx4 v1, s[8:11], s32 offen sc1 lds
    s_add_u32 m0, s38, 50176
    s_add_u32 s32, s39, 589824
    buffer_load_dwordx4 v1, s[8:11], s32 offen sc1 lds
    s_add_u32 m0, s38, 51200
    s_add_u32 s32, s39, 737280
    buffer_load_dwordx4 v1, s[8:11], s32 offen sc1 lds
    s_add_u32 m0, s38, 52224
    s_add_u32 s32, s39, 884736
    buffer_load_dwordx4 v1, s[8:11], s32 offen sc1 lds
    s_add_u32 m0, s38, 53248
    s_add_u32 s32, s39, 1032192
    buffer_load_dwordx4 v1, s[8:11], s32 offen sc1 lds
    s_barrier
    s_add_u32 s39, s17, 1
    s_and_b32 s39, s39, 3
    s_mul_i32 s39, s39, 9
    s_add_u32 s39, s39, s42
    s_add_u32 s39, s39, 6
    s_lshl_b32 s39, s39, 10
    s_add_u32 s39, s39, s43
    s_add_u32 m0, s38, 82944
    s_add_u32 s32, s39, 0
    buffer_load_dwordx4 v1, s[8:11], s32 offen sc1 lds
    s_add_u32 m0, s38, 83968
    s_add_u32 s32, s39, 147456
    buffer_load_dwordx4 v1, s[8:11], s32 offen sc1 lds
    s_add_u32 m0, s38, 84992
    s_add_u32 s32, s39, 294912
    buffer_load_dwordx4 v1, s[8:11], s32 offen sc1 lds
    s_add_u32 m0, s38, 86016
    s_add_u32 s32, s39, 442368
    buffer_load_dwordx4 v1, s[8:11], s32 offen sc1 lds
    s_add_u32 m0, s38, 87040
    s_add_u32 s32, s39, 589824
    buffer_load_dwordx4 v1, s[8:11], s32 offen sc1 lds
    s_add_u32 m0, s38, 88064
    s_add_u32 s32, s39, 737280
    buffer_load_dwordx4 v1, s[8:11], s32 offen sc1 lds
    s_add_u32 m0, s38, 89088
    s_add_u32 s32, s39, 884736
    buffer_load_dwordx4 v1, s[8:11], s32 offen sc1 lds
    s_add_u32 m0, s38, 90112
    s_add_u32 s32, s39, 1032192
    buffer_load_dwordx4 v1, s[8:11], s32 offen sc1 lds
    s_waitcnt vmcnt(8)
    s_barrier
    s_add_u32 s39, s17, 2
    s_and_b32 s39, s39, 3
    s_mul_i32 s39, s39, 9
    s_add_u32 s39, s39, s42
    s_add_u32 s39, s39, 6
    s_lshl_b32 s39, s39, 10
    s_add_u32 s39, s39, s43
    s_add_u32 m0, s38, 119808
    s_add_u32 s32, s39, 0
    buffer_load_dwordx4 v1, s[8:11], s32 offen sc1 lds
    s_add_u32 m0, s38, 120832
    s_add_u32 s32, s39, 147456
    buffer_load_dwordx4 v1, s[8:11], s32 offen sc1 lds
    s_add_u32 m0, s38, 121856
    s_add_u32 s32, s39, 294912
    buffer_load_dwordx4 v1, s[8:11], s32 offen sc1 lds
    s_add_u32 m0, s38, 122880
    s_add_u32 s32, s39, 442368
    buffer_load_dwordx4 v1, s[8:11], s32 offen sc1 lds
    s_add_u32 m0, s38, 123904
    s_add_u32 s32, s39, 589824
    buffer_load_dwordx4 v1, s[8:11], s32 offen sc1 lds
    s_add_u32 m0, s38, 124928
    s_add_u32 s32, s39, 737280
    buffer_load_dwordx4 v1, s[8:11], s32 offen sc1 lds
    s_add_u32 m0, s38, 125952
    s_add_u32 s32, s39, 884736
    buffer_load_dwordx4 v1, s[8:11], s32 offen sc1 lds
    s_add_u32 m0, s38, 126976
    s_add_u32 s32, s39, 1032192
    buffer_load_dwordx4 v1, s[8:11], s32 offen sc1 lds
    s_waitcnt vmcnt(8)
    s_barrier
    s_add_u32 s39, s17, 3
    s_and_b32 s39, s39, 3
    s_mul_i32 s39, s39, 9
    s_add_u32 s39, s39, s42
    s_add_u32 s39, s39, 6
    s_lshl_b32 s39, s39, 10
    s_add_u32 s39, s39, s43
    s_add_u32 m0, s38, 9216
    s_add_u32 s32, s39, 0
    buffer_load_dwordx4 v1, s[8:11], s32 offen sc1 lds
    s_add_u32 m0, s38, 10240
    s_add_u32 s32, s39, 147456
    buffer_load_dwordx4 v1, s[8:11], s32 offen sc1 lds
    s_add_u32 m0, s38, 11264
    s_add_u32 s32, s39, 294912
    buffer_load_dwordx4 v1, s[8:11], s32 offen sc1 lds
    s_add_u32 m0, s38, 12288
    s_add_u32 s32, s39, 442368
    buffer_load_dwordx4 v1, s[8:11], s32 offen sc1 lds
    s_add_u32 m0, s38, 13312
    s_add_u32 s32, s39, 589824
    buffer_load_dwordx4 v1, s[8:11], s32 offen sc1 lds
    s_add_u32 m0, s38, 14336
    s_add_u32 s32, s39, 737280
    buffer_load_dwordx4 v1, s[8:11], s32 offen sc1 lds
    s_add_u32 m0, s38, 15360
    s_add_u32 s32, s39, 884736
    buffer_load_dwordx4 v1, s[8:11], s32 offen sc1 lds
    s_add_u32 m0, s38, 16384
    s_add_u32 s32, s39, 1032192
    buffer_load_dwordx4 v1, s[8:11], s32 offen sc1 lds
    s_waitcnt vmcnt(8)
    s_barrier
    s_add_u32 s39, s17, s42
    s_add_u32 s39, s39, 0
    s_and_b32 s39, s39, 3
    s_mul_i32 s39, s39, 9
    s_add_u32 s39, s39, 8
    s_lshl_b32 s39, s39, 10
    s_add_u32 s39, s39, s43
    s_add_u32 m0, s38, 46080
    s_add_u32 s32, s39, 0
    buffer_load_dwordx4 v1, s[8:11], s32 offen sc1 lds
    s_add_u32 m0, s38, 47104
    s_add_u32 s32, s39, 147456
    buffer_load_dwordx4 v1, s[8:11], s32 offen sc1 lds
    s_add_u32 m0, s38, 48128
    s_add_u32 s32, s39, 294912
    buffer_load_dwordx4 v1, s[8:11], s32 offen sc1 lds
    s_add_u32 m0, s38, 49152
    s_add_u32 s32, s39, 442368
    buffer_load_dwordx4 v1, s[8:11], s32 offen sc1 lds
    s_add_u32 m0, s38, 50176
    s_add_u32 s32, s39, 589824
    buffer_load_dwordx4 v1, s[8:11], s32 offen sc1 lds
    s_add_u32 m0, s38, 51200
    s_add_u32 s32, s39, 737280
    buffer_load_dwordx4 v1, s[8:11], s32 offen sc1 lds
    s_add_u32 m0, s38, 52224
    s_add_u32 s32, s39, 884736
    buffer_load_dwordx4 v1, s[8:11], s32 offen sc1 lds
    s_add_u32 m0, s38, 53248
    s_add_u32 s32, s39, 1032192
    buffer_load_dwordx4 v1, s[8:11], s32 offen sc1 lds
    s_waitcnt vmcnt(8)
    s_barrier
    s_add_u32 s39, s17, s42
    s_add_u32 s39, s39, 2
    s_and_b32 s39, s39, 3
    s_mul_i32 s39, s39, 9
    s_add_u32 s39, s39, 8
    s_lshl_b32 s39, s39, 10
    s_add_u32 s39, s39, s43
    s_add_u32 m0, s38, 82944
    s_add_u32 s32, s39, 0
    buffer_load_dwordx4 v1, s[8:11], s32 offen sc1 lds
    s_add_u32 m0, s38, 83968
    s_add_u32 s32, s39, 147456
    buffer_load_dwordx4 v1, s[8:11], s32 offen sc1 lds
    s_add_u32 m0, s38, 84992
    s_add_u32 s32, s39, 294912
    buffer_load_dwordx4 v1, s[8:11], s32 offen sc1 lds
    s_add_u32 m0, s38, 86016
    s_add_u32 s32, s39, 442368
    buffer_load_dwordx4 v1, s[8:11], s32 offen sc1 lds
    s_add_u32 m0, s38, 87040
    s_add_u32 s32, s39, 589824
    buffer_load_dwordx4 v1, s[8:11], s32 offen sc1 lds
    s_add_u32 m0, s38, 88064
    s_add_u32 s32, s39, 737280
    buffer_load_dwordx4 v1, s[8:11], s32 offen sc1 lds
    s_add_u32 m0, s38, 89088
    s_add_u32 s32, s39, 884736
    buffer_load_dwordx4 v1, s[8:11], s32 offen sc1 lds
    s_add_u32 m0, s38, 90112
    s_add_u32 s32, s39, 1032192
    buffer_load_dwordx4 v1, s[8:11], s32 offen sc1 lds
    s_waitcnt vmcnt(8)
    s_barrier
    s_waitcnt vmcnt(0)
    s_barrier
    s_mov_b32 s13, s40
    s_mov_b32 s23, s41
    s_barrier
g2_phc:
    s_lshl_b32 s24, s23, 2
    s_add_u32 s24, s24, s13
    s_lshl_b32 s27, s24, 7
    s_add_u32 s27, s27, 53313536
    s_mul_i32 s26, s24, 36864
    s_add_u32 s26, s26, 34439168
    s_lshl_b32 s20, s14, 10
    s_add_u32 s26, s26, s20
    s_lshl_b32 s20, s14, 11
    v_add_u32 v4, s20, v1
    s_lshl_b32 s28, s12, 2
    s_add_u32 s28, s28, s13
    s_mul_i32 s30, s28, 72
    s_mul_i32 s31, s17, 18
    s_add_u32 s30, s30, s31
    s_lshl_b32 s31, s14, 1
    s_add_u32 s30, s30, s31
    s_lshl_b32 s30, s30, 9
    s_add_u32 s30, s30, 2441216
    v_lshrrev_b32 v7, 4, v0
    v_and_b32 v8, 15, v0
    v_lshrrev_b32 v9, 5, v0
    v_lshlrev_b32 v9, 9, v9
    v_lshl_add_u32 v9, v8, 4, v9
    v_and_b32 v10, 1, v7
    v_lshl_add_u32 v9, v10, 3, v9
    s_mul_i32 s31, s17, 576
    s_lshl_b32 s32, s14, 6
    s_add_u32 s31, s31, s32
    s_add_u32 s31, s31, 68864
    v_lshlrev_b32 v10, 4, v7
    s_lshl_b32 s32, s28, 5
    v_add_u32 v8, s32, v8
    v_mul_u32_u24 v8, 1152, v8
    v_lshl_add_u32 v8, v7, 3, v8
    s_mul_i32 s32, s17, 288
    s_lshl_b32 s33, s14, 5
    s_add_u32 s32, s32, s33
    s_add_u32 s37, s32, 18432
    v_mov_b32 v6, 0
    s_add_u32 s33, s30, 0
    buffer_load_dwordx2 v[12:13], v9, s[8:11], s33 offen
    buffer_load_dwordx2 v[14:15], v9, s[8:11], s33 offen offset:256
    buffer_load_dwordx4 v[20:23], v10, s[8:11], s31 offen offset:0
    s_add_u32 s33, s30, 8192
    buffer_load_dwordx2 v[16:17], v9, s[8:11], s33 offen
    buffer_load_dwordx2 v[18:19], v9, s[8:11], s33 offen offset:256
    buffer_load_dwordx4 v[24:27], v10, s[8:11], s31 offen offset:512
    s_waitcnt lgkmcnt(0)
    s_barrier
    ds_read_b128 v[32:35], v4 offset:0
    ds_read_b128 v[36:39], v4 offset:1024
    ds_read_b128 v[40:43], v4 offset:16384
    ds_read_b128 v[44:47], v4 offset:17408
    s_mov_b32 s36, 0
g2_poll:
    buffer_load_dwordx4 v[48:51], v6, s[8:11], s27 offen sc1
    s_waitcnt vmcnt(0)
    v_add3_u32 v48, v48, v49, v50
    v_add_u32 v48, v48, v51
    s_nop 0
    v_readfirstlane_b32 s33, v48
    s_cmp_ge_u32 s33, 3
    s_cbranch_scc1 g2_polled
    s_sleep 1
    s_add_u32 s36, s36, 1
    s_cmp_lt_u32 s36, 0x100000
    s_cbranch_scc1 g2_poll
g2_polled:
    s_add_u32 s33, s13, 1
    s_and_b32 s33, s33, 3
    s_mul_i32 s33, s33, 9216
    s_add_u32 s33, s33, s26
    s_add_u32 s33, s33, 0
    buffer_load_dwordx4 v[52:55], v1, s[8:11], s33 offen sc1
    s_add_u32 s33, s13, 2
    s_and_b32 s33, s33, 3
    s_mul_i32 s33, s33, 9216
    s_add_u32 s33, s33, s26
    s_add_u32 s33, s33, 0
    buffer_load_dwordx4 v[56:59], v1, s[8:11], s33 offen sc1
    s_add_u32 s33, s13, 3
    s_and_b32 s33, s33, 3
    s_mul_i32 s33, s33, 9216
    s_add_u32 s33, s33, s26
    s_add_u32 s33, s33, 0
    buffer_load_dwordx4 v[60:63], v1, s[8:11], s33 offen sc1
    s_cmp_lg_u32 s14, 0
    s_cbranch_scc1 g2_ld_done
    s_add_u32 s33, s13, 1
    s_and_b32 s33, s33, 3
    s_mul_i32 s33, s33, 9216
    s_add_u32 s33, s33, s26
    s_add_u32 s33, s33, 8192
    buffer_load_dwordx4 v[64:67], v1, s[8:11], s33 offen sc1
    s_add_u32 s33, s13, 2
    s_and_b32 s33, s33, 3
    s_mul_i32 s33, s33, 9216
    s_add_u32 s33, s33, s26
    s_add_u32 s33, s33, 8192
    buffer_load_dwordx4 v[68:71], v1, s[8:11], s33 offen sc1
    s_add_u32 s33, s13, 3
    s_and_b32 s33, s33, 3
    s_mul_i32 s33, s33, 9216
    s_add_u32 s33, s33, s26
    s_add_u32 s33, s33, 8192
    buffer_load_dwordx4 v[72:75], v1, s[8:11], s33 offen sc1
g2_ld_done:
    s_waitcnt vmcnt(0) lgkmcnt(0)
    v_lshlrev_b32 v92, 16, v52
    v_and_b32 v93, 0xffff0000, v52
    v_pk_add_f32 v[32:33], v[32:33], v[92:93]
    v_lshlrev_b32 v92, 16, v53
    v_and_b32 v93, 0xffff0000, v53
    v_pk_add_f32 v[34:35], v[34:35], v[92:93]
    v_lshlrev_b32 v92, 16, v56
    v_and_b32 v93, 0xffff0000, v56
    v_pk_add_f32 v[32:33], v[32:33], v[92:93]
    v_lshlrev_b32 v92, 16, v57
    v_and_b32 v93, 0xffff0000, v57
    v_pk_add_f32 v[34:35], v[34:35], v[92:93]
    v_lshlrev_b32 v92, 16, v60
    v_and_b32 v93, 0xffff0000, v60
    v_pk_add_f32 v[32:33], v[32:33], v[92:93]
    v_lshlrev_b32 v92, 16, v61
    v_and_b32 v93, 0xffff0000, v61
    v_pk_add_f32 v[34:35], v[34:35], v[92:93]
    v_cvt_pk_bf16_f32 v90, v32, v33
    v_lshlrev_b32 v92, 16, v90
    v_and_b32 v93, 0xffff0000, v90
    v_pk_mul_f32 v[92:93], v[92:93], v[20:21]
    v_cvt_pk_bf16_f32 v90, v92, v93
    v_lshlrev_b32 v92, 16, v90
    v_and_b32 v93, 0xffff0000, v90
    v_lshlrev_b32 v94, 16, v12
    v_and_b32 v95, 0xffff0000, v12
    v_pk_add_f32 v[92:93], v[92:93], v[94:95]
    v_cvt_pk_bf16_f32 v96, v92, v93
    v_cvt_pk_bf16_f32 v90, v34, v35
    v_lshlrev_b32 v92, 16, v90
    v_and_b32 v93, 0xffff0000, v90
    v_pk_mul_f32 v[92:93], v[92:93], v[22:23]
    v_cvt_pk_bf16_f32 v90, v92, v93
    v_lshlrev_b32 v92, 16, v90
    v_and_b32 v93, 0xffff0000, v90
    v_lshlrev_b32 v94, 16, v13
    v_and_b32 v95, 0xffff0000, v13
    v_pk_add_f32 v[92:93], v[92:93], v[94:95]
    v_cvt_pk_bf16_f32 v97, v92, v93
    buffer_store_dwordx2 v[96:97], v8, s[48:51], s32 offen offset:0
    v_lshlrev_b32 v92, 16, v54
    v_and_b32 v93, 0xffff0000, v54
    v_pk_add_f32 v[36:37], v[36:37], v[92:93]
    v_lshlrev_b32 v92, 16, v55
    v_and_b32 v93, 0xffff0000, v55
    v_pk_add_f32 v[38:39], v[38:39], v[92:93]
    v_lshlrev_b32 v92, 16, v58
    v_and_b32 v93, 0xffff0000, v58
    v_pk_add_f32 v[36:37], v[36:37], v[92:93]
    v_lshlrev_b32 v92, 16, v59
    v_and_b32 v93, 0xffff0000, v59
    v_pk_add_f32 v[38:39], v[38:39], v[92:93]
    v_lshlrev_b32 v92, 16, v62
    v_and_b32 v93, 0xffff0000, v62
    v_pk_add_f32 v[36:37], v[36:37], v[92:93]
    v_lshlrev_b32 v92, 16, v63
    v_and_b32 v93, 0xffff0000, v63
    v_pk_add_f32 v[38:39], v[38:39], v[92:93]
    v_cvt_pk_bf16_f32 v90, v36, v37
    v_lshlrev_b32 v92, 16, v90
    v_and_b32 v93, 0xffff0000, v90
    v_pk_mul_f32 v[92:93], v[92:93], v[20:21]
    v_cvt_pk_bf16_f32 v90, v92, v93
    v_lshlrev_b32 v92, 16, v90
    v_and_b32 v93, 0xffff0000, v90
    v_lshlrev_b32 v94, 16, v14
    v_and_b32 v95, 0xffff0000, v14
    v_pk_add_f32 v[92:93], v[92:93], v[94:95]
    v_cvt_pk_bf16_f32 v98, v92, v93
    v_cvt_pk_bf16_f32 v90, v38, v39
    v_lshlrev_b32 v92, 16, v90
    v_and_b32 v93, 0xffff0000, v90
    v_pk_mul_f32 v[92:93], v[92:93], v[22:23]
    v_cvt_pk_bf16_f32 v90, v92, v93
    v_lshlrev_b32 v92, 16, v90
    v_and_b32 v93, 0xffff0000, v90
    v_lshlrev_b32 v94, 16, v15
    v_and_b32 v95, 0xffff0000, v15
    v_pk_add_f32 v[92:93], v[92:93], v[94:95]
    v_cvt_pk_bf16_f32 v99, v92, v93
    buffer_store_dwordx2 v[98:99], v8, s[48:51], s37 offen offset:0
    s_cmp_lg_u32 s14, 0
    s_cbranch_scc1 g2_fin
    v_lshlrev_b32 v92, 16, v64
    v_and_b32 v93, 0xffff0000, v64
    v_pk_add_f32 v[40:41], v[40:41], v[92:93]
    v_lshlrev_b32 v92, 16, v65
    v_and_b32 v93, 0xffff0000, v65
    v_pk_add_f32 v[42:43], v[42:43], v[92:93]
    v_lshlrev_b32 v92, 16, v68
    v_and_b32 v93, 0xffff0000, v68
    v_pk_add_f32 v[40:41], v[40:41], v[92:93]
    v_lshlrev_b32 v92, 16, v69
    v_and_b32 v93, 0xffff0000, v69
    v_pk_add_f32 v[42:43], v[42:43], v[92:93]
    v_lshlrev_b32 v92, 16, v72
    v_and_b32 v93, 0xffff0000, v72
    v_pk_add_f32 v[40:41], v[40:41], v[92:93]
    v_lshlrev_b32 v92, 16, v73
    v_and_b32 v93, 0xffff0000, v73
    v_pk_add_f32 v[42:43], v[42:43], v[92:93]
    v_cvt_pk_bf16_f32 v90, v40, v41
    v_lshlrev_b32 v92, 16, v90
    v_and_b32 v93, 0xffff0000, v90
    v_pk_mul_f32 v[92:93], v[92:93], v[24:25]
    v_cvt_pk_bf16_f32 v90, v92, v93
    v_lshlrev_b32 v92, 16, v90
    v_and_b32 v93, 0xffff0000, v90
    v_lshlrev_b32 v94, 16, v16
    v_and_b32 v95, 0xffff0000, v16
    v_pk_add_f32 v[92:93], v[92:93], v[94:95]
    v_cvt_pk_bf16_f32 v100, v92, v93
    v_cvt_pk_bf16_f32 v90, v42, v43
    v_lshlrev_b32 v92, 16, v90
    v_and_b32 v93, 0xffff0000, v90
    v_pk_mul_f32 v[92:93], v[92:93], v[26:27]
    v_cvt_pk_bf16_f32 v90, v92, v93
    v_lshlrev_b32 v92, 16, v90
    v_and_b32 v93, 0xffff0000, v90
    v_lshlrev_b32 v94, 16, v17
    v_and_b32 v95, 0xffff0000, v17
    v_pk_add_f32 v[92:93], v[92:93], v[94:95]
    v_cvt_pk_bf16_f32 v101, v92, v93
    buffer_store_dwordx2 v[100:101], v8, s[48:51], s32 offen offset:256
    v_lshlrev_b32 v92, 16, v66
    v_and_b32 v93, 0xffff0000, v66
    v_pk_add_f32 v[44:45], v[44:45], v[92:93]
    v_lshlrev_b32 v92, 16, v67
    v_and_b32 v93, 0xffff0000, v67
    v_pk_add_f32 v[46:47], v[46:47], v[92:93]
    v_lshlrev_b32 v92, 16, v70
    v_and_b32 v93, 0xffff0000, v70
    v_pk_add_f32 v[44:45], v[44:45], v[92:93]
    v_lshlrev_b32 v92, 16, v71
    v_and_b32 v93, 0xffff0000, v71
    v_pk_add_f32 v[46:47], v[46:47], v[92:93]
    v_lshlrev_b32 v92, 16, v74
    v_and_b32 v93, 0xffff0000, v74
    v_pk_add_f32 v[44:45], v[44:45], v[92:93]
    v_lshlrev_b32 v92, 16, v75
    v_and_b32 v93, 0xffff0000, v75
    v_pk_add_f32 v[46:47], v[46:47], v[92:93]
    v_cvt_pk_bf16_f32 v90, v44, v45
    v_lshlrev_b32 v92, 16, v90
    v_and_b32 v93, 0xffff0000, v90
    v_pk_mul_f32 v[92:93], v[92:93], v[24:25]
    v_cvt_pk_bf16_f32 v90, v92, v93
    v_lshlrev_b32 v92, 16, v90
    v_and_b32 v93, 0xffff0000, v90
    v_lshlrev_b32 v94, 16, v18
    v_and_b32 v95, 0xffff0000, v18
    v_pk_add_f32 v[92:93], v[92:93], v[94:95]
    v_cvt_pk_bf16_f32 v102, v92, v93
    v_cvt_pk_bf16_f32 v90, v46, v47
    v_lshlrev_b32 v92, 16, v90
    v_and_b32 v93, 0xffff0000, v90
    v_pk_mul_f32 v[92:93], v[92:93], v[26:27]
    v_cvt_pk_bf16_f32 v90, v92, v93
    v_lshlrev_b32 v92, 16, v90
    v_and_b32 v93, 0xffff0000, v90
    v_lshlrev_b32 v94, 16, v19
    v_and_b32 v95, 0xffff0000, v19
    v_pk_add_f32 v[92:93], v[92:93], v[94:95]
    v_cvt_pk_bf16_f32 v103, v92, v93
    buffer_store_dwordx2 v[102:103], v8, s[48:51], s37 offen offset:256
g2_fin:
g2_end:
    s_endpgm
code_end:
.section .rodata,"a"
.p2align 6
.amdhsa_kernel f_kernel
  .amdhsa_next_free_vgpr 256
  .amdhsa_next_free_sgpr 102
  .amdhsa_accum_offset 256
  .amdhsa_group_segment_fixed_size 0
  .amdhsa_kernarg_size 120
  .amdhsa_user_sgpr_count 2
  .amdhsa_user_sgpr_kernarg_segment_ptr 1
  .amdhsa_system_sgpr_workgroup_id_x 1
  .amdhsa_float_denorm_mode_32 3
.end_amdhsa_kernel
.p2align 6
.amdhsa_kernel m_kernel
  .amdhsa_next_free_vgpr 256
  .amdhsa_next_free_sgpr 96
  .amdhsa_accum_offset 256
  .amdhsa_group_segment_fixed_size 0
  .amdhsa_kernarg_size 120
  .amdhsa_user_sgpr_count 2
  .amdhsa_user_sgpr_kernarg_segment_ptr 1
  .amdhsa_system_sgpr_workgroup_id_x 1
  .amdhsa_float_denorm_mode_32 3
.end_amdhsa_kernel
```
